```python
import torch

def _softmax(x, axis=-1):
    return torch.softmax(x, dim=axis)

def _gelu(x):
    return torch.nn.functional.gelu(x, approximate='tanh')

def _silu(x):
    return torch.nn.functional.silu(x)

def _sigmoid(x):
    return torch.sigmoid(x)

def _layernorm(x, axis=-1, eps=1e-05):
    m = x.mean(dim=axis, keepdim=True)
    v = x.var(dim=axis, keepdim=True, unbiased=False)
    return (x - m) / torch.sqrt(v + eps)

def _scatter_add(tgt, idx, src, axis=0):
    return tgt.clone().index_add_(axis, idx, src)

def _segment_sum(src, seg, n):
    out = torch.zeros((n,) + src.shape[1:], dtype=src.dtype)
    return out.index_add_(0, seg, src)

def _pad(x, pw):
    flat = tuple((v for pair in reversed(pw) for v in pair))
    return torch.nn.functional.pad(x, flat)
kernel_name = 'adaLN_cond__spectral_gfnet__glu_gated_swiglu__prompt'

def setup_inputs():

    _w = lambda a: (lambda t: t.to(torch.bfloat16) if t.is_floating_point() else t)(torch.as_tensor(a))

    def _A_setup():
        B, S, D = (1, 2048, 640)
        Df = D // 2 + 1
        return {'x': _w((lambda *s: torch.randn(*s, dtype=torch.bfloat16) * 0.05)(B, S, D)), 'w_r': _w((lambda *s: torch.randn(*s, dtype=torch.bfloat16) * 1.6)(S, Df) * 0.02), 'w_i': _w((lambda *s: torch.randn(*s, dtype=torch.bfloat16) * 1.6)(S, Df) * 0.02)}
    _A_in = _A_setup()

    def _B_setup():
        B, S, D, F = (1, 2048, 640, 1728)
        return {'x': _w((lambda *s: torch.randn(*s, dtype=torch.bfloat16) * 0.05)(B, S, D)), 'w1': _w((lambda *s: torch.randn(*s, dtype=torch.bfloat16) * 0.4)(D, F) * (2.0 / D) ** 0.5), 'w3': _w((lambda *s: torch.randn(*s, dtype=torch.bfloat16) * 0.4)(D, F) * (2.0 / D) ** 0.5), 'w2': _w((lambda *s: torch.randn(*s, dtype=torch.bfloat16) * 0.4)(F, D) * (2.0 / F) ** 0.5)}
    _B_in = _B_setup()
    return {'A_x': _A_in['x'], 'A_w_r': _A_in['w_r'], 'A_w_i': _A_in['w_i'], 'B_x': _B_in['x'], 'B_w1': _B_in['w1'], 'B_w3': _B_in['w3'], 'B_w2': _B_in['w2'], 'c': _w((lambda *s: torch.randn(*s, dtype=torch.bfloat16) * 0.1)(1, 640) * 8.0), 'w_mod': _w((lambda *s: torch.randn(*s, dtype=torch.bfloat16) * 0.1)(640, 6 * 640) * 640 ** (-0.5) * 8.0)}

def reference(A_x, A_w_r, A_w_i, B_x, B_w1, B_w3, B_w2, c, w_mod):

    def _A_ref(x, w_r, w_i):
        B, S, D = x.shape
        X = (lambda x, axes=(-2, -1): torch.fft.rfft2(x.float(), dim=axes))(x, axes=(-2, -1))
        W = w_r + 1j * w_i
        X = X * W
        y = (lambda x, s, axes=(-2, -1): torch.fft.irfft2(x, s=s, dim=axes).to(torch.bfloat16))(X, (S, D), axes=(-2, -1))
        return y

    def _B_ref(x, w1, w3, w2):
        gate = torch.einsum('bsd,df->bsf', x, w1)
        up = torch.einsum('bsd,df->bsf', x, w3)
        h = _silu(gate) * up
        out = torch.einsum('bsf,fd->bsd', h, w2)
        return out
    x = A_x
    mod = (_silu(c) @ w_mod).reshape(c.shape[0], 6, 1, -1)
    sa, ca, ga, sb, cb, gb = (mod[:, 0].clone(), mod[:, 1].clone(), mod[:, 2].clone(), mod[:, 3].clone(), mod[:, 4].clone(), mod[:, 5].clone())
    h = _layernorm(x, axis=-1) * (1 + ca) + sa
    x = x + ga * _A_ref(h, A_w_r, A_w_i)
    h = _layernorm(x, axis=-1) * (1 + cb) + sb
    x = x + gb * _B_ref(h, B_w1, B_w3, B_w2)
    return x
```

```asm
; @launch grid=(256,1,1) block=(256,1,1) lds=163840
.amdgcn_target "amdgcn-amd-amdhsa--gfx950"
.text
.globl adaLN_cond__spectral_gfnet__glu_gated_swiglu__prompt_kernel
.p2align 8
.type adaLN_cond__spectral_gfnet__glu_gated_swiglu__prompt_kernel,@function
adaLN_cond__spectral_gfnet__glu_gated_swiglu__prompt_kernel:
  s_cmp_ge_u32 s2, 256
  s_cbranch_scc1 L_end
  s_load_dwordx16 s[64:79], s[0:1], 0
  s_load_dwordx8 s[80:87], s[0:1], 64
  s_getpc_b64 s[60:61]
L_pc:
  v_lshrrev_b32 v2, 6, v0
  s_lshr_b32 s62, s2, 3
  s_lshl_b32 s62, s62, 2
  v_add_u32 v2, s62, v2
  v_and_b32 v3, 7, v0
  v_lshl_add_u32 v2, v2, 3, v3
  v_lshlrev_b32 v2, 6, v2
  v_min_u32 v2, L_code_end-L_pc-4, v2
  v_mov_b32 v3, s61
  v_add_co_u32 v2, vcc, s60, v2
  s_nop 1
  v_addc_co_u32 v3, vcc, 0, v3, vcc
  global_load_dword v253, v[2:3], off
  v_lshrrev_b32 v1, 6, v0
  s_and_b32 s96, s2, 7
  v_readfirstlane_b32 s3, v1
  v_and_b32 v1, 63, v0
  s_lshr_b32 s95, s2, 3
  s_mul_i32 s54, s95, 37
  s_lshr_b32 s54, s54, 8
  s_mul_i32 s55, s54, 7
  s_sub_u32 s91, s95, s55
  s_lshl_b32 s54, s54, 3
  s_add_u32 s90, s54, s96
  s_mul_i32 s56, s91, 3
  s_add_u32 s92, s56, s3
  s_mov_b32 s93, s90
  s_sub_u32 s94, 2048, s90
  s_cmp_eq_u32 s90, 0
  s_cselect_b32 s94, 32, s94
  s_cmp_ge_u32 s95, 16
  s_cbranch_scc1 L_p1_gemv
  s_lshr_b32 s54, s95, 2
  s_lshl_b32 s54, s54, 3
  s_add_u32 s54, s54, s96
  s_and_b32 s55, s95, 3
  v_add_u32 v12, 0, v1
  v_mul_u32_u24 v13, 0xcccd, v12
  v_lshrrev_b32 v13, 22, v13
  v_mul_u32_u24 v14, 80, v13
  v_sub_u32 v14, v12, v14
  v_lshlrev_b32 v15, 1, v13
  v_xor_b32 v14, v14, v15
  v_mul_u32_u24 v13, 0xa000, v13
  v_lshl_add_u32 v2, v14, 4, v13
  v_xor_b32 v14, 8, v14
  v_lshl_add_u32 v7, v14, 4, v13
  v_add_u32 v12, 64, v1
  v_mul_u32_u24 v13, 0xcccd, v12
  v_lshrrev_b32 v13, 22, v13
  v_mul_u32_u24 v14, 80, v13
  v_sub_u32 v14, v12, v14
  v_lshlrev_b32 v15, 1, v13
  v_xor_b32 v14, v14, v15
  v_mul_u32_u24 v13, 0xa000, v13
  v_lshl_add_u32 v3, v14, 4, v13
  v_xor_b32 v14, 8, v14
  v_lshl_add_u32 v8, v14, 4, v13
  v_add_u32 v12, 128, v1
  v_mul_u32_u24 v13, 0xcccd, v12
  v_lshrrev_b32 v13, 22, v13
  v_mul_u32_u24 v14, 80, v13
  v_sub_u32 v14, v12, v14
  v_lshlrev_b32 v15, 1, v13
  v_xor_b32 v14, v14, v15
  v_mul_u32_u24 v13, 0xa000, v13
  v_lshl_add_u32 v4, v14, 4, v13
  v_xor_b32 v14, 8, v14
  v_lshl_add_u32 v9, v14, 4, v13
  v_add_u32 v12, 192, v1
  v_mul_u32_u24 v13, 0xcccd, v12
  v_lshrrev_b32 v13, 22, v13
  v_mul_u32_u24 v14, 80, v13
  v_sub_u32 v14, v12, v14
  v_lshlrev_b32 v15, 1, v13
  v_xor_b32 v14, v14, v15
  v_mul_u32_u24 v13, 0xa000, v13
  v_lshl_add_u32 v5, v14, 4, v13
  v_xor_b32 v14, 8, v14
  v_lshl_add_u32 v10, v14, 4, v13
  v_add_u32 v12, 256, v1
  v_mul_u32_u24 v13, 0xcccd, v12
  v_lshrrev_b32 v13, 22, v13
  v_mul_u32_u24 v14, 80, v13
  v_sub_u32 v14, v12, v14
  v_lshlrev_b32 v15, 1, v13
  v_xor_b32 v14, v14, v15
  v_mul_u32_u24 v13, 0xa000, v13
  v_lshl_add_u32 v6, v14, 4, v13
  v_xor_b32 v14, 8, v14
  v_lshl_add_u32 v11, v14, 4, v13
  s_mul_i32 s56, s54, 1280
  s_mul_i32 s57, s3, 655360
  s_add_u32 s56, s56, s57
  s_mul_i32 s57, s3, 20480
  s_waitcnt lgkmcnt(0)
  s_mov_b32 s4, s64
  s_mov_b32 s5, s65
  s_mov_b32 s6, 0x280000
  s_mov_b32 s7, 0x00020000
  s_add_u32 m0, s57, 0
  s_nop 0
  buffer_load_dwordx4 v2, s[4:7], s56 offen lds
  s_add_u32 m0, s57, 1024
  s_nop 0
  buffer_load_dwordx4 v3, s[4:7], s56 offen lds
  s_add_u32 m0, s57, 2048
  s_nop 0
  buffer_load_dwordx4 v4, s[4:7], s56 offen lds
  s_add_u32 m0, s57, 3072
  s_nop 0
  buffer_load_dwordx4 v5, s[4:7], s56 offen lds
  s_add_u32 m0, s57, 4096
  s_nop 0
  buffer_load_dwordx4 v6, s[4:7], s56 offen lds
  s_add_u32 s56, s56, 163840
  s_add_u32 m0, s57, 5120
  s_nop 0
  buffer_load_dwordx4 v2, s[4:7], s56 offen lds
  s_add_u32 m0, s57, 6144
  s_nop 0
  buffer_load_dwordx4 v3, s[4:7], s56 offen lds
  s_add_u32 m0, s57, 7168
  s_nop 0
  buffer_load_dwordx4 v4, s[4:7], s56 offen lds
  s_add_u32 m0, s57, 8192
  s_nop 0
  buffer_load_dwordx4 v5, s[4:7], s56 offen lds
  s_add_u32 m0, s57, 9216
  s_nop 0
  buffer_load_dwordx4 v6, s[4:7], s56 offen lds
  s_add_u32 s56, s56, 163840
  s_add_u32 m0, s57, 10240
  s_nop 0
  buffer_load_dwordx4 v7, s[4:7], s56 offen lds
  s_add_u32 m0, s57, 11264
  s_nop 0
  buffer_load_dwordx4 v8, s[4:7], s56 offen lds
  s_add_u32 m0, s57, 12288
  s_nop 0
  buffer_load_dwordx4 v9, s[4:7], s56 offen lds
  s_add_u32 m0, s57, 13312
  s_nop 0
  buffer_load_dwordx4 v10, s[4:7], s56 offen lds
  s_add_u32 m0, s57, 14336
  s_nop 0
  buffer_load_dwordx4 v11, s[4:7], s56 offen lds
  s_add_u32 s56, s56, 163840
  s_add_u32 m0, s57, 15360
  s_nop 0
  buffer_load_dwordx4 v7, s[4:7], s56 offen lds
  s_add_u32 m0, s57, 16384
  s_nop 0
  buffer_load_dwordx4 v8, s[4:7], s56 offen lds
  s_add_u32 m0, s57, 17408
  s_nop 0
  buffer_load_dwordx4 v9, s[4:7], s56 offen lds
  s_add_u32 m0, s57, 18432
  s_nop 0
  buffer_load_dwordx4 v10, s[4:7], s56 offen lds
  s_add_u32 m0, s57, 19456
  s_nop 0
  buffer_load_dwordx4 v11, s[4:7], s56 offen lds
  s_mov_b32 s8, s66
  s_mov_b32 s9, s67
  s_mov_b32 s10, 0x141000
  s_mov_b32 s11, 0x00020000
  s_mov_b32 s12, s68
  s_mov_b32 s13, s69
  s_mov_b32 s14, 0x141000
  s_mov_b32 s15, 0x00020000
  s_mov_b32 s16, s72
  s_mov_b32 s17, s73
  s_mov_b32 s18, 0x21c000
  s_mov_b32 s19, 0x00020000
  s_mov_b32 s20, s74
  s_mov_b32 s21, s75
  s_mov_b32 s22, 0x21c000
  s_mov_b32 s23, 0x00020000
  s_mov_b32 s24, s76
  s_mov_b32 s25, s77
  s_mov_b32 s26, 0x21c000
  s_mov_b32 s27, 0x00020000
  s_mov_b32 s28, s78
  s_mov_b32 s29, s79
  s_mov_b32 s30, 0x500
  s_mov_b32 s31, 0x00020000
  s_mov_b32 s32, s80
  s_mov_b32 s33, s81
  s_mov_b32 s34, 0x4b0000
  s_mov_b32 s35, 0x00020000
  s_mov_b32 s36, s82
  s_mov_b32 s37, s83
  s_mov_b32 s38, 0x280000
  s_mov_b32 s39, 0x00020000
  s_mov_b32 s40, s84
  s_mov_b32 s41, s85
  s_mov_b32 s42, 0x100
  s_mov_b32 s43, 0x00020000
  s_mov_b32 s44, s86
  s_mov_b32 s45, s87
  s_mov_b32 s46, 0x1c80000
  s_mov_b32 s47, 0x00020000
  v_and_b32 v12, 15, v1
  v_lshrrev_b32 v13, 4, v1
  s_lshl_b32 s58, s3, 4
  v_add_u32 v14, s58, v12
  v_cmp_lt_u32 vcc, 32, v14
  v_subrev_u32 v15, 32, v14
  s_nop 0
  v_cndmask_b32 v15, v14, v15, vcc
  v_mov_b32 v16, 0
  v_mov_b32 v17, 0x3e800000
  v_cndmask_b32 v16, v16, v17, vcc
  v_cvt_f32_u32 v15, v15
  v_mul_f32 v15, 0x3c800000, v15
  v_lshlrev_b32 v17, 3, v13
  v_cvt_f32_u32 v17, v17
  v_fma_f32 v16, v15, v17, v16
  v_cos_f32 v20, v16
  v_fmamk_f32 v18, v15, 0x3f800000, v16
  v_cos_f32 v21, v18
  v_fmamk_f32 v18, v15, 0x40000000, v16
  v_cos_f32 v22, v18
  v_fmamk_f32 v18, v15, 0x40400000, v16
  v_cos_f32 v23, v18
  v_fmamk_f32 v18, v15, 0x40800000, v16
  v_cos_f32 v24, v18
  v_fmamk_f32 v18, v15, 0x40a00000, v16
  v_cos_f32 v25, v18
  v_fmamk_f32 v18, v15, 0x40c00000, v16
  v_cos_f32 v26, v18
  v_fmamk_f32 v18, v15, 0x40e00000, v16
  v_cos_f32 v27, v18
  v_fmamk_f32 v18, v15, 0x42000000, v16
  v_cos_f32 v28, v18
  v_fmamk_f32 v18, v15, 0x42040000, v16
  v_cos_f32 v29, v18
  v_fmamk_f32 v18, v15, 0x42080000, v16
  v_cos_f32 v30, v18
  v_fmamk_f32 v18, v15, 0x420c0000, v16
  v_cos_f32 v31, v18
  v_fmamk_f32 v18, v15, 0x42100000, v16
  v_cos_f32 v32, v18
  v_fmamk_f32 v18, v15, 0x42140000, v16
  v_cos_f32 v33, v18
  v_fmamk_f32 v18, v15, 0x42180000, v16
  v_cos_f32 v34, v18
  v_fmamk_f32 v18, v15, 0x421c0000, v16
  v_cos_f32 v35, v18
  v_and_b32 v14, 3, v12
  v_lshlrev_b32 v14, 1, v14
  v_and_b32 v15, 8, v12
  v_or_b32 v14, v14, v15
  v_add_u32 v15, s58, v12
  v_mul_u32_u24 v15, 1280, v15
  v_add_u32 v16, 0, v13
  v_xor_b32 v16, v16, v14
  v_lshl_add_u32 v36, v16, 4, v15
  v_add_u32 v16, 4, v13
  v_xor_b32 v16, v16, v14
  v_lshl_add_u32 v37, v16, 4, v15
  v_add_u32 v16, 8, v13
  v_xor_b32 v16, v16, v14
  v_lshl_add_u32 v38, v16, 4, v15
  v_add_u32 v16, 12, v13
  v_xor_b32 v16, v16, v14
  v_lshl_add_u32 v39, v16, 4, v15
  v_mov_b32 v112, 0x3f803f80
  v_mov_b32 v113, v112
  v_mov_b32 v114, v112
  v_mov_b32 v115, v112
  s_cmp_eq_u32 s3, 3
  s_cbranch_scc1 L_wde3
  v_lshrrev_b32 v2, 4, v1
  v_bfe_u32 v3, v1, 2, 2
  v_and_b32 v4, 3, v1
  v_lshlrev_b32 v2, 6, v2
  v_lshl_add_u32 v2, v3, 8, v2
  v_lshlrev_b32 v4, 4, v4
  s_lshl_b32 s59, s92, 5
  v_mov_b32 v5, s59
  s_movk_i32 s59, 642
  s_lshl_b32 s60, s3, 13
  s_add_u32 s60, s60, 82944
  s_add_u32 s61, s93, 0
  v_add_u32 v6, s61, v2
  v_and_b32 v6, 2047, v6
  v_mad_u32_u24 v7, v6, s59, v5
  v_and_b32 v7, -4, v7
  v_min_u32 v7, 1314752, v7
  v_add_u32 v7, v7, v4
  s_add_u32 s61, s93, 1024
  v_add_u32 v6, s61, v2
  v_and_b32 v6, 2047, v6
  v_mad_u32_u24 v8, v6, s59, v5
  v_and_b32 v8, -4, v8
  v_min_u32 v8, 1314752, v8
  v_add_u32 v8, v8, v4
  s_add_u32 s61, s94, 0
  v_add_u32 v6, s61, v2
  v_and_b32 v6, 2047, v6
  v_mad_u32_u24 v9, v6, s59, v5
  v_and_b32 v9, -4, v9
  v_min_u32 v9, 1314752, v9
  v_add_u32 v9, v9, v4
  s_add_u32 s61, s94, 1024
  v_add_u32 v6, s61, v2
  v_and_b32 v6, 2047, v6
  v_mad_u32_u24 v10, v6, s59, v5
  v_and_b32 v10, -4, v10
  v_min_u32 v10, 1314752, v10
  v_add_u32 v10, v10, v4
  s_add_u32 m0, s60, 0
  s_nop 0
  buffer_load_dwordx4 v7, s[8:11], 0 offen lds
  s_add_u32 m0, s60, 1024
  s_nop 0
  buffer_load_dwordx4 v8, s[8:11], 0 offen lds
  s_add_u32 m0, s60, 2048
  s_nop 0
  buffer_load_dwordx4 v9, s[8:11], 0 offen lds
  s_add_u32 m0, s60, 3072
  s_nop 0
  buffer_load_dwordx4 v10, s[8:11], 0 offen lds
  s_add_u32 m0, s60, 4096
  s_nop 0
  buffer_load_dwordx4 v7, s[12:15], 0 offen lds
  s_add_u32 m0, s60, 5120
  s_nop 0
  buffer_load_dwordx4 v8, s[12:15], 0 offen lds
  s_add_u32 m0, s60, 6144
  s_nop 0
  buffer_load_dwordx4 v9, s[12:15], 0 offen lds
  s_add_u32 m0, s60, 7168
  s_nop 0
  buffer_load_dwordx4 v10, s[12:15], 0 offen lds
  s_waitcnt vmcnt(8)
  s_branch L_wde
L_wde3:
  s_waitcnt vmcnt(0)
L_wde:
  ds_read_b128 v[120:123], v36 offset:0
  ds_read_b128 v[124:127], v37 offset:0
  ds_read_b128 v[128:131], v38 offset:0
  ds_read_b128 v[132:135], v39 offset:0
  ds_read_b128 v[136:139], v36 offset:256
  ds_read_b128 v[140:143], v37 offset:256
  ds_read_b128 v[144:147], v38 offset:256
  ds_read_b128 v[148:151], v39 offset:256
  ds_read_b128 v[152:155], v36 offset:512
  ds_read_b128 v[156:159], v37 offset:512
  ds_read_b128 v[160:163], v38 offset:512
  s_waitcnt lgkmcnt(10)
  v_mfma_f32_16x16x32_bf16 v[40:43], v[120:123], v[120:123], 0
  v_mfma_f32_16x16x32_bf16 v[44:47], v[120:123], v[112:115], 0
  ds_read_b128 v[164:167], v39 offset:512
  s_waitcnt lgkmcnt(10)
  v_mfma_f32_16x16x32_bf16 v[40:43], v[124:127], v[124:127], v[40:43]
  v_mfma_f32_16x16x32_bf16 v[44:47], v[124:127], v[112:115], v[44:47]
  ds_read_b128 v[168:171], v36 offset:768
  s_waitcnt lgkmcnt(10)
  v_mfma_f32_16x16x32_bf16 v[40:43], v[128:131], v[128:131], v[40:43]
  v_mfma_f32_16x16x32_bf16 v[44:47], v[128:131], v[112:115], v[44:47]
  ds_read_b128 v[172:175], v37 offset:768
  s_waitcnt lgkmcnt(10)
  v_mfma_f32_16x16x32_bf16 v[40:43], v[132:135], v[132:135], v[40:43]
  v_mfma_f32_16x16x32_bf16 v[44:47], v[132:135], v[112:115], v[44:47]
  ds_read_b128 v[176:179], v38 offset:768
  s_waitcnt lgkmcnt(10)
  v_mfma_f32_16x16x32_bf16 v[40:43], v[136:139], v[136:139], v[40:43]
  v_mfma_f32_16x16x32_bf16 v[44:47], v[136:139], v[112:115], v[44:47]
  ds_read_b128 v[180:183], v39 offset:768
  s_waitcnt lgkmcnt(10)
  v_mfma_f32_16x16x32_bf16 v[40:43], v[140:143], v[140:143], v[40:43]
  v_mfma_f32_16x16x32_bf16 v[44:47], v[140:143], v[112:115], v[44:47]
  ds_read_b128 v[184:187], v36 offset:1024
  s_waitcnt lgkmcnt(10)
  v_mfma_f32_16x16x32_bf16 v[40:43], v[144:147], v[144:147], v[40:43]
  v_mfma_f32_16x16x32_bf16 v[44:47], v[144:147], v[112:115], v[44:47]
  ds_read_b128 v[188:191], v37 offset:1024
  s_waitcnt lgkmcnt(10)
  v_mfma_f32_16x16x32_bf16 v[40:43], v[148:151], v[148:151], v[40:43]
  v_mfma_f32_16x16x32_bf16 v[44:47], v[148:151], v[112:115], v[44:47]
  ds_read_b128 v[192:195], v38 offset:1024
  s_waitcnt lgkmcnt(10)
  v_mfma_f32_16x16x32_bf16 v[40:43], v[152:155], v[152:155], v[40:43]
  v_mfma_f32_16x16x32_bf16 v[44:47], v[152:155], v[112:115], v[44:47]
  ds_read_b128 v[196:199], v39 offset:1024
  s_waitcnt lgkmcnt(10)
  v_mfma_f32_16x16x32_bf16 v[40:43], v[156:159], v[156:159], v[40:43]
  v_mfma_f32_16x16x32_bf16 v[44:47], v[156:159], v[112:115], v[44:47]
  s_waitcnt lgkmcnt(9)
  v_mfma_f32_16x16x32_bf16 v[40:43], v[160:163], v[160:163], v[40:43]
  v_mfma_f32_16x16x32_bf16 v[44:47], v[160:163], v[112:115], v[44:47]
  s_waitcnt lgkmcnt(8)
  v_mfma_f32_16x16x32_bf16 v[40:43], v[164:167], v[164:167], v[40:43]
  v_mfma_f32_16x16x32_bf16 v[44:47], v[164:167], v[112:115], v[44:47]
  s_waitcnt lgkmcnt(7)
  v_mfma_f32_16x16x32_bf16 v[40:43], v[168:171], v[168:171], v[40:43]
  v_mfma_f32_16x16x32_bf16 v[44:47], v[168:171], v[112:115], v[44:47]
  s_waitcnt lgkmcnt(6)
  v_mfma_f32_16x16x32_bf16 v[40:43], v[172:175], v[172:175], v[40:43]
  v_mfma_f32_16x16x32_bf16 v[44:47], v[172:175], v[112:115], v[44:47]
  s_waitcnt lgkmcnt(5)
  v_mfma_f32_16x16x32_bf16 v[40:43], v[176:179], v[176:179], v[40:43]
  v_mfma_f32_16x16x32_bf16 v[44:47], v[176:179], v[112:115], v[44:47]
  s_waitcnt lgkmcnt(4)
  v_mfma_f32_16x16x32_bf16 v[40:43], v[180:183], v[180:183], v[40:43]
  v_mfma_f32_16x16x32_bf16 v[44:47], v[180:183], v[112:115], v[44:47]
  s_waitcnt lgkmcnt(3)
  v_mfma_f32_16x16x32_bf16 v[40:43], v[184:187], v[184:187], v[40:43]
  v_mfma_f32_16x16x32_bf16 v[44:47], v[184:187], v[112:115], v[44:47]
  s_waitcnt lgkmcnt(2)
  v_mfma_f32_16x16x32_bf16 v[40:43], v[188:191], v[188:191], v[40:43]
  v_mfma_f32_16x16x32_bf16 v[44:47], v[188:191], v[112:115], v[44:47]
  s_waitcnt lgkmcnt(1)
  v_mfma_f32_16x16x32_bf16 v[40:43], v[192:195], v[192:195], v[40:43]
  v_mfma_f32_16x16x32_bf16 v[44:47], v[192:195], v[112:115], v[44:47]
  s_waitcnt lgkmcnt(0)
  v_mfma_f32_16x16x32_bf16 v[40:43], v[196:199], v[196:199], v[40:43]
  v_mfma_f32_16x16x32_bf16 v[44:47], v[196:199], v[112:115], v[44:47]
  v_and_b32 v14, 3, v12
  v_cmp_eq_u32 s[60:61], 1, v14
  v_cmp_eq_u32 s[62:63], 2, v14
  v_cmp_eq_u32 s[64:65], 3, v14
  s_nop 2
  v_cndmask_b32 v40, v40, v41, s[60:61]
  v_cndmask_b32 v40, v40, v42, s[62:63]
  v_cndmask_b32 v40, v40, v43, s[64:65]
  v_cndmask_b32 v44, v44, v45, s[60:61]
  v_cndmask_b32 v44, v44, v46, s[62:63]
  v_cndmask_b32 v44, v44, v47, s[64:65]
  v_mul_f32 v44, 0x3acccccd, v44
  v_mul_f32 v40, 0x3acccccd, v40
  v_fma_f32 v40, -v44, v44, v40
  v_max_f32 v40, 0, v40
  v_cvt_pk_bf16_f32 v40, v40, v40
  v_lshlrev_b32 v40, 16, v40
  v_add_f32 v40, 0x3727c5ac, v40
  v_cvt_pk_bf16_f32 v40, v40, v40
  v_lshlrev_b32 v40, 16, v40
  v_sqrt_f32 v40, v40
  s_nop 0
  v_cvt_pk_bf16_f32 v40, v40, v40
  v_lshlrev_b32 v40, 16, v40
  v_rcp_f32 v40, v40
  v_cvt_pk_bf16_f32 v44, -v44, -v44
  v_add_u32 v15, s58, v12
  v_lshrrev_b32 v14, 2, v12
  v_cmp_eq_u32 vcc, v14, v13
  v_lshlrev_b32 v16, 2, v15
  v_lshlrev_b32 v17, 1, v15
  s_and_saveexec_b64 s[60:61], vcc
  v_add_u32 v16, 81920, v16
  v_add_u32 v17, 82176, v17
  ds_write_b32 v16, v40
  ds_write_b16 v17, v44
  s_mov_b64 exec, s[60:61]
  s_waitcnt lgkmcnt(0)
  s_barrier
  v_lshlrev_b32 v14, 5, v13
  v_add_u32 v14, 81920, v14
  v_lshlrev_b32 v15, 4, v13
  v_add_u32 v15, 82176, v15
  ds_read_b128 v[48:51], v14 offset:0
  ds_read_b128 v[52:55], v14 offset:16
  ds_read_b128 v[64:67], v15 offset:0
  ds_read_b128 v[56:59], v14 offset:128
  ds_read_b128 v[60:63], v14 offset:144
  ds_read_b128 v[68:71], v15 offset:64
  v_lshrrev_b32 v16, 2, v12
  v_and_b32 v17, 3, v12
  v_lshl_add_u32 v18, v13, 3, v16
  v_mul_u32_u24 v18, 1280, v18
  v_and_b32 v19, 1, v13
  v_lshl_or_b32 v19, v19, 2, v16
  v_lshl_add_u32 v18, v19, 5, v18
  v_lshl_add_u32 v72, v17, 3, v18
  s_waitcnt lgkmcnt(0)
  v_pk_mul_f32 v[48:49], v[48:49], v[20:21]
  v_pk_mul_f32 v[50:51], v[50:51], v[22:23]
  v_pk_mul_f32 v[52:53], v[52:53], v[24:25]
  v_pk_mul_f32 v[54:55], v[54:55], v[26:27]
  v_pk_mul_f32 v[56:57], v[56:57], v[28:29]
  v_pk_mul_f32 v[58:59], v[58:59], v[30:31]
  v_pk_mul_f32 v[60:61], v[60:61], v[32:33]
  v_pk_mul_f32 v[62:63], v[62:63], v[34:35]
  v_cvt_pk_bf16_f32 v76, v48, v49
  v_cvt_pk_bf16_f32 v77, v50, v51
  v_cvt_pk_bf16_f32 v78, v52, v53
  v_cvt_pk_bf16_f32 v79, v54, v55
  v_cvt_pk_bf16_f32 v80, v56, v57
  v_cvt_pk_bf16_f32 v81, v58, v59
  v_cvt_pk_bf16_f32 v82, v60, v61
  v_cvt_pk_bf16_f32 v83, v62, v63
  v_mfma_f32_16x16x32_bf16 v[84:87], v[64:67], v[76:79], 0
  s_nop 0
  v_mfma_f32_16x16x32_bf16 v[84:87], v[68:71], v[80:83], v[84:87]
  s_mul_i32 s59, s55, 10
  s_add_u32 s60, s59, 0
  s_and_b32 s61, s60, 7
  s_lshl_b32 s61, s61, 5
  s_lshr_b32 s62, s60, 3
  s_lshl_b32 s62, s62, 8
  v_xor_b32 v73, s61, v72
  v_add_u32 v73, s62, v73
  ds_read_b64_tr_b16 v[120:121], v73 offset:0
  ds_read_b64_tr_b16 v[122:123], v73 offset:5120
  ds_read_b64_tr_b16 v[124:125], v73 offset:40960
  ds_read_b64_tr_b16 v[126:127], v73 offset:46080
  s_add_u32 s60, s59, 1
  s_and_b32 s61, s60, 7
  s_lshl_b32 s61, s61, 5
  s_lshr_b32 s62, s60, 3
  s_lshl_b32 s62, s62, 8
  v_xor_b32 v73, s61, v72
  v_add_u32 v73, s62, v73
  ds_read_b64_tr_b16 v[128:129], v73 offset:0
  ds_read_b64_tr_b16 v[130:131], v73 offset:5120
  ds_read_b64_tr_b16 v[132:133], v73 offset:40960
  ds_read_b64_tr_b16 v[134:135], v73 offset:46080
  s_add_u32 s60, s59, 2
  s_and_b32 s61, s60, 7
  s_lshl_b32 s61, s61, 5
  s_lshr_b32 s62, s60, 3
  s_lshl_b32 s62, s62, 8
  v_xor_b32 v73, s61, v72
  v_add_u32 v73, s62, v73
  ds_read_b64_tr_b16 v[136:137], v73 offset:0
  ds_read_b64_tr_b16 v[138:139], v73 offset:5120
  ds_read_b64_tr_b16 v[140:141], v73 offset:40960
  ds_read_b64_tr_b16 v[142:143], v73 offset:46080
  s_waitcnt lgkmcnt(8)
  v_mfma_f32_16x16x32_bf16 v[200:203], v[120:123], v[76:79], v[84:87]
  v_mfma_f32_16x16x32_bf16 v[200:203], v[124:127], v[80:83], v[200:203]
  s_add_u32 s60, s59, 3
  s_and_b32 s61, s60, 7
  s_lshl_b32 s61, s61, 5
  s_lshr_b32 s62, s60, 3
  s_lshl_b32 s62, s62, 8
  v_xor_b32 v73, s61, v72
  v_add_u32 v73, s62, v73
  ds_read_b64_tr_b16 v[144:145], v73 offset:0
  ds_read_b64_tr_b16 v[146:147], v73 offset:5120
  ds_read_b64_tr_b16 v[148:149], v73 offset:40960
  ds_read_b64_tr_b16 v[150:151], v73 offset:46080
  s_waitcnt lgkmcnt(8)
  v_mfma_f32_16x16x32_bf16 v[204:207], v[128:131], v[76:79], v[84:87]
  v_mfma_f32_16x16x32_bf16 v[204:207], v[132:135], v[80:83], v[204:207]
  s_add_u32 s60, s59, 4
  s_and_b32 s61, s60, 7
  s_lshl_b32 s61, s61, 5
  s_lshr_b32 s62, s60, 3
  s_lshl_b32 s62, s62, 8
  v_xor_b32 v73, s61, v72
  v_add_u32 v73, s62, v73
  ds_read_b64_tr_b16 v[152:153], v73 offset:0
  ds_read_b64_tr_b16 v[154:155], v73 offset:5120
  ds_read_b64_tr_b16 v[156:157], v73 offset:40960
  ds_read_b64_tr_b16 v[158:159], v73 offset:46080
  s_waitcnt lgkmcnt(8)
  v_mfma_f32_16x16x32_bf16 v[208:211], v[136:139], v[76:79], v[84:87]
  v_mfma_f32_16x16x32_bf16 v[208:211], v[140:143], v[80:83], v[208:211]
  s_add_u32 s60, s59, 5
  s_and_b32 s61, s60, 7
  s_lshl_b32 s61, s61, 5
  s_lshr_b32 s62, s60, 3
  s_lshl_b32 s62, s62, 8
  v_xor_b32 v73, s61, v72
  v_add_u32 v73, s62, v73
  ds_read_b64_tr_b16 v[160:161], v73 offset:0
  ds_read_b64_tr_b16 v[162:163], v73 offset:5120
  ds_read_b64_tr_b16 v[164:165], v73 offset:40960
  ds_read_b64_tr_b16 v[166:167], v73 offset:46080
  s_waitcnt lgkmcnt(8)
  v_mfma_f32_16x16x32_bf16 v[212:215], v[144:147], v[76:79], v[84:87]
  v_mfma_f32_16x16x32_bf16 v[212:215], v[148:151], v[80:83], v[212:215]
  s_add_u32 s60, s59, 6
  s_and_b32 s61, s60, 7
  s_lshl_b32 s61, s61, 5
  s_lshr_b32 s62, s60, 3
  s_lshl_b32 s62, s62, 8
  v_xor_b32 v73, s61, v72
  v_add_u32 v73, s62, v73
  ds_read_b64_tr_b16 v[168:169], v73 offset:0
  ds_read_b64_tr_b16 v[170:171], v73 offset:5120
  ds_read_b64_tr_b16 v[172:173], v73 offset:40960
  ds_read_b64_tr_b16 v[174:175], v73 offset:46080
  s_waitcnt lgkmcnt(8)
  v_mfma_f32_16x16x32_bf16 v[216:219], v[152:155], v[76:79], v[84:87]
  v_mfma_f32_16x16x32_bf16 v[216:219], v[156:159], v[80:83], v[216:219]
  s_add_u32 s60, s59, 7
  s_and_b32 s61, s60, 7
  s_lshl_b32 s61, s61, 5
  s_lshr_b32 s62, s60, 3
  s_lshl_b32 s62, s62, 8
  v_xor_b32 v73, s61, v72
  v_add_u32 v73, s62, v73
  ds_read_b64_tr_b16 v[176:177], v73 offset:0
  ds_read_b64_tr_b16 v[178:179], v73 offset:5120
  ds_read_b64_tr_b16 v[180:181], v73 offset:40960
  ds_read_b64_tr_b16 v[182:183], v73 offset:46080
  s_waitcnt lgkmcnt(8)
  v_mfma_f32_16x16x32_bf16 v[220:223], v[160:163], v[76:79], v[84:87]
  v_mfma_f32_16x16x32_bf16 v[220:223], v[164:167], v[80:83], v[220:223]
  s_add_u32 s60, s59, 8
  s_and_b32 s61, s60, 7
  s_lshl_b32 s61, s61, 5
  s_lshr_b32 s62, s60, 3
  s_lshl_b32 s62, s62, 8
  v_xor_b32 v73, s61, v72
  v_add_u32 v73, s62, v73
  ds_read_b64_tr_b16 v[184:185], v73 offset:0
  ds_read_b64_tr_b16 v[186:187], v73 offset:5120
  ds_read_b64_tr_b16 v[188:189], v73 offset:40960
  ds_read_b64_tr_b16 v[190:191], v73 offset:46080
  s_waitcnt lgkmcnt(8)
  v_mfma_f32_16x16x32_bf16 v[224:227], v[168:171], v[76:79], v[84:87]
  v_mfma_f32_16x16x32_bf16 v[224:227], v[172:175], v[80:83], v[224:227]
  s_add_u32 s60, s59, 9
  s_and_b32 s61, s60, 7
  s_lshl_b32 s61, s61, 5
  s_lshr_b32 s62, s60, 3
  s_lshl_b32 s62, s62, 8
  v_xor_b32 v73, s61, v72
  v_add_u32 v73, s62, v73
  ds_read_b64_tr_b16 v[192:193], v73 offset:0
  ds_read_b64_tr_b16 v[194:195], v73 offset:5120
  ds_read_b64_tr_b16 v[196:197], v73 offset:40960
  ds_read_b64_tr_b16 v[198:199], v73 offset:46080
  s_waitcnt lgkmcnt(8)
  v_mfma_f32_16x16x32_bf16 v[228:231], v[176:179], v[76:79], v[84:87]
  v_mfma_f32_16x16x32_bf16 v[228:231], v[180:183], v[80:83], v[228:231]
  s_waitcnt lgkmcnt(4)
  v_mfma_f32_16x16x32_bf16 v[232:235], v[184:187], v[76:79], v[84:87]
  v_mfma_f32_16x16x32_bf16 v[232:235], v[188:191], v[80:83], v[232:235]
  s_waitcnt lgkmcnt(0)
  v_mfma_f32_16x16x32_bf16 v[236:239], v[192:195], v[76:79], v[84:87]
  v_mfma_f32_16x16x32_bf16 v[236:239], v[196:199], v[80:83], v[236:239]
  s_lshr_b32 s60, s54, 2
  s_and_b32 s60, s60, 3
  s_lshr_b32 s61, s60, 1
  s_xor_b32 s62, s60, s61
  s_and_b32 s62, s62, 1
  s_lshl_b32 s62, s62, 1
  s_or_b32 s61, s61, s62
  v_xor_b32 v14, s61, v13
  v_add_u32 v15, s58, v12
  v_mul_u32_u24 v15, 0xa000, v15
  v_lshl_add_u32 v15, v14, 4, v15
  s_mul_i32 s60, s55, 5
  s_lshl_b32 s60, s60, 11
  s_lshl_b32 s61, s54, 6
  s_add_u32 s60, s60, s61
  v_cvt_pk_bf16_f32 v88, v200, v201
  v_cvt_pk_bf16_f32 v89, v202, v203
  v_cvt_pk_bf16_f32 v90, v204, v205
  v_cvt_pk_bf16_f32 v91, v206, v207
  buffer_store_dwordx4 v[88:91], v15, s[44:47], s60 offen sc1
  s_add_u32 s60, s60, 2048
  v_cvt_pk_bf16_f32 v92, v208, v209
  v_cvt_pk_bf16_f32 v93, v210, v211
  v_cvt_pk_bf16_f32 v94, v212, v213
  v_cvt_pk_bf16_f32 v95, v214, v215
  buffer_store_dwordx4 v[92:95], v15, s[44:47], s60 offen sc1
  s_add_u32 s60, s60, 2048
  v_cvt_pk_bf16_f32 v96, v216, v217
  v_cvt_pk_bf16_f32 v97, v218, v219
  v_cvt_pk_bf16_f32 v98, v220, v221
  v_cvt_pk_bf16_f32 v99, v222, v223
  buffer_store_dwordx4 v[96:99], v15, s[44:47], s60 offen sc1
  s_add_u32 s60, s60, 2048
  v_cvt_pk_bf16_f32 v100, v224, v225
  v_cvt_pk_bf16_f32 v101, v226, v227
  v_cvt_pk_bf16_f32 v102, v228, v229
  v_cvt_pk_bf16_f32 v103, v230, v231
  buffer_store_dwordx4 v[100:103], v15, s[44:47], s60 offen sc1
  s_add_u32 s60, s60, 2048
  v_cvt_pk_bf16_f32 v104, v232, v233
  v_cvt_pk_bf16_f32 v105, v234, v235
  v_cvt_pk_bf16_f32 v106, v236, v237
  v_cvt_pk_bf16_f32 v107, v238, v239
  buffer_store_dwordx4 v[104:107], v15, s[44:47], s60 offen sc1
  s_branch L_arr1
L_p1_gemv:
  s_lshl_b32 s54, s96, 4
  s_add_u32 s54, s54, s95
  s_sub_u32 s54, s54, 16
  s_cmp_ge_u32 s54, 120
  s_cbranch_scc1 L_p1_idle
  s_mul_i32 s55, s54, 205
  s_lshr_b32 s55, s55, 12
  s_mul_i32 s56, s55, 20
  s_sub_u32 s56, s54, s56
  v_and_b32 v2, 3, v1
  v_lshrrev_b32 v3, 2, v1
  s_mul_i32 s57, s3, 160
  v_add_u32 v4, s57, v3
  v_mul_u32_u24 v5, 7680, v4
  v_lshl_add_u32 v5, v2, 4, v5
  v_lshlrev_b32 v6, 1, v4
  s_lshl_b32 s58, s54, 6
  s_waitcnt lgkmcnt(0)
  s_mov_b32 s32, s80
  s_mov_b32 s33, s81
  s_mov_b32 s34, 0x4b0000
  s_mov_b32 s35, 0x00020000
  s_mov_b32 s28, s78
  s_mov_b32 s29, s79
  s_mov_b32 s30, 0x500
  s_mov_b32 s31, 0x00020000
  buffer_load_dwordx4 v[20:23], v5, s[32:35], s58 offen
  s_add_u32 s58, s58, 122880
  buffer_load_dwordx4 v[24:27], v5, s[32:35], s58 offen
  s_add_u32 s58, s58, 122880
  buffer_load_dwordx4 v[28:31], v5, s[32:35], s58 offen
  s_add_u32 s58, s58, 122880
  buffer_load_dwordx4 v[32:35], v5, s[32:35], s58 offen
  s_add_u32 s58, s58, 122880
  buffer_load_dwordx4 v[36:39], v5, s[32:35], s58 offen
  s_add_u32 s58, s58, 122880
  buffer_load_dwordx4 v[40:43], v5, s[32:35], s58 offen
  s_add_u32 s58, s58, 122880
  buffer_load_dwordx4 v[44:47], v5, s[32:35], s58 offen
  s_add_u32 s58, s58, 122880
  buffer_load_dwordx4 v[48:51], v5, s[32:35], s58 offen
  s_add_u32 s58, s58, 122880
  buffer_load_dwordx4 v[52:55], v5, s[32:35], s58 offen
  s_add_u32 s58, s58, 122880
  buffer_load_dwordx4 v[56:59], v5, s[32:35], s58 offen
  buffer_load_ushort v10, v6, s[28:31], 0 offen offset:0
  buffer_load_ushort v11, v6, s[28:31], 0 offen offset:32
  buffer_load_ushort v12, v6, s[28:31], 0 offen offset:64
  buffer_load_ushort v13, v6, s[28:31], 0 offen offset:96
  buffer_load_ushort v14, v6, s[28:31], 0 offen offset:128
  buffer_load_ushort v15, v6, s[28:31], 0 offen offset:160
  buffer_load_ushort v16, v6, s[28:31], 0 offen offset:192
  buffer_load_ushort v17, v6, s[28:31], 0 offen offset:224
  buffer_load_ushort v18, v6, s[28:31], 0 offen offset:256
  buffer_load_ushort v19, v6, s[28:31], 0 offen offset:288
  s_mov_b32 s4, s64
  s_mov_b32 s5, s65
  s_mov_b32 s6, 0x280000
  s_mov_b32 s7, 0x00020000
  s_mov_b32 s8, s66
  s_mov_b32 s9, s67
  s_mov_b32 s10, 0x141000
  s_mov_b32 s11, 0x00020000
  s_mov_b32 s12, s68
  s_mov_b32 s13, s69
  s_mov_b32 s14, 0x141000
  s_mov_b32 s15, 0x00020000
  s_mov_b32 s16, s72
  s_mov_b32 s17, s73
  s_mov_b32 s18, 0x21c000
  s_mov_b32 s19, 0x00020000
  s_mov_b32 s20, s74
  s_mov_b32 s21, s75
  s_mov_b32 s22, 0x21c000
  s_mov_b32 s23, 0x00020000
  s_mov_b32 s24, s76
  s_mov_b32 s25, s77
  s_mov_b32 s26, 0x21c000
  s_mov_b32 s27, 0x00020000
  s_mov_b32 s36, s82
  s_mov_b32 s37, s83
  s_mov_b32 s38, 0x280000
  s_mov_b32 s39, 0x00020000
  s_mov_b32 s40, s84
  s_mov_b32 s41, s85
  s_mov_b32 s42, 0x100
  s_mov_b32 s43, 0x00020000
  s_mov_b32 s44, s86
  s_mov_b32 s45, s87
  s_mov_b32 s46, 0x1c80000
  s_mov_b32 s47, 0x00020000
  s_cmp_le_u32 s55, 1
  s_cbranch_scc0 L_gv_notrig
  v_and_b32 v7, 15, v1
  v_lshrrev_b32 v8, 4, v1
  s_lshl_b32 s57, s3, 4
  v_add_u32 v7, s57, v7
  s_lshl_b32 s57, s56, 5
  v_lshl_add_u32 v8, v8, 2, s57
  v_add_u32 v60, 0, v8
  v_mul_u32_u24 v61, v7, v60
  v_lshrrev_b32 v62, 7, v61
  v_mul_u32_u24 v62, 0xcccd, v62
  v_lshrrev_b32 v62, 18, v62
  v_mul_u32_u24 v62, 640, v62
  v_sub_u32 v61, v61, v62
  v_cvt_f32_u32 v62, v61
  v_mul_f32 v62, 0x3acccccd, v62
  v_cos_f32 v100, v62
  v_sin_f32 v101, v62
  v_lshlrev_b32 v61, 6, v60
  v_lshrrev_b32 v62, 7, v61
  v_mul_u32_u24 v62, 0xcccd, v62
  v_lshrrev_b32 v62, 18, v62
  v_mul_u32_u24 v62, 640, v62
  v_sub_u32 v61, v61, v62
  v_cvt_f32_u32 v62, v61
  v_mul_f32 v62, 0x3acccccd, v62
  v_cos_f32 v68, v62
  v_sin_f32 v69, v62
  v_add_u32 v60, 1, v8
  v_mul_u32_u24 v61, v7, v60
  v_lshrrev_b32 v62, 7, v61
  v_mul_u32_u24 v62, 0xcccd, v62
  v_lshrrev_b32 v62, 18, v62
  v_mul_u32_u24 v62, 640, v62
  v_sub_u32 v61, v61, v62
  v_cvt_f32_u32 v62, v61
  v_mul_f32 v62, 0x3acccccd, v62
  v_cos_f32 v102, v62
  v_sin_f32 v103, v62
  v_lshlrev_b32 v61, 6, v60
  v_lshrrev_b32 v62, 7, v61
  v_mul_u32_u24 v62, 0xcccd, v62
  v_lshrrev_b32 v62, 18, v62
  v_mul_u32_u24 v62, 640, v62
  v_sub_u32 v61, v61, v62
  v_cvt_f32_u32 v62, v61
  v_mul_f32 v62, 0x3acccccd, v62
  v_cos_f32 v70, v62
  v_sin_f32 v71, v62
  v_add_u32 v60, 2, v8
  v_mul_u32_u24 v61, v7, v60
  v_lshrrev_b32 v62, 7, v61
  v_mul_u32_u24 v62, 0xcccd, v62
  v_lshrrev_b32 v62, 18, v62
  v_mul_u32_u24 v62, 640, v62
  v_sub_u32 v61, v61, v62
  v_cvt_f32_u32 v62, v61
  v_mul_f32 v62, 0x3acccccd, v62
  v_cos_f32 v104, v62
  v_sin_f32 v105, v62
  v_lshlrev_b32 v61, 6, v60
  v_lshrrev_b32 v62, 7, v61
  v_mul_u32_u24 v62, 0xcccd, v62
  v_lshrrev_b32 v62, 18, v62
  v_mul_u32_u24 v62, 640, v62
  v_sub_u32 v61, v61, v62
  v_cvt_f32_u32 v62, v61
  v_mul_f32 v62, 0x3acccccd, v62
  v_cos_f32 v72, v62
  v_sin_f32 v73, v62
  v_add_u32 v60, 3, v8
  v_mul_u32_u24 v61, v7, v60
  v_lshrrev_b32 v62, 7, v61
  v_mul_u32_u24 v62, 0xcccd, v62
  v_lshrrev_b32 v62, 18, v62
  v_mul_u32_u24 v62, 640, v62
  v_sub_u32 v61, v61, v62
  v_cvt_f32_u32 v62, v61
  v_mul_f32 v62, 0x3acccccd, v62
  v_cos_f32 v106, v62
  v_sin_f32 v107, v62
  v_lshlrev_b32 v61, 6, v60
  v_lshrrev_b32 v62, 7, v61
  v_mul_u32_u24 v62, 0xcccd, v62
  v_lshrrev_b32 v62, 18, v62
  v_mul_u32_u24 v62, 640, v62
  v_sub_u32 v61, v61, v62
  v_cvt_f32_u32 v62, v61
  v_mul_f32 v62, 0x3acccccd, v62
  v_cos_f32 v74, v62
  v_sin_f32 v75, v62
  v_add_u32 v60, 16, v8
  v_mul_u32_u24 v61, v7, v60
  v_lshrrev_b32 v62, 7, v61
  v_mul_u32_u24 v62, 0xcccd, v62
  v_lshrrev_b32 v62, 18, v62
  v_mul_u32_u24 v62, 640, v62
  v_sub_u32 v61, v61, v62
  v_cvt_f32_u32 v62, v61
  v_mul_f32 v62, 0x3acccccd, v62
  v_cos_f32 v108, v62
  v_sin_f32 v109, v62
  v_lshlrev_b32 v61, 6, v60
  v_lshrrev_b32 v62, 7, v61
  v_mul_u32_u24 v62, 0xcccd, v62
  v_lshrrev_b32 v62, 18, v62
  v_mul_u32_u24 v62, 640, v62
  v_sub_u32 v61, v61, v62
  v_cvt_f32_u32 v62, v61
  v_mul_f32 v62, 0x3acccccd, v62
  v_cos_f32 v76, v62
  v_sin_f32 v77, v62
  v_add_u32 v60, 17, v8
  v_mul_u32_u24 v61, v7, v60
  v_lshrrev_b32 v62, 7, v61
  v_mul_u32_u24 v62, 0xcccd, v62
  v_lshrrev_b32 v62, 18, v62
  v_mul_u32_u24 v62, 640, v62
  v_sub_u32 v61, v61, v62
  v_cvt_f32_u32 v62, v61
  v_mul_f32 v62, 0x3acccccd, v62
  v_cos_f32 v110, v62
  v_sin_f32 v111, v62
  v_lshlrev_b32 v61, 6, v60
  v_lshrrev_b32 v62, 7, v61
  v_mul_u32_u24 v62, 0xcccd, v62
  v_lshrrev_b32 v62, 18, v62
  v_mul_u32_u24 v62, 640, v62
  v_sub_u32 v61, v61, v62
  v_cvt_f32_u32 v62, v61
  v_mul_f32 v62, 0x3acccccd, v62
  v_cos_f32 v78, v62
  v_sin_f32 v79, v62
  v_add_u32 v60, 18, v8
  v_mul_u32_u24 v61, v7, v60
  v_lshrrev_b32 v62, 7, v61
  v_mul_u32_u24 v62, 0xcccd, v62
  v_lshrrev_b32 v62, 18, v62
  v_mul_u32_u24 v62, 640, v62
  v_sub_u32 v61, v61, v62
  v_cvt_f32_u32 v62, v61
  v_mul_f32 v62, 0x3acccccd, v62
  v_cos_f32 v112, v62
  v_sin_f32 v113, v62
  v_lshlrev_b32 v61, 6, v60
  v_lshrrev_b32 v62, 7, v61
  v_mul_u32_u24 v62, 0xcccd, v62
  v_lshrrev_b32 v62, 18, v62
  v_mul_u32_u24 v62, 640, v62
  v_sub_u32 v61, v61, v62
  v_cvt_f32_u32 v62, v61
  v_mul_f32 v62, 0x3acccccd, v62
  v_cos_f32 v80, v62
  v_sin_f32 v81, v62
  v_add_u32 v60, 19, v8
  v_mul_u32_u24 v61, v7, v60
  v_lshrrev_b32 v62, 7, v61
  v_mul_u32_u24 v62, 0xcccd, v62
  v_lshrrev_b32 v62, 18, v62
  v_mul_u32_u24 v62, 640, v62
  v_sub_u32 v61, v61, v62
  v_cvt_f32_u32 v62, v61
  v_mul_f32 v62, 0x3acccccd, v62
  v_cos_f32 v114, v62
  v_sin_f32 v115, v62
  v_lshlrev_b32 v61, 6, v60
  v_lshrrev_b32 v62, 7, v61
  v_mul_u32_u24 v62, 0xcccd, v62
  v_lshrrev_b32 v62, 18, v62
  v_mul_u32_u24 v62, 640, v62
  v_sub_u32 v61, v61, v62
  v_cvt_f32_u32 v62, v61
  v_mul_f32 v62, 0x3acccccd, v62
  v_cos_f32 v82, v62
  v_sin_f32 v83, v62
  v_pk_mul_f32 v[116:117], v[100:101], v[68:69] op_sel:[0,0] op_sel_hi:[1,0]
  v_pk_fma_f32 v[116:117], v[100:101], v[68:69], v[116:117] op_sel:[1,1,0] op_sel_hi:[0,1,1] neg_lo:[0,1,0]
  v_pk_mul_f32 v[118:119], v[102:103], v[70:71] op_sel:[0,0] op_sel_hi:[1,0]
  v_pk_fma_f32 v[118:119], v[102:103], v[70:71], v[118:119] op_sel:[1,1,0] op_sel_hi:[0,1,1] neg_lo:[0,1,0]
  v_pk_mul_f32 v[120:121], v[104:105], v[72:73] op_sel:[0,0] op_sel_hi:[1,0]
  v_pk_fma_f32 v[120:121], v[104:105], v[72:73], v[120:121] op_sel:[1,1,0] op_sel_hi:[0,1,1] neg_lo:[0,1,0]
  v_pk_mul_f32 v[122:123], v[106:107], v[74:75] op_sel:[0,0] op_sel_hi:[1,0]
  v_pk_fma_f32 v[122:123], v[106:107], v[74:75], v[122:123] op_sel:[1,1,0] op_sel_hi:[0,1,1] neg_lo:[0,1,0]
  v_pk_mul_f32 v[124:125], v[108:109], v[76:77] op_sel:[0,0] op_sel_hi:[1,0]
  v_pk_fma_f32 v[124:125], v[108:109], v[76:77], v[124:125] op_sel:[1,1,0] op_sel_hi:[0,1,1] neg_lo:[0,1,0]
  v_pk_mul_f32 v[126:127], v[110:111], v[78:79] op_sel:[0,0] op_sel_hi:[1,0]
  v_pk_fma_f32 v[126:127], v[110:111], v[78:79], v[126:127] op_sel:[1,1,0] op_sel_hi:[0,1,1] neg_lo:[0,1,0]
  v_pk_mul_f32 v[128:129], v[112:113], v[80:81] op_sel:[0,0] op_sel_hi:[1,0]
  v_pk_fma_f32 v[128:129], v[112:113], v[80:81], v[128:129] op_sel:[1,1,0] op_sel_hi:[0,1,1] neg_lo:[0,1,0]
  v_pk_mul_f32 v[130:131], v[114:115], v[82:83] op_sel:[0,0] op_sel_hi:[1,0]
  v_pk_fma_f32 v[130:131], v[114:115], v[82:83], v[130:131] op_sel:[1,1,0] op_sel_hi:[0,1,1] neg_lo:[0,1,0]
  v_pk_mul_f32 v[132:133], v[116:117], v[68:69] op_sel:[0,0] op_sel_hi:[1,0]
  v_pk_fma_f32 v[132:133], v[116:117], v[68:69], v[132:133] op_sel:[1,1,0] op_sel_hi:[0,1,1] neg_lo:[0,1,0]
  v_pk_mul_f32 v[134:135], v[118:119], v[70:71] op_sel:[0,0] op_sel_hi:[1,0]
  v_pk_fma_f32 v[134:135], v[118:119], v[70:71], v[134:135] op_sel:[1,1,0] op_sel_hi:[0,1,1] neg_lo:[0,1,0]
  v_pk_mul_f32 v[136:137], v[120:121], v[72:73] op_sel:[0,0] op_sel_hi:[1,0]
  v_pk_fma_f32 v[136:137], v[120:121], v[72:73], v[136:137] op_sel:[1,1,0] op_sel_hi:[0,1,1] neg_lo:[0,1,0]
  v_pk_mul_f32 v[138:139], v[122:123], v[74:75] op_sel:[0,0] op_sel_hi:[1,0]
  v_pk_fma_f32 v[138:139], v[122:123], v[74:75], v[138:139] op_sel:[1,1,0] op_sel_hi:[0,1,1] neg_lo:[0,1,0]
  v_pk_mul_f32 v[140:141], v[124:125], v[76:77] op_sel:[0,0] op_sel_hi:[1,0]
  v_pk_fma_f32 v[140:141], v[124:125], v[76:77], v[140:141] op_sel:[1,1,0] op_sel_hi:[0,1,1] neg_lo:[0,1,0]
  v_pk_mul_f32 v[142:143], v[126:127], v[78:79] op_sel:[0,0] op_sel_hi:[1,0]
  v_pk_fma_f32 v[142:143], v[126:127], v[78:79], v[142:143] op_sel:[1,1,0] op_sel_hi:[0,1,1] neg_lo:[0,1,0]
  v_pk_mul_f32 v[144:145], v[128:129], v[80:81] op_sel:[0,0] op_sel_hi:[1,0]
  v_pk_fma_f32 v[144:145], v[128:129], v[80:81], v[144:145] op_sel:[1,1,0] op_sel_hi:[0,1,1] neg_lo:[0,1,0]
  v_pk_mul_f32 v[146:147], v[130:131], v[82:83] op_sel:[0,0] op_sel_hi:[1,0]
  v_pk_fma_f32 v[146:147], v[130:131], v[82:83], v[146:147] op_sel:[1,1,0] op_sel_hi:[0,1,1] neg_lo:[0,1,0]
  v_pk_mul_f32 v[148:149], v[132:133], v[68:69] op_sel:[0,0] op_sel_hi:[1,0]
  v_pk_fma_f32 v[148:149], v[132:133], v[68:69], v[148:149] op_sel:[1,1,0] op_sel_hi:[0,1,1] neg_lo:[0,1,0]
  v_pk_mul_f32 v[150:151], v[134:135], v[70:71] op_sel:[0,0] op_sel_hi:[1,0]
  v_pk_fma_f32 v[150:151], v[134:135], v[70:71], v[150:151] op_sel:[1,1,0] op_sel_hi:[0,1,1] neg_lo:[0,1,0]
  v_pk_mul_f32 v[152:153], v[136:137], v[72:73] op_sel:[0,0] op_sel_hi:[1,0]
  v_pk_fma_f32 v[152:153], v[136:137], v[72:73], v[152:153] op_sel:[1,1,0] op_sel_hi:[0,1,1] neg_lo:[0,1,0]
  v_pk_mul_f32 v[154:155], v[138:139], v[74:75] op_sel:[0,0] op_sel_hi:[1,0]
  v_pk_fma_f32 v[154:155], v[138:139], v[74:75], v[154:155] op_sel:[1,1,0] op_sel_hi:[0,1,1] neg_lo:[0,1,0]
  v_pk_mul_f32 v[156:157], v[140:141], v[76:77] op_sel:[0,0] op_sel_hi:[1,0]
  v_pk_fma_f32 v[156:157], v[140:141], v[76:77], v[156:157] op_sel:[1,1,0] op_sel_hi:[0,1,1] neg_lo:[0,1,0]
  v_pk_mul_f32 v[158:159], v[142:143], v[78:79] op_sel:[0,0] op_sel_hi:[1,0]
  v_pk_fma_f32 v[158:159], v[142:143], v[78:79], v[158:159] op_sel:[1,1,0] op_sel_hi:[0,1,1] neg_lo:[0,1,0]
  v_pk_mul_f32 v[160:161], v[144:145], v[80:81] op_sel:[0,0] op_sel_hi:[1,0]
  v_pk_fma_f32 v[160:161], v[144:145], v[80:81], v[160:161] op_sel:[1,1,0] op_sel_hi:[0,1,1] neg_lo:[0,1,0]
  v_pk_mul_f32 v[162:163], v[146:147], v[82:83] op_sel:[0,0] op_sel_hi:[1,0]
  v_pk_fma_f32 v[162:163], v[146:147], v[82:83], v[162:163] op_sel:[1,1,0] op_sel_hi:[0,1,1] neg_lo:[0,1,0]
  v_pk_mul_f32 v[164:165], v[148:149], v[68:69] op_sel:[0,0] op_sel_hi:[1,0]
  v_pk_fma_f32 v[164:165], v[148:149], v[68:69], v[164:165] op_sel:[1,1,0] op_sel_hi:[0,1,1] neg_lo:[0,1,0]
  v_pk_mul_f32 v[166:167], v[150:151], v[70:71] op_sel:[0,0] op_sel_hi:[1,0]
  v_pk_fma_f32 v[166:167], v[150:151], v[70:71], v[166:167] op_sel:[1,1,0] op_sel_hi:[0,1,1] neg_lo:[0,1,0]
  v_pk_mul_f32 v[168:169], v[152:153], v[72:73] op_sel:[0,0] op_sel_hi:[1,0]
  v_pk_fma_f32 v[168:169], v[152:153], v[72:73], v[168:169] op_sel:[1,1,0] op_sel_hi:[0,1,1] neg_lo:[0,1,0]
  v_pk_mul_f32 v[170:171], v[154:155], v[74:75] op_sel:[0,0] op_sel_hi:[1,0]
  v_pk_fma_f32 v[170:171], v[154:155], v[74:75], v[170:171] op_sel:[1,1,0] op_sel_hi:[0,1,1] neg_lo:[0,1,0]
  v_pk_mul_f32 v[172:173], v[156:157], v[76:77] op_sel:[0,0] op_sel_hi:[1,0]
  v_pk_fma_f32 v[172:173], v[156:157], v[76:77], v[172:173] op_sel:[1,1,0] op_sel_hi:[0,1,1] neg_lo:[0,1,0]
  v_pk_mul_f32 v[174:175], v[158:159], v[78:79] op_sel:[0,0] op_sel_hi:[1,0]
  v_pk_fma_f32 v[174:175], v[158:159], v[78:79], v[174:175] op_sel:[1,1,0] op_sel_hi:[0,1,1] neg_lo:[0,1,0]
  v_pk_mul_f32 v[176:177], v[160:161], v[80:81] op_sel:[0,0] op_sel_hi:[1,0]
  v_pk_fma_f32 v[176:177], v[160:161], v[80:81], v[176:177] op_sel:[1,1,0] op_sel_hi:[0,1,1] neg_lo:[0,1,0]
  v_pk_mul_f32 v[178:179], v[162:163], v[82:83] op_sel:[0,0] op_sel_hi:[1,0]
  v_pk_fma_f32 v[178:179], v[162:163], v[82:83], v[178:179] op_sel:[1,1,0] op_sel_hi:[0,1,1] neg_lo:[0,1,0]
  v_pk_mul_f32 v[180:181], v[164:165], v[68:69] op_sel:[0,0] op_sel_hi:[1,0]
  v_pk_fma_f32 v[180:181], v[164:165], v[68:69], v[180:181] op_sel:[1,1,0] op_sel_hi:[0,1,1] neg_lo:[0,1,0]
  v_pk_mul_f32 v[182:183], v[166:167], v[70:71] op_sel:[0,0] op_sel_hi:[1,0]
  v_pk_fma_f32 v[182:183], v[166:167], v[70:71], v[182:183] op_sel:[1,1,0] op_sel_hi:[0,1,1] neg_lo:[0,1,0]
  v_pk_mul_f32 v[184:185], v[168:169], v[72:73] op_sel:[0,0] op_sel_hi:[1,0]
  v_pk_fma_f32 v[184:185], v[168:169], v[72:73], v[184:185] op_sel:[1,1,0] op_sel_hi:[0,1,1] neg_lo:[0,1,0]
  v_pk_mul_f32 v[186:187], v[170:171], v[74:75] op_sel:[0,0] op_sel_hi:[1,0]
  v_pk_fma_f32 v[186:187], v[170:171], v[74:75], v[186:187] op_sel:[1,1,0] op_sel_hi:[0,1,1] neg_lo:[0,1,0]
  v_pk_mul_f32 v[188:189], v[172:173], v[76:77] op_sel:[0,0] op_sel_hi:[1,0]
  v_pk_fma_f32 v[188:189], v[172:173], v[76:77], v[188:189] op_sel:[1,1,0] op_sel_hi:[0,1,1] neg_lo:[0,1,0]
  v_pk_mul_f32 v[190:191], v[174:175], v[78:79] op_sel:[0,0] op_sel_hi:[1,0]
  v_pk_fma_f32 v[190:191], v[174:175], v[78:79], v[190:191] op_sel:[1,1,0] op_sel_hi:[0,1,1] neg_lo:[0,1,0]
  v_pk_mul_f32 v[192:193], v[176:177], v[80:81] op_sel:[0,0] op_sel_hi:[1,0]
  v_pk_fma_f32 v[192:193], v[176:177], v[80:81], v[192:193] op_sel:[1,1,0] op_sel_hi:[0,1,1] neg_lo:[0,1,0]
  v_pk_mul_f32 v[194:195], v[178:179], v[82:83] op_sel:[0,0] op_sel_hi:[1,0]
  v_pk_fma_f32 v[194:195], v[178:179], v[82:83], v[194:195] op_sel:[1,1,0] op_sel_hi:[0,1,1] neg_lo:[0,1,0]
  s_branch L_gv_pre_done0
L_gv_notrig:
  s_cmp_eq_u32 s55, 2
  s_cbranch_scc0 L_gv_pre_done0
  s_and_b32 s57, s3, 1
  s_lshl_b32 s58, s56, 1
  s_add_u32 s57, s57, s58
  s_mul_i32 s58, s57, 52
  s_lshr_b32 s58, s58, 8
  s_mul_i32 s59, s58, 5
  s_sub_u32 s59, s57, s59
  s_lshr_b32 s60, s3, 1
  s_mul_i32 s58, s58, 21
  s_add_u32 s58, s58, s60
  s_mul_i32 s58, s58, 5120
  s_lshl_b32 s59, s59, 10
  s_add_u32 s58, s58, s59
  s_add_u32 s58, s58, 0x360000
  v_and_b32 v7, 15, v1
  v_lshrrev_b32 v8, 4, v1
  s_lshl_b32 s57, s57, 4
  v_add_u32 v7, s57, v7
  s_lshl_b32 s60, s60, 4
  v_lshl_add_u32 v8, v8, 2, s60
  v_add_u32 v60, 0, v8
  v_mul_u32_u24 v61, v7, v60
  v_lshrrev_b32 v62, 7, v61
  v_mul_u32_u24 v62, 0xcccd, v62
  v_lshrrev_b32 v62, 18, v62
  v_mul_u32_u24 v62, 640, v62
  v_sub_u32 v61, v61, v62
  v_cvt_f32_u32 v62, v61
  v_mul_f32 v62, 0x3acccccd, v62
  v_cos_f32 v100, v62
  v_sin_f32 v101, v62
  v_mul_f32 v100, 0x35cccccd, v100
  v_mul_f32 v101, 0x35cccccd, v101
  v_add_u32 v60, 1, v8
  v_mul_u32_u24 v61, v7, v60
  v_lshrrev_b32 v62, 7, v61
  v_mul_u32_u24 v62, 0xcccd, v62
  v_lshrrev_b32 v62, 18, v62
  v_mul_u32_u24 v62, 640, v62
  v_sub_u32 v61, v61, v62
  v_cvt_f32_u32 v62, v61
  v_mul_f32 v62, 0x3acccccd, v62
  v_cos_f32 v102, v62
  v_sin_f32 v103, v62
  v_mul_f32 v102, 0x35cccccd, v102
  v_mul_f32 v103, 0x35cccccd, v103
  v_add_u32 v60, 2, v8
  v_mul_u32_u24 v61, v7, v60
  v_lshrrev_b32 v62, 7, v61
  v_mul_u32_u24 v62, 0xcccd, v62
  v_lshrrev_b32 v62, 18, v62
  v_mul_u32_u24 v62, 640, v62
  v_sub_u32 v61, v61, v62
  v_cvt_f32_u32 v62, v61
  v_mul_f32 v62, 0x3acccccd, v62
  v_cos_f32 v104, v62
  v_sin_f32 v105, v62
  v_mul_f32 v104, 0x35cccccd, v104
  v_mul_f32 v105, 0x35cccccd, v105
  v_add_u32 v60, 3, v8
  v_mul_u32_u24 v61, v7, v60
  v_lshrrev_b32 v62, 7, v61
  v_mul_u32_u24 v62, 0xcccd, v62
  v_lshrrev_b32 v62, 18, v62
  v_mul_u32_u24 v62, 640, v62
  v_sub_u32 v61, v61, v62
  v_cvt_f32_u32 v62, v61
  v_mul_f32 v62, 0x3acccccd, v62
  v_cos_f32 v106, v62
  v_sin_f32 v107, v62
  v_mul_f32 v106, 0x35cccccd, v106
  v_mul_f32 v107, 0x35cccccd, v107
  v_lshlrev_b32 v61, 5, v7
  v_lshrrev_b32 v62, 7, v61
  v_mul_u32_u24 v62, 0xcccd, v62
  v_lshrrev_b32 v62, 18, v62
  v_mul_u32_u24 v62, 640, v62
  v_sub_u32 v61, v61, v62
  v_cvt_f32_u32 v62, v61
  v_mul_f32 v62, 0x3acccccd, v62
  v_cos_f32 v68, v62
  v_sin_f32 v69, v62
  v_lshlrev_b32 v9, 4, v1
  v_add_u32 v60, 0, v8
  v_mov_b32 v61, 1.0
  v_cmp_eq_u32 vcc, 0, v60
  v_mov_b32 v62, 0.5
  s_nop 0
  v_cndmask_b32 v61, v61, v62, vcc
  v_cmp_eq_u32 vcc, 320, v60
  s_nop 1
  v_cndmask_b32 v61, v61, v62, vcc
  v_mov_b32 v62, 0
  v_cmp_lt_u32 vcc, 320, v60
  s_nop 1
  v_cndmask_b32 v61, v61, v62, vcc
  v_mul_f32 v110, v100, v61
  v_mul_f32 v111, v101, v61
  v_add_u32 v60, 1, v8
  v_mov_b32 v61, 1.0
  v_cmp_eq_u32 vcc, 0, v60
  v_mov_b32 v62, 0.5
  s_nop 0
  v_cndmask_b32 v61, v61, v62, vcc
  v_cmp_eq_u32 vcc, 320, v60
  s_nop 1
  v_cndmask_b32 v61, v61, v62, vcc
  v_mov_b32 v62, 0
  v_cmp_lt_u32 vcc, 320, v60
  s_nop 1
  v_cndmask_b32 v61, v61, v62, vcc
  v_mul_f32 v112, v102, v61
  v_mul_f32 v113, v103, v61
  v_add_u32 v60, 2, v8
  v_mov_b32 v61, 1.0
  v_cmp_eq_u32 vcc, 0, v60
  v_mov_b32 v62, 0.5
  s_nop 0
  v_cndmask_b32 v61, v61, v62, vcc
  v_cmp_eq_u32 vcc, 320, v60
  s_nop 1
  v_cndmask_b32 v61, v61, v62, vcc
  v_mov_b32 v62, 0
  v_cmp_lt_u32 vcc, 320, v60
  s_nop 1
  v_cndmask_b32 v61, v61, v62, vcc
  v_mul_f32 v114, v104, v61
  v_mul_f32 v115, v105, v61
  v_add_u32 v60, 3, v8
  v_mov_b32 v61, 1.0
  v_cmp_eq_u32 vcc, 0, v60
  v_mov_b32 v62, 0.5
  s_nop 0
  v_cndmask_b32 v61, v61, v62, vcc
  v_cmp_eq_u32 vcc, 320, v60
  s_nop 1
  v_cndmask_b32 v61, v61, v62, vcc
  v_mov_b32 v62, 0
  v_cmp_lt_u32 vcc, 320, v60
  s_nop 1
  v_cndmask_b32 v61, v61, v62, vcc
  v_mul_f32 v116, v106, v61
  v_mul_f32 v117, v107, v61
  v_cvt_pk_bf16_f32 v70, v110, v112
  v_cvt_pk_bf16_f32 v71, v114, v116
  v_cvt_pk_bf16_f32 v72, v111, v113
  v_cvt_pk_bf16_f32 v73, v115, v117
  buffer_store_dwordx4 v[70:73], v9, s[44:47], s58 offen sc1
  s_add_u32 s58, s58, 10240
  v_pk_mul_f32 v[64:65], v[100:101], v[68:69] op_sel:[0,0] op_sel_hi:[1,0]
  v_pk_fma_f32 v[100:101], v[100:101], v[68:69], v[64:65] op_sel:[1,1,0] op_sel_hi:[0,1,1] neg_lo:[0,1,0]
  v_pk_mul_f32 v[64:65], v[102:103], v[68:69] op_sel:[0,0] op_sel_hi:[1,0]
  v_pk_fma_f32 v[102:103], v[102:103], v[68:69], v[64:65] op_sel:[1,1,0] op_sel_hi:[0,1,1] neg_lo:[0,1,0]
  v_pk_mul_f32 v[64:65], v[104:105], v[68:69] op_sel:[0,0] op_sel_hi:[1,0]
  v_pk_fma_f32 v[104:105], v[104:105], v[68:69], v[64:65] op_sel:[1,1,0] op_sel_hi:[0,1,1] neg_lo:[0,1,0]
  v_pk_mul_f32 v[64:65], v[106:107], v[68:69] op_sel:[0,0] op_sel_hi:[1,0]
  v_pk_fma_f32 v[106:107], v[106:107], v[68:69], v[64:65] op_sel:[1,1,0] op_sel_hi:[0,1,1] neg_lo:[0,1,0]
  v_cvt_pk_bf16_f32 v70, v100, v102
  v_cvt_pk_bf16_f32 v71, v104, v106
  v_cvt_pk_bf16_f32 v72, v101, v103
  v_cvt_pk_bf16_f32 v73, v105, v107
  buffer_store_dwordx4 v[70:73], v9, s[44:47], s58 offen sc1
  s_add_u32 s58, s58, 10240
  v_pk_mul_f32 v[64:65], v[100:101], v[68:69] op_sel:[0,0] op_sel_hi:[1,0]
  v_pk_fma_f32 v[100:101], v[100:101], v[68:69], v[64:65] op_sel:[1,1,0] op_sel_hi:[0,1,1] neg_lo:[0,1,0]
  v_pk_mul_f32 v[64:65], v[102:103], v[68:69] op_sel:[0,0] op_sel_hi:[1,0]
  v_pk_fma_f32 v[102:103], v[102:103], v[68:69], v[64:65] op_sel:[1,1,0] op_sel_hi:[0,1,1] neg_lo:[0,1,0]
  v_pk_mul_f32 v[64:65], v[104:105], v[68:69] op_sel:[0,0] op_sel_hi:[1,0]
  v_pk_fma_f32 v[104:105], v[104:105], v[68:69], v[64:65] op_sel:[1,1,0] op_sel_hi:[0,1,1] neg_lo:[0,1,0]
  v_pk_mul_f32 v[64:65], v[106:107], v[68:69] op_sel:[0,0] op_sel_hi:[1,0]
  v_pk_fma_f32 v[106:107], v[106:107], v[68:69], v[64:65] op_sel:[1,1,0] op_sel_hi:[0,1,1] neg_lo:[0,1,0]
  v_cvt_pk_bf16_f32 v70, v100, v102
  v_cvt_pk_bf16_f32 v71, v104, v106
  v_cvt_pk_bf16_f32 v72, v101, v103
  v_cvt_pk_bf16_f32 v73, v105, v107
  buffer_store_dwordx4 v[70:73], v9, s[44:47], s58 offen sc1
  s_add_u32 s58, s58, 10240
  v_pk_mul_f32 v[64:65], v[100:101], v[68:69] op_sel:[0,0] op_sel_hi:[1,0]
  v_pk_fma_f32 v[100:101], v[100:101], v[68:69], v[64:65] op_sel:[1,1,0] op_sel_hi:[0,1,1] neg_lo:[0,1,0]
  v_pk_mul_f32 v[64:65], v[102:103], v[68:69] op_sel:[0,0] op_sel_hi:[1,0]
  v_pk_fma_f32 v[102:103], v[102:103], v[68:69], v[64:65] op_sel:[1,1,0] op_sel_hi:[0,1,1] neg_lo:[0,1,0]
  v_pk_mul_f32 v[64:65], v[104:105], v[68:69] op_sel:[0,0] op_sel_hi:[1,0]
  v_pk_fma_f32 v[104:105], v[104:105], v[68:69], v[64:65] op_sel:[1,1,0] op_sel_hi:[0,1,1] neg_lo:[0,1,0]
  v_pk_mul_f32 v[64:65], v[106:107], v[68:69] op_sel:[0,0] op_sel_hi:[1,0]
  v_pk_fma_f32 v[106:107], v[106:107], v[68:69], v[64:65] op_sel:[1,1,0] op_sel_hi:[0,1,1] neg_lo:[0,1,0]
  v_cvt_pk_bf16_f32 v70, v100, v102
  v_cvt_pk_bf16_f32 v71, v104, v106
  v_cvt_pk_bf16_f32 v72, v101, v103
  v_cvt_pk_bf16_f32 v73, v105, v107
  buffer_store_dwordx4 v[70:73], v9, s[44:47], s58 offen sc1
  s_add_u32 s58, s58, 10240
  v_pk_mul_f32 v[64:65], v[100:101], v[68:69] op_sel:[0,0] op_sel_hi:[1,0]
  v_pk_fma_f32 v[100:101], v[100:101], v[68:69], v[64:65] op_sel:[1,1,0] op_sel_hi:[0,1,1] neg_lo:[0,1,0]
  v_pk_mul_f32 v[64:65], v[102:103], v[68:69] op_sel:[0,0] op_sel_hi:[1,0]
  v_pk_fma_f32 v[102:103], v[102:103], v[68:69], v[64:65] op_sel:[1,1,0] op_sel_hi:[0,1,1] neg_lo:[0,1,0]
  v_pk_mul_f32 v[64:65], v[104:105], v[68:69] op_sel:[0,0] op_sel_hi:[1,0]
  v_pk_fma_f32 v[104:105], v[104:105], v[68:69], v[64:65] op_sel:[1,1,0] op_sel_hi:[0,1,1] neg_lo:[0,1,0]
  v_pk_mul_f32 v[64:65], v[106:107], v[68:69] op_sel:[0,0] op_sel_hi:[1,0]
  v_pk_fma_f32 v[106:107], v[106:107], v[68:69], v[64:65] op_sel:[1,1,0] op_sel_hi:[0,1,1] neg_lo:[0,1,0]
  v_cvt_pk_bf16_f32 v70, v100, v102
  v_cvt_pk_bf16_f32 v71, v104, v106
  v_cvt_pk_bf16_f32 v72, v101, v103
  v_cvt_pk_bf16_f32 v73, v105, v107
  buffer_store_dwordx4 v[70:73], v9, s[44:47], s58 offen sc1
  s_add_u32 s58, s58, 10240
  v_pk_mul_f32 v[64:65], v[100:101], v[68:69] op_sel:[0,0] op_sel_hi:[1,0]
  v_pk_fma_f32 v[100:101], v[100:101], v[68:69], v[64:65] op_sel:[1,1,0] op_sel_hi:[0,1,1] neg_lo:[0,1,0]
  v_pk_mul_f32 v[64:65], v[102:103], v[68:69] op_sel:[0,0] op_sel_hi:[1,0]
  v_pk_fma_f32 v[102:103], v[102:103], v[68:69], v[64:65] op_sel:[1,1,0] op_sel_hi:[0,1,1] neg_lo:[0,1,0]
  v_pk_mul_f32 v[64:65], v[104:105], v[68:69] op_sel:[0,0] op_sel_hi:[1,0]
  v_pk_fma_f32 v[104:105], v[104:105], v[68:69], v[64:65] op_sel:[1,1,0] op_sel_hi:[0,1,1] neg_lo:[0,1,0]
  v_pk_mul_f32 v[64:65], v[106:107], v[68:69] op_sel:[0,0] op_sel_hi:[1,0]
  v_pk_fma_f32 v[106:107], v[106:107], v[68:69], v[64:65] op_sel:[1,1,0] op_sel_hi:[0,1,1] neg_lo:[0,1,0]
  v_cvt_pk_bf16_f32 v70, v100, v102
  v_cvt_pk_bf16_f32 v71, v104, v106
  v_cvt_pk_bf16_f32 v72, v101, v103
  v_cvt_pk_bf16_f32 v73, v105, v107
  buffer_store_dwordx4 v[70:73], v9, s[44:47], s58 offen sc1
  s_add_u32 s58, s58, 10240
  v_pk_mul_f32 v[64:65], v[100:101], v[68:69] op_sel:[0,0] op_sel_hi:[1,0]
  v_pk_fma_f32 v[100:101], v[100:101], v[68:69], v[64:65] op_sel:[1,1,0] op_sel_hi:[0,1,1] neg_lo:[0,1,0]
  v_pk_mul_f32 v[64:65], v[102:103], v[68:69] op_sel:[0,0] op_sel_hi:[1,0]
  v_pk_fma_f32 v[102:103], v[102:103], v[68:69], v[64:65] op_sel:[1,1,0] op_sel_hi:[0,1,1] neg_lo:[0,1,0]
  v_pk_mul_f32 v[64:65], v[104:105], v[68:69] op_sel:[0,0] op_sel_hi:[1,0]
  v_pk_fma_f32 v[104:105], v[104:105], v[68:69], v[64:65] op_sel:[1,1,0] op_sel_hi:[0,1,1] neg_lo:[0,1,0]
  v_pk_mul_f32 v[64:65], v[106:107], v[68:69] op_sel:[0,0] op_sel_hi:[1,0]
  v_pk_fma_f32 v[106:107], v[106:107], v[68:69], v[64:65] op_sel:[1,1,0] op_sel_hi:[0,1,1] neg_lo:[0,1,0]
  v_cvt_pk_bf16_f32 v70, v100, v102
  v_cvt_pk_bf16_f32 v71, v104, v106
  v_cvt_pk_bf16_f32 v72, v101, v103
  v_cvt_pk_bf16_f32 v73, v105, v107
  buffer_store_dwordx4 v[70:73], v9, s[44:47], s58 offen sc1
  s_add_u32 s58, s58, 10240
  v_pk_mul_f32 v[64:65], v[100:101], v[68:69] op_sel:[0,0] op_sel_hi:[1,0]
  v_pk_fma_f32 v[100:101], v[100:101], v[68:69], v[64:65] op_sel:[1,1,0] op_sel_hi:[0,1,1] neg_lo:[0,1,0]
  v_pk_mul_f32 v[64:65], v[102:103], v[68:69] op_sel:[0,0] op_sel_hi:[1,0]
  v_pk_fma_f32 v[102:103], v[102:103], v[68:69], v[64:65] op_sel:[1,1,0] op_sel_hi:[0,1,1] neg_lo:[0,1,0]
  v_pk_mul_f32 v[64:65], v[104:105], v[68:69] op_sel:[0,0] op_sel_hi:[1,0]
  v_pk_fma_f32 v[104:105], v[104:105], v[68:69], v[64:65] op_sel:[1,1,0] op_sel_hi:[0,1,1] neg_lo:[0,1,0]
  v_pk_mul_f32 v[64:65], v[106:107], v[68:69] op_sel:[0,0] op_sel_hi:[1,0]
  v_pk_fma_f32 v[106:107], v[106:107], v[68:69], v[64:65] op_sel:[1,1,0] op_sel_hi:[0,1,1] neg_lo:[0,1,0]
  v_cvt_pk_bf16_f32 v70, v100, v102
  v_cvt_pk_bf16_f32 v71, v104, v106
  v_cvt_pk_bf16_f32 v72, v101, v103
  v_cvt_pk_bf16_f32 v73, v105, v107
  buffer_store_dwordx4 v[70:73], v9, s[44:47], s58 offen sc1
  s_add_u32 s58, s58, 10240
  v_pk_mul_f32 v[64:65], v[100:101], v[68:69] op_sel:[0,0] op_sel_hi:[1,0]
  v_pk_fma_f32 v[100:101], v[100:101], v[68:69], v[64:65] op_sel:[1,1,0] op_sel_hi:[0,1,1] neg_lo:[0,1,0]
  v_pk_mul_f32 v[64:65], v[102:103], v[68:69] op_sel:[0,0] op_sel_hi:[1,0]
  v_pk_fma_f32 v[102:103], v[102:103], v[68:69], v[64:65] op_sel:[1,1,0] op_sel_hi:[0,1,1] neg_lo:[0,1,0]
  v_pk_mul_f32 v[64:65], v[104:105], v[68:69] op_sel:[0,0] op_sel_hi:[1,0]
  v_pk_fma_f32 v[104:105], v[104:105], v[68:69], v[64:65] op_sel:[1,1,0] op_sel_hi:[0,1,1] neg_lo:[0,1,0]
  v_pk_mul_f32 v[64:65], v[106:107], v[68:69] op_sel:[0,0] op_sel_hi:[1,0]
  v_pk_fma_f32 v[106:107], v[106:107], v[68:69], v[64:65] op_sel:[1,1,0] op_sel_hi:[0,1,1] neg_lo:[0,1,0]
  v_cvt_pk_bf16_f32 v70, v100, v102
  v_cvt_pk_bf16_f32 v71, v104, v106
  v_cvt_pk_bf16_f32 v72, v101, v103
  v_cvt_pk_bf16_f32 v73, v105, v107
  buffer_store_dwordx4 v[70:73], v9, s[44:47], s58 offen sc1
  s_add_u32 s58, s58, 10240
  v_pk_mul_f32 v[64:65], v[100:101], v[68:69] op_sel:[0,0] op_sel_hi:[1,0]
  v_pk_fma_f32 v[100:101], v[100:101], v[68:69], v[64:65] op_sel:[1,1,0] op_sel_hi:[0,1,1] neg_lo:[0,1,0]
  v_pk_mul_f32 v[64:65], v[102:103], v[68:69] op_sel:[0,0] op_sel_hi:[1,0]
  v_pk_fma_f32 v[102:103], v[102:103], v[68:69], v[64:65] op_sel:[1,1,0] op_sel_hi:[0,1,1] neg_lo:[0,1,0]
  v_pk_mul_f32 v[64:65], v[104:105], v[68:69] op_sel:[0,0] op_sel_hi:[1,0]
  v_pk_fma_f32 v[104:105], v[104:105], v[68:69], v[64:65] op_sel:[1,1,0] op_sel_hi:[0,1,1] neg_lo:[0,1,0]
  v_pk_mul_f32 v[64:65], v[106:107], v[68:69] op_sel:[0,0] op_sel_hi:[1,0]
  v_pk_fma_f32 v[106:107], v[106:107], v[68:69], v[64:65] op_sel:[1,1,0] op_sel_hi:[0,1,1] neg_lo:[0,1,0]
  v_cvt_pk_bf16_f32 v70, v100, v102
  v_cvt_pk_bf16_f32 v71, v104, v106
  v_cvt_pk_bf16_f32 v72, v101, v103
  v_cvt_pk_bf16_f32 v73, v105, v107
  buffer_store_dwordx4 v[70:73], v9, s[44:47], s58 offen sc1
  s_add_u32 s58, s58, 10240
  v_pk_mul_f32 v[64:65], v[100:101], v[68:69] op_sel:[0,0] op_sel_hi:[1,0]
  v_pk_fma_f32 v[100:101], v[100:101], v[68:69], v[64:65] op_sel:[1,1,0] op_sel_hi:[0,1,1] neg_lo:[0,1,0]
  v_pk_mul_f32 v[64:65], v[102:103], v[68:69] op_sel:[0,0] op_sel_hi:[1,0]
  v_pk_fma_f32 v[102:103], v[102:103], v[68:69], v[64:65] op_sel:[1,1,0] op_sel_hi:[0,1,1] neg_lo:[0,1,0]
  v_pk_mul_f32 v[64:65], v[104:105], v[68:69] op_sel:[0,0] op_sel_hi:[1,0]
  v_pk_fma_f32 v[104:105], v[104:105], v[68:69], v[64:65] op_sel:[1,1,0] op_sel_hi:[0,1,1] neg_lo:[0,1,0]
  v_pk_mul_f32 v[64:65], v[106:107], v[68:69] op_sel:[0,0] op_sel_hi:[1,0]
  v_pk_fma_f32 v[106:107], v[106:107], v[68:69], v[64:65] op_sel:[1,1,0] op_sel_hi:[0,1,1] neg_lo:[0,1,0]
  s_cmp_ge_u32 s3, 2
  s_cbranch_scc1 L_gv_nog
  v_add_u32 v60, 320, v8
  v_mov_b32 v61, 1.0
  v_cmp_eq_u32 vcc, 0, v60
  v_mov_b32 v62, 0.5
  s_nop 0
  v_cndmask_b32 v61, v61, v62, vcc
  v_cmp_eq_u32 vcc, 320, v60
  s_nop 1
  v_cndmask_b32 v61, v61, v62, vcc
  v_mov_b32 v62, 0
  v_cmp_lt_u32 vcc, 320, v60
  s_nop 1
  v_cndmask_b32 v61, v61, v62, vcc
  v_mul_f32 v110, v100, v61
  v_mul_f32 v111, v101, v61
  v_add_u32 v60, 321, v8
  v_mov_b32 v61, 1.0
  v_cmp_eq_u32 vcc, 0, v60
  v_mov_b32 v62, 0.5
  s_nop 0
  v_cndmask_b32 v61, v61, v62, vcc
  v_cmp_eq_u32 vcc, 320, v60
  s_nop 1
  v_cndmask_b32 v61, v61, v62, vcc
  v_mov_b32 v62, 0
  v_cmp_lt_u32 vcc, 320, v60
  s_nop 1
  v_cndmask_b32 v61, v61, v62, vcc
  v_mul_f32 v112, v102, v61
  v_mul_f32 v113, v103, v61
  v_add_u32 v60, 322, v8
  v_mov_b32 v61, 1.0
  v_cmp_eq_u32 vcc, 0, v60
  v_mov_b32 v62, 0.5
  s_nop 0
  v_cndmask_b32 v61, v61, v62, vcc
  v_cmp_eq_u32 vcc, 320, v60
  s_nop 1
  v_cndmask_b32 v61, v61, v62, vcc
  v_mov_b32 v62, 0
  v_cmp_lt_u32 vcc, 320, v60
  s_nop 1
  v_cndmask_b32 v61, v61, v62, vcc
  v_mul_f32 v114, v104, v61
  v_mul_f32 v115, v105, v61
  v_add_u32 v60, 323, v8
  v_mov_b32 v61, 1.0
  v_cmp_eq_u32 vcc, 0, v60
  v_mov_b32 v62, 0.5
  s_nop 0
  v_cndmask_b32 v61, v61, v62, vcc
  v_cmp_eq_u32 vcc, 320, v60
  s_nop 1
  v_cndmask_b32 v61, v61, v62, vcc
  v_mov_b32 v62, 0
  v_cmp_lt_u32 vcc, 320, v60
  s_nop 1
  v_cndmask_b32 v61, v61, v62, vcc
  v_mul_f32 v116, v106, v61
  v_mul_f32 v117, v107, v61
  v_cvt_pk_bf16_f32 v70, v110, v112
  v_cvt_pk_bf16_f32 v71, v114, v116
  v_cvt_pk_bf16_f32 v72, v111, v113
  v_cvt_pk_bf16_f32 v73, v115, v117
  buffer_store_dwordx4 v[70:73], v9, s[44:47], s58 offen sc1
  s_add_u32 s58, s58, 10240
L_gv_nog:
  s_waitcnt vmcnt(10)
  s_branch L_gv_go
L_gv_pre_done0:
  s_waitcnt vmcnt(0)
L_gv_go:
  v_lshlrev_b32 v10, 16, v10
  v_mul_f32 v7, 0xbfb8aa3b, v10
  v_exp_f32 v7, v7
  s_nop 0
  v_add_f32 v7, 1.0, v7
  v_rcp_f32 v7, v7
  s_nop 0
  v_mul_f32 v10, v10, v7
  v_cvt_pk_bf16_f32 v10, v10, v10
  v_lshlrev_b32 v10, 16, v10
  v_lshlrev_b32 v11, 16, v11
  v_mul_f32 v7, 0xbfb8aa3b, v11
  v_exp_f32 v7, v7
  s_nop 0
  v_add_f32 v7, 1.0, v7
  v_rcp_f32 v7, v7
  s_nop 0
  v_mul_f32 v11, v11, v7
  v_cvt_pk_bf16_f32 v11, v11, v11
  v_lshlrev_b32 v11, 16, v11
  v_lshlrev_b32 v12, 16, v12
  v_mul_f32 v7, 0xbfb8aa3b, v12
  v_exp_f32 v7, v7
  s_nop 0
  v_add_f32 v7, 1.0, v7
  v_rcp_f32 v7, v7
  s_nop 0
  v_mul_f32 v12, v12, v7
  v_cvt_pk_bf16_f32 v12, v12, v12
  v_lshlrev_b32 v12, 16, v12
  v_lshlrev_b32 v13, 16, v13
  v_mul_f32 v7, 0xbfb8aa3b, v13
  v_exp_f32 v7, v7
  s_nop 0
  v_add_f32 v7, 1.0, v7
  v_rcp_f32 v7, v7
  s_nop 0
  v_mul_f32 v13, v13, v7
  v_cvt_pk_bf16_f32 v13, v13, v13
  v_lshlrev_b32 v13, 16, v13
  v_lshlrev_b32 v14, 16, v14
  v_mul_f32 v7, 0xbfb8aa3b, v14
  v_exp_f32 v7, v7
  s_nop 0
  v_add_f32 v7, 1.0, v7
  v_rcp_f32 v7, v7
  s_nop 0
  v_mul_f32 v14, v14, v7
  v_cvt_pk_bf16_f32 v14, v14, v14
  v_lshlrev_b32 v14, 16, v14
  v_lshlrev_b32 v15, 16, v15
  v_mul_f32 v7, 0xbfb8aa3b, v15
  v_exp_f32 v7, v7
  s_nop 0
  v_add_f32 v7, 1.0, v7
  v_rcp_f32 v7, v7
  s_nop 0
  v_mul_f32 v15, v15, v7
  v_cvt_pk_bf16_f32 v15, v15, v15
  v_lshlrev_b32 v15, 16, v15
  v_lshlrev_b32 v16, 16, v16
  v_mul_f32 v7, 0xbfb8aa3b, v16
  v_exp_f32 v7, v7
  s_nop 0
  v_add_f32 v7, 1.0, v7
  v_rcp_f32 v7, v7
  s_nop 0
  v_mul_f32 v16, v16, v7
  v_cvt_pk_bf16_f32 v16, v16, v16
  v_lshlrev_b32 v16, 16, v16
  v_lshlrev_b32 v17, 16, v17
  v_mul_f32 v7, 0xbfb8aa3b, v17
  v_exp_f32 v7, v7
  s_nop 0
  v_add_f32 v7, 1.0, v7
  v_rcp_f32 v7, v7
  s_nop 0
  v_mul_f32 v17, v17, v7
  v_cvt_pk_bf16_f32 v17, v17, v17
  v_lshlrev_b32 v17, 16, v17
  v_lshlrev_b32 v18, 16, v18
  v_mul_f32 v7, 0xbfb8aa3b, v18
  v_exp_f32 v7, v7
  s_nop 0
  v_add_f32 v7, 1.0, v7
  v_rcp_f32 v7, v7
  s_nop 0
  v_mul_f32 v18, v18, v7
  v_cvt_pk_bf16_f32 v18, v18, v18
  v_lshlrev_b32 v18, 16, v18
  v_lshlrev_b32 v19, 16, v19
  v_mul_f32 v7, 0xbfb8aa3b, v19
  v_exp_f32 v7, v7
  s_nop 0
  v_add_f32 v7, 1.0, v7
  v_rcp_f32 v7, v7
  s_nop 0
  v_mul_f32 v19, v19, v7
  v_cvt_pk_bf16_f32 v19, v19, v19
  v_lshlrev_b32 v19, 16, v19
  v_mov_b32 v60, 0
  v_mov_b32 v61, 0
  v_mov_b32 v62, 0
  v_mov_b32 v63, 0
  v_mov_b32 v64, 0
  v_mov_b32 v65, 0
  v_mov_b32 v66, 0
  v_mov_b32 v67, 0
  v_lshlrev_b32 v7, 16, v20
  v_and_b32 v8, 0xffff0000, v20
  v_fmac_f32 v60, v10, v7
  v_fmac_f32 v61, v10, v8
  v_lshlrev_b32 v7, 16, v21
  v_and_b32 v8, 0xffff0000, v21
  v_fmac_f32 v62, v10, v7
  v_fmac_f32 v63, v10, v8
  v_lshlrev_b32 v7, 16, v22
  v_and_b32 v8, 0xffff0000, v22
  v_fmac_f32 v64, v10, v7
  v_fmac_f32 v65, v10, v8
  v_lshlrev_b32 v7, 16, v23
  v_and_b32 v8, 0xffff0000, v23
  v_fmac_f32 v66, v10, v7
  v_fmac_f32 v67, v10, v8
  v_lshlrev_b32 v7, 16, v24
  v_and_b32 v8, 0xffff0000, v24
  v_fmac_f32 v60, v11, v7
  v_fmac_f32 v61, v11, v8
  v_lshlrev_b32 v7, 16, v25
  v_and_b32 v8, 0xffff0000, v25
  v_fmac_f32 v62, v11, v7
  v_fmac_f32 v63, v11, v8
  v_lshlrev_b32 v7, 16, v26
  v_and_b32 v8, 0xffff0000, v26
  v_fmac_f32 v64, v11, v7
  v_fmac_f32 v65, v11, v8
  v_lshlrev_b32 v7, 16, v27
  v_and_b32 v8, 0xffff0000, v27
  v_fmac_f32 v66, v11, v7
  v_fmac_f32 v67, v11, v8
  v_lshlrev_b32 v7, 16, v28
  v_and_b32 v8, 0xffff0000, v28
  v_fmac_f32 v60, v12, v7
  v_fmac_f32 v61, v12, v8
  v_lshlrev_b32 v7, 16, v29
  v_and_b32 v8, 0xffff0000, v29
  v_fmac_f32 v62, v12, v7
  v_fmac_f32 v63, v12, v8
  v_lshlrev_b32 v7, 16, v30
  v_and_b32 v8, 0xffff0000, v30
  v_fmac_f32 v64, v12, v7
  v_fmac_f32 v65, v12, v8
  v_lshlrev_b32 v7, 16, v31
  v_and_b32 v8, 0xffff0000, v31
  v_fmac_f32 v66, v12, v7
  v_fmac_f32 v67, v12, v8
  v_lshlrev_b32 v7, 16, v32
  v_and_b32 v8, 0xffff0000, v32
  v_fmac_f32 v60, v13, v7
  v_fmac_f32 v61, v13, v8
  v_lshlrev_b32 v7, 16, v33
  v_and_b32 v8, 0xffff0000, v33
  v_fmac_f32 v62, v13, v7
  v_fmac_f32 v63, v13, v8
  v_lshlrev_b32 v7, 16, v34
  v_and_b32 v8, 0xffff0000, v34
  v_fmac_f32 v64, v13, v7
  v_fmac_f32 v65, v13, v8
  v_lshlrev_b32 v7, 16, v35
  v_and_b32 v8, 0xffff0000, v35
  v_fmac_f32 v66, v13, v7
  v_fmac_f32 v67, v13, v8
  v_lshlrev_b32 v7, 16, v36
  v_and_b32 v8, 0xffff0000, v36
  v_fmac_f32 v60, v14, v7
  v_fmac_f32 v61, v14, v8
  v_lshlrev_b32 v7, 16, v37
  v_and_b32 v8, 0xffff0000, v37
  v_fmac_f32 v62, v14, v7
  v_fmac_f32 v63, v14, v8
  v_lshlrev_b32 v7, 16, v38
  v_and_b32 v8, 0xffff0000, v38
  v_fmac_f32 v64, v14, v7
  v_fmac_f32 v65, v14, v8
  v_lshlrev_b32 v7, 16, v39
  v_and_b32 v8, 0xffff0000, v39
  v_fmac_f32 v66, v14, v7
  v_fmac_f32 v67, v14, v8
  v_lshlrev_b32 v7, 16, v40
  v_and_b32 v8, 0xffff0000, v40
  v_fmac_f32 v60, v15, v7
  v_fmac_f32 v61, v15, v8
  v_lshlrev_b32 v7, 16, v41
  v_and_b32 v8, 0xffff0000, v41
  v_fmac_f32 v62, v15, v7
  v_fmac_f32 v63, v15, v8
  v_lshlrev_b32 v7, 16, v42
  v_and_b32 v8, 0xffff0000, v42
  v_fmac_f32 v64, v15, v7
  v_fmac_f32 v65, v15, v8
  v_lshlrev_b32 v7, 16, v43
  v_and_b32 v8, 0xffff0000, v43
  v_fmac_f32 v66, v15, v7
  v_fmac_f32 v67, v15, v8
  v_lshlrev_b32 v7, 16, v44
  v_and_b32 v8, 0xffff0000, v44
  v_fmac_f32 v60, v16, v7
  v_fmac_f32 v61, v16, v8
  v_lshlrev_b32 v7, 16, v45
  v_and_b32 v8, 0xffff0000, v45
  v_fmac_f32 v62, v16, v7
  v_fmac_f32 v63, v16, v8
  v_lshlrev_b32 v7, 16, v46
  v_and_b32 v8, 0xffff0000, v46
  v_fmac_f32 v64, v16, v7
  v_fmac_f32 v65, v16, v8
  v_lshlrev_b32 v7, 16, v47
  v_and_b32 v8, 0xffff0000, v47
  v_fmac_f32 v66, v16, v7
  v_fmac_f32 v67, v16, v8
  v_lshlrev_b32 v7, 16, v48
  v_and_b32 v8, 0xffff0000, v48
  v_fmac_f32 v60, v17, v7
  v_fmac_f32 v61, v17, v8
  v_lshlrev_b32 v7, 16, v49
  v_and_b32 v8, 0xffff0000, v49
  v_fmac_f32 v62, v17, v7
  v_fmac_f32 v63, v17, v8
  v_lshlrev_b32 v7, 16, v50
  v_and_b32 v8, 0xffff0000, v50
  v_fmac_f32 v64, v17, v7
  v_fmac_f32 v65, v17, v8
  v_lshlrev_b32 v7, 16, v51
  v_and_b32 v8, 0xffff0000, v51
  v_fmac_f32 v66, v17, v7
  v_fmac_f32 v67, v17, v8
  v_lshlrev_b32 v7, 16, v52
  v_and_b32 v8, 0xffff0000, v52
  v_fmac_f32 v60, v18, v7
  v_fmac_f32 v61, v18, v8
  v_lshlrev_b32 v7, 16, v53
  v_and_b32 v8, 0xffff0000, v53
  v_fmac_f32 v62, v18, v7
  v_fmac_f32 v63, v18, v8
  v_lshlrev_b32 v7, 16, v54
  v_and_b32 v8, 0xffff0000, v54
  v_fmac_f32 v64, v18, v7
  v_fmac_f32 v65, v18, v8
  v_lshlrev_b32 v7, 16, v55
  v_and_b32 v8, 0xffff0000, v55
  v_fmac_f32 v66, v18, v7
  v_fmac_f32 v67, v18, v8
  v_lshlrev_b32 v7, 16, v56
  v_and_b32 v8, 0xffff0000, v56
  v_fmac_f32 v60, v19, v7
  v_fmac_f32 v61, v19, v8
  v_lshlrev_b32 v7, 16, v57
  v_and_b32 v8, 0xffff0000, v57
  v_fmac_f32 v62, v19, v7
  v_fmac_f32 v63, v19, v8
  v_lshlrev_b32 v7, 16, v58
  v_and_b32 v8, 0xffff0000, v58
  v_fmac_f32 v64, v19, v7
  v_fmac_f32 v65, v19, v8
  v_lshlrev_b32 v7, 16, v59
  v_and_b32 v8, 0xffff0000, v59
  v_fmac_f32 v66, v19, v7
  v_fmac_f32 v67, v19, v8
  s_lshl_b32 s57, s3, 4
  v_add_u32 v7, s57, v3
  v_lshlrev_b32 v7, 7, v7
  v_lshl_add_u32 v7, v2, 5, v7
  ds_write_b128 v7, v[60:63]
  ds_write_b128 v7, v[64:67] offset:16
  s_waitcnt lgkmcnt(0)
  s_barrier
  v_and_b32 v7, 31, v0
  v_lshrrev_b32 v8, 5, v0
  v_lshlrev_b32 v9, 10, v8
  v_lshl_add_u32 v9, v7, 2, v9
  ds_read_b32 v60, v9 offset:0
  ds_read_b32 v61, v9 offset:128
  ds_read_b32 v62, v9 offset:256
  ds_read_b32 v63, v9 offset:384
  ds_read_b32 v64, v9 offset:512
  ds_read_b32 v65, v9 offset:640
  ds_read_b32 v66, v9 offset:768
  ds_read_b32 v67, v9 offset:896
  s_waitcnt lgkmcnt(0)
  v_add_f32 v60, v60, v61
  v_add_f32 v60, v60, v62
  v_add_f32 v60, v60, v63
  v_add_f32 v60, v60, v64
  v_add_f32 v60, v60, v65
  v_add_f32 v60, v60, v66
  v_add_f32 v60, v60, v67
  v_lshlrev_b32 v9, 7, v8
  v_lshl_add_u32 v9, v7, 2, v9
  v_add_u32 v9, 8192, v9
  ds_write_b32 v9, v60
  s_waitcnt lgkmcnt(0)
  s_barrier
  v_lshlrev_b32 v9, 2, v7
  v_add_u32 v9, 8192, v9
  ds_read_b32 v60, v9 offset:0
  ds_read_b32 v61, v9 offset:128
  ds_read_b32 v62, v9 offset:256
  ds_read_b32 v63, v9 offset:384
  ds_read_b32 v64, v9 offset:512
  ds_read_b32 v65, v9 offset:640
  ds_read_b32 v66, v9 offset:768
  ds_read_b32 v67, v9 offset:896
  s_waitcnt lgkmcnt(0)
  v_add_f32 v60, v60, v61
  v_add_f32 v60, v60, v62
  v_add_f32 v60, v60, v63
  v_add_f32 v60, v60, v64
  v_add_f32 v60, v60, v65
  v_add_f32 v60, v60, v66
  v_add_f32 v60, v60, v67
  v_cvt_pk_bf16_f32 v60, v60, v60
  v_lshlrev_b32 v60, 16, v60
  s_cmp_eq_u32 s55, 1
  s_cbranch_scc1 L_gv_add1
  s_cmp_eq_u32 s55, 4
  s_cbranch_scc0 L_gv_noadd
L_gv_add1:
  v_add_f32 v60, 1.0, v60
  v_cvt_pk_bf16_f32 v60, v60, v60
  v_lshlrev_b32 v60, 16, v60
L_gv_noadd:
  s_cmp_le_u32 s55, 1
  s_cbranch_scc1 L_gv_trig
  s_cmp_lg_u32 s3, 0
  s_cbranch_scc1 L_arr1
  s_lshl_b32 s57, s56, 7
  v_lshlrev_b32 v9, 2, v7
  v_add_u32 v9, s57, v9
  v_lshrrev_b32 v62, 1, v9
  v_lshrrev_b32 v61, 16, v60
  s_mov_b64 s[60:61], exec
  s_mov_b32 exec_hi, 0
  s_cmp_eq_u32 s55, 2
  s_cbranch_scc0 L_gv_n2
  s_mov_b32 s58, 0x450000
  buffer_store_dword v60, v9, s[44:47], s58 offen sc1
L_gv_n2:
  s_cmp_eq_u32 s55, 5
  s_cbranch_scc0 L_gv_n5
  s_mov_b32 s58, 0x451000
  buffer_store_dword v60, v9, s[44:47], s58 offen sc1
L_gv_n5:
  s_cmp_eq_u32 s55, 4
  s_cbranch_scc0 L_gv_n4
  s_mov_b32 s58, 0x452000
  buffer_store_dword v60, v9, s[44:47], s58 offen sc1
  s_mov_b32 s58, 0x453000
  buffer_store_short v61, v62, s[44:47], s58 offen sc1
L_gv_n4:
  s_cmp_eq_u32 s55, 3
  s_cbranch_scc0 L_gv_n3
  s_mov_b32 s58, 0x454000
  buffer_store_short v61, v62, s[44:47], s58 offen sc1
L_gv_n3:
  s_mov_b64 exec, s[60:61]
  s_branch L_arr1
L_gv_trig:
  v_lshlrev_b32 v9, 2, v7
  v_add_u32 v9, 12288, v9
  ds_write_b32 v9, v60
  s_waitcnt lgkmcnt(0)
  s_barrier
  v_lshrrev_b32 v9, 4, v1
  v_lshlrev_b32 v9, 4, v9
  v_add_u32 v9, 12288, v9
  ds_read_b128 v[60:63], v9
  ds_read_b128 v[64:67], v9 offset:64
  s_waitcnt lgkmcnt(0)
  s_cmp_eq_u32 s55, 0
  s_cbranch_scc1 L_gv_sa
  v_lshlrev_b32 v9, 4, v1
  s_mul_i32 s57, s3, 40960
  s_lshl_b32 s58, s56, 11
  s_add_u32 s57, s57, s58
  s_add_u32 s57, s57, 0x280000
  v_pk_mul_f32 v[100:101], v[100:101], v[60:61] op_sel:[0,0] op_sel_hi:[1,0]
  v_pk_mul_f32 v[102:103], v[102:103], v[60:61] op_sel:[0,1] op_sel_hi:[1,1]
  v_pk_mul_f32 v[104:105], v[104:105], v[62:63] op_sel:[0,0] op_sel_hi:[1,0]
  v_pk_mul_f32 v[106:107], v[106:107], v[62:63] op_sel:[0,1] op_sel_hi:[1,1]
  v_pk_mul_f32 v[108:109], v[108:109], v[64:65] op_sel:[0,0] op_sel_hi:[1,0]
  v_pk_mul_f32 v[110:111], v[110:111], v[64:65] op_sel:[0,1] op_sel_hi:[1,1]
  v_pk_mul_f32 v[112:113], v[112:113], v[66:67] op_sel:[0,0] op_sel_hi:[1,0]
  v_pk_mul_f32 v[114:115], v[114:115], v[66:67] op_sel:[0,1] op_sel_hi:[1,1]
  v_cvt_pk_bf16_f32 v70, v100, v102
  v_cvt_pk_bf16_f32 v74, v101, v103
  v_cvt_pk_bf16_f32 v71, v104, v106
  v_cvt_pk_bf16_f32 v75, v105, v107
  v_cvt_pk_bf16_f32 v72, v108, v110
  v_cvt_pk_bf16_f32 v76, v109, v111
  v_cvt_pk_bf16_f32 v73, v112, v114
  v_cvt_pk_bf16_f32 v77, v113, v115
  buffer_store_dwordx4 v[70:73], v9, s[44:47], s57 offen sc1
  buffer_store_dwordx4 v[74:77], v9, s[44:47], s57 offen offset:1024 sc1
  s_add_u32 s57, s57, 163840
  s_nop 1
  v_pk_mul_f32 v[116:117], v[116:117], v[60:61] op_sel:[0,0] op_sel_hi:[1,0]
  v_pk_mul_f32 v[118:119], v[118:119], v[60:61] op_sel:[0,1] op_sel_hi:[1,1]
  v_pk_mul_f32 v[120:121], v[120:121], v[62:63] op_sel:[0,0] op_sel_hi:[1,0]
  v_pk_mul_f32 v[122:123], v[122:123], v[62:63] op_sel:[0,1] op_sel_hi:[1,1]
  v_pk_mul_f32 v[124:125], v[124:125], v[64:65] op_sel:[0,0] op_sel_hi:[1,0]
  v_pk_mul_f32 v[126:127], v[126:127], v[64:65] op_sel:[0,1] op_sel_hi:[1,1]
  v_pk_mul_f32 v[128:129], v[128:129], v[66:67] op_sel:[0,0] op_sel_hi:[1,0]
  v_pk_mul_f32 v[130:131], v[130:131], v[66:67] op_sel:[0,1] op_sel_hi:[1,1]
  v_cvt_pk_bf16_f32 v70, v116, v118
  v_cvt_pk_bf16_f32 v74, v117, v119
  v_cvt_pk_bf16_f32 v71, v120, v122
  v_cvt_pk_bf16_f32 v75, v121, v123
  v_cvt_pk_bf16_f32 v72, v124, v126
  v_cvt_pk_bf16_f32 v76, v125, v127
  v_cvt_pk_bf16_f32 v73, v128, v130
  v_cvt_pk_bf16_f32 v77, v129, v131
  buffer_store_dwordx4 v[70:73], v9, s[44:47], s57 offen sc1
  buffer_store_dwordx4 v[74:77], v9, s[44:47], s57 offen offset:1024 sc1
  s_add_u32 s57, s57, 163840
  s_nop 1
  v_pk_mul_f32 v[132:133], v[132:133], v[60:61] op_sel:[0,0] op_sel_hi:[1,0]
  v_pk_mul_f32 v[134:135], v[134:135], v[60:61] op_sel:[0,1] op_sel_hi:[1,1]
  v_pk_mul_f32 v[136:137], v[136:137], v[62:63] op_sel:[0,0] op_sel_hi:[1,0]
  v_pk_mul_f32 v[138:139], v[138:139], v[62:63] op_sel:[0,1] op_sel_hi:[1,1]
  v_pk_mul_f32 v[140:141], v[140:141], v[64:65] op_sel:[0,0] op_sel_hi:[1,0]
  v_pk_mul_f32 v[142:143], v[142:143], v[64:65] op_sel:[0,1] op_sel_hi:[1,1]
  v_pk_mul_f32 v[144:145], v[144:145], v[66:67] op_sel:[0,0] op_sel_hi:[1,0]
  v_pk_mul_f32 v[146:147], v[146:147], v[66:67] op_sel:[0,1] op_sel_hi:[1,1]
  v_cvt_pk_bf16_f32 v70, v132, v134
  v_cvt_pk_bf16_f32 v74, v133, v135
  v_cvt_pk_bf16_f32 v71, v136, v138
  v_cvt_pk_bf16_f32 v75, v137, v139
  v_cvt_pk_bf16_f32 v72, v140, v142
  v_cvt_pk_bf16_f32 v76, v141, v143
  v_cvt_pk_bf16_f32 v73, v144, v146
  v_cvt_pk_bf16_f32 v77, v145, v147
  buffer_store_dwordx4 v[70:73], v9, s[44:47], s57 offen sc1
  buffer_store_dwordx4 v[74:77], v9, s[44:47], s57 offen offset:1024 sc1
  s_add_u32 s57, s57, 163840
  s_nop 1
  v_pk_mul_f32 v[148:149], v[148:149], v[60:61] op_sel:[0,0] op_sel_hi:[1,0]
  v_pk_mul_f32 v[150:151], v[150:151], v[60:61] op_sel:[0,1] op_sel_hi:[1,1]
  v_pk_mul_f32 v[152:153], v[152:153], v[62:63] op_sel:[0,0] op_sel_hi:[1,0]
  v_pk_mul_f32 v[154:155], v[154:155], v[62:63] op_sel:[0,1] op_sel_hi:[1,1]
  v_pk_mul_f32 v[156:157], v[156:157], v[64:65] op_sel:[0,0] op_sel_hi:[1,0]
  v_pk_mul_f32 v[158:159], v[158:159], v[64:65] op_sel:[0,1] op_sel_hi:[1,1]
  v_pk_mul_f32 v[160:161], v[160:161], v[66:67] op_sel:[0,0] op_sel_hi:[1,0]
  v_pk_mul_f32 v[162:163], v[162:163], v[66:67] op_sel:[0,1] op_sel_hi:[1,1]
  v_cvt_pk_bf16_f32 v70, v148, v150
  v_cvt_pk_bf16_f32 v74, v149, v151
  v_cvt_pk_bf16_f32 v71, v152, v154
  v_cvt_pk_bf16_f32 v75, v153, v155
  v_cvt_pk_bf16_f32 v72, v156, v158
  v_cvt_pk_bf16_f32 v76, v157, v159
  v_cvt_pk_bf16_f32 v73, v160, v162
  v_cvt_pk_bf16_f32 v77, v161, v163
  buffer_store_dwordx4 v[70:73], v9, s[44:47], s57 offen sc1
  buffer_store_dwordx4 v[74:77], v9, s[44:47], s57 offen offset:1024 sc1
  s_add_u32 s57, s57, 163840
  s_nop 1
  v_pk_mul_f32 v[164:165], v[164:165], v[60:61] op_sel:[0,0] op_sel_hi:[1,0]
  v_pk_mul_f32 v[166:167], v[166:167], v[60:61] op_sel:[0,1] op_sel_hi:[1,1]
  v_pk_mul_f32 v[168:169], v[168:169], v[62:63] op_sel:[0,0] op_sel_hi:[1,0]
  v_pk_mul_f32 v[170:171], v[170:171], v[62:63] op_sel:[0,1] op_sel_hi:[1,1]
  v_pk_mul_f32 v[172:173], v[172:173], v[64:65] op_sel:[0,0] op_sel_hi:[1,0]
  v_pk_mul_f32 v[174:175], v[174:175], v[64:65] op_sel:[0,1] op_sel_hi:[1,1]
  v_pk_mul_f32 v[176:177], v[176:177], v[66:67] op_sel:[0,0] op_sel_hi:[1,0]
  v_pk_mul_f32 v[178:179], v[178:179], v[66:67] op_sel:[0,1] op_sel_hi:[1,1]
  v_cvt_pk_bf16_f32 v70, v164, v166
  v_cvt_pk_bf16_f32 v74, v165, v167
  v_cvt_pk_bf16_f32 v71, v168, v170
  v_cvt_pk_bf16_f32 v75, v169, v171
  v_cvt_pk_bf16_f32 v72, v172, v174
  v_cvt_pk_bf16_f32 v76, v173, v175
  v_cvt_pk_bf16_f32 v73, v176, v178
  v_cvt_pk_bf16_f32 v77, v177, v179
  buffer_store_dwordx4 v[70:73], v9, s[44:47], s57 offen sc1
  buffer_store_dwordx4 v[74:77], v9, s[44:47], s57 offen offset:1024 sc1
  s_add_u32 s57, s57, 163840
  s_nop 1
  s_cmp_lg_u32 s3, 0
  s_cbranch_scc1 L_gv_late
  v_pk_mul_f32 v[180:181], v[180:181], v[60:61] op_sel:[0,0] op_sel_hi:[1,0]
  v_pk_mul_f32 v[182:183], v[182:183], v[60:61] op_sel:[0,1] op_sel_hi:[1,1]
  v_pk_mul_f32 v[184:185], v[184:185], v[62:63] op_sel:[0,0] op_sel_hi:[1,0]
  v_pk_mul_f32 v[186:187], v[186:187], v[62:63] op_sel:[0,1] op_sel_hi:[1,1]
  v_pk_mul_f32 v[188:189], v[188:189], v[64:65] op_sel:[0,0] op_sel_hi:[1,0]
  v_pk_mul_f32 v[190:191], v[190:191], v[64:65] op_sel:[0,1] op_sel_hi:[1,1]
  v_pk_mul_f32 v[192:193], v[192:193], v[66:67] op_sel:[0,0] op_sel_hi:[1,0]
  v_pk_mul_f32 v[194:195], v[194:195], v[66:67] op_sel:[0,1] op_sel_hi:[1,1]
  v_cvt_pk_bf16_f32 v70, v180, v182
  v_cvt_pk_bf16_f32 v74, v181, v183
  v_cvt_pk_bf16_f32 v71, v184, v186
  v_cvt_pk_bf16_f32 v75, v185, v187
  v_cvt_pk_bf16_f32 v72, v188, v190
  v_cvt_pk_bf16_f32 v76, v189, v191
  v_cvt_pk_bf16_f32 v73, v192, v194
  v_cvt_pk_bf16_f32 v77, v193, v195
  v_and_b32 v8, 15, v1
  v_cmp_eq_u32 vcc, 0, v8
  s_nop 1
  v_cndmask_b32 v70, 0, v70, vcc
  v_cndmask_b32 v71, 0, v71, vcc
  v_cndmask_b32 v72, 0, v72, vcc
  v_cndmask_b32 v73, 0, v73, vcc
  v_cndmask_b32 v74, 0, v74, vcc
  v_cndmask_b32 v75, 0, v75, vcc
  v_cndmask_b32 v76, 0, v76, vcc
  v_cndmask_b32 v77, 0, v77, vcc
  buffer_store_dwordx4 v[70:73], v9, s[44:47], s57 offen sc1
  buffer_store_dwordx4 v[74:77], v9, s[44:47], s57 offen offset:1024 sc1
  s_add_u32 s57, s57, 163840
  s_nop 1
  s_branch L_gv_late
L_gv_sa:
  v_cvt_pk_bf16_f32 v78, v60, v61
  v_cvt_pk_bf16_f32 v79, v62, v63
  v_cvt_pk_bf16_f32 v80, v64, v65
  v_cvt_pk_bf16_f32 v81, v66, v67
  v_lshrrev_b32 v9, 4, v1
  v_lshlrev_b32 v9, 4, v9
  s_mul_i32 s57, s56, 2688
  s_lshl_b32 s58, s3, 6
  s_add_u32 s57, s57, s58
  s_add_u32 s57, s57, 0x440000
  v_and_b32 v8, 15, v1
  v_cmp_eq_u32 s[62:63], 0, v8
  v_cvt_pk_bf16_f32 v70, v100, v102
  v_cvt_pk_bf16_f32 v74, v101, v103
  v_cvt_pk_bf16_f32 v71, v104, v106
  v_cvt_pk_bf16_f32 v75, v105, v107
  v_cvt_pk_bf16_f32 v72, v108, v110
  v_cvt_pk_bf16_f32 v76, v109, v111
  v_cvt_pk_bf16_f32 v73, v112, v114
  v_cvt_pk_bf16_f32 v77, v113, v115
  s_nop 0
  v_mfma_f32_16x16x32_bf16 v[84:87], v[70:73], v[78:81], 0
  v_mfma_f32_16x16x32_bf16 v[88:91], v[74:77], v[78:81], 0
  s_mov_b64 s[60:61], exec
  s_mov_b64 exec, s[62:63]
  s_nop 4
  buffer_store_dwordx4 v[84:87], v9, s[44:47], s57 offen sc1
  buffer_store_dwordx4 v[88:91], v9, s[44:47], s57 offen offset:1344 sc1
  s_mov_b64 exec, s[60:61]
  s_add_u32 s57, s57, 256
  s_nop 1
  v_cvt_pk_bf16_f32 v70, v116, v118
  v_cvt_pk_bf16_f32 v74, v117, v119
  v_cvt_pk_bf16_f32 v71, v120, v122
  v_cvt_pk_bf16_f32 v75, v121, v123
  v_cvt_pk_bf16_f32 v72, v124, v126
  v_cvt_pk_bf16_f32 v76, v125, v127
  v_cvt_pk_bf16_f32 v73, v128, v130
  v_cvt_pk_bf16_f32 v77, v129, v131
  s_nop 0
  v_mfma_f32_16x16x32_bf16 v[84:87], v[70:73], v[78:81], 0
  v_mfma_f32_16x16x32_bf16 v[88:91], v[74:77], v[78:81], 0
  s_mov_b64 s[60:61], exec
  s_mov_b64 exec, s[62:63]
  s_nop 4
  buffer_store_dwordx4 v[84:87], v9, s[44:47], s57 offen sc1
  buffer_store_dwordx4 v[88:91], v9, s[44:47], s57 offen offset:1344 sc1
  s_mov_b64 exec, s[60:61]
  s_add_u32 s57, s57, 256
  s_nop 1
  v_cvt_pk_bf16_f32 v70, v132, v134
  v_cvt_pk_bf16_f32 v74, v133, v135
  v_cvt_pk_bf16_f32 v71, v136, v138
  v_cvt_pk_bf16_f32 v75, v137, v139
  v_cvt_pk_bf16_f32 v72, v140, v142
  v_cvt_pk_bf16_f32 v76, v141, v143
  v_cvt_pk_bf16_f32 v73, v144, v146
  v_cvt_pk_bf16_f32 v77, v145, v147
  s_nop 0
  v_mfma_f32_16x16x32_bf16 v[84:87], v[70:73], v[78:81], 0
  v_mfma_f32_16x16x32_bf16 v[88:91], v[74:77], v[78:81], 0
  s_mov_b64 s[60:61], exec
  s_mov_b64 exec, s[62:63]
  s_nop 4
  buffer_store_dwordx4 v[84:87], v9, s[44:47], s57 offen sc1
  buffer_store_dwordx4 v[88:91], v9, s[44:47], s57 offen offset:1344 sc1
  s_mov_b64 exec, s[60:61]
  s_add_u32 s57, s57, 256
  s_nop 1
  v_cvt_pk_bf16_f32 v70, v148, v150
  v_cvt_pk_bf16_f32 v74, v149, v151
  v_cvt_pk_bf16_f32 v71, v152, v154
  v_cvt_pk_bf16_f32 v75, v153, v155
  v_cvt_pk_bf16_f32 v72, v156, v158
  v_cvt_pk_bf16_f32 v76, v157, v159
  v_cvt_pk_bf16_f32 v73, v160, v162
  v_cvt_pk_bf16_f32 v77, v161, v163
  s_nop 0
  v_mfma_f32_16x16x32_bf16 v[84:87], v[70:73], v[78:81], 0
  v_mfma_f32_16x16x32_bf16 v[88:91], v[74:77], v[78:81], 0
  s_mov_b64 s[60:61], exec
  s_mov_b64 exec, s[62:63]
  s_nop 4
  buffer_store_dwordx4 v[84:87], v9, s[44:47], s57 offen sc1
  buffer_store_dwordx4 v[88:91], v9, s[44:47], s57 offen offset:1344 sc1
  s_mov_b64 exec, s[60:61]
  s_add_u32 s57, s57, 256
  s_nop 1
  v_cvt_pk_bf16_f32 v70, v164, v166
  v_cvt_pk_bf16_f32 v74, v165, v167
  v_cvt_pk_bf16_f32 v71, v168, v170
  v_cvt_pk_bf16_f32 v75, v169, v171
  v_cvt_pk_bf16_f32 v72, v172, v174
  v_cvt_pk_bf16_f32 v76, v173, v175
  v_cvt_pk_bf16_f32 v73, v176, v178
  v_cvt_pk_bf16_f32 v77, v177, v179
  s_nop 0
  v_mfma_f32_16x16x32_bf16 v[84:87], v[70:73], v[78:81], 0
  v_mfma_f32_16x16x32_bf16 v[88:91], v[74:77], v[78:81], 0
  s_mov_b64 s[60:61], exec
  s_mov_b64 exec, s[62:63]
  s_nop 4
  buffer_store_dwordx4 v[84:87], v9, s[44:47], s57 offen sc1
  buffer_store_dwordx4 v[88:91], v9, s[44:47], s57 offen offset:1344 sc1
  s_mov_b64 exec, s[60:61]
  s_add_u32 s57, s57, 256
  s_nop 1
  s_cmp_lg_u32 s3, 0
  s_cbranch_scc1 L_gv_late
  v_cvt_pk_bf16_f32 v70, v180, v182
  v_cvt_pk_bf16_f32 v74, v181, v183
  v_cvt_pk_bf16_f32 v71, v184, v186
  v_cvt_pk_bf16_f32 v75, v185, v187
  v_cvt_pk_bf16_f32 v72, v188, v190
  v_cvt_pk_bf16_f32 v76, v189, v191
  v_cvt_pk_bf16_f32 v73, v192, v194
  v_cvt_pk_bf16_f32 v77, v193, v195
  v_and_b32 v8, 15, v1
  v_cmp_eq_u32 vcc, 0, v8
  s_nop 1
  v_cndmask_b32 v70, 0, v70, vcc
  v_cndmask_b32 v71, 0, v71, vcc
  v_cndmask_b32 v72, 0, v72, vcc
  v_cndmask_b32 v73, 0, v73, vcc
  v_cndmask_b32 v74, 0, v74, vcc
  v_cndmask_b32 v75, 0, v75, vcc
  v_cndmask_b32 v76, 0, v76, vcc
  v_cndmask_b32 v77, 0, v77, vcc
  v_mfma_f32_16x16x32_bf16 v[84:87], v[70:73], v[78:81], 0
  s_nop 0
  v_mfma_f32_16x16x32_bf16 v[88:91], v[74:77], v[78:81], 0
  s_mov_b64 s[60:61], exec
  s_mov_b64 exec, s[62:63]
  s_nop 3
  buffer_store_dwordx4 v[84:87], v9, s[44:47], s57 offen sc1
  s_nop 0
  buffer_store_dwordx4 v[88:91], v9, s[44:47], s57 offen offset:1344 sc1
  s_mov_b64 exec, s[60:61]
  s_add_u32 s57, s57, 256
  s_nop 1
L_gv_late:
  s_branch L_arr1
L_p1_idle:
  s_waitcnt lgkmcnt(0)
  s_mov_b32 s4, s64
  s_mov_b32 s5, s65
  s_mov_b32 s6, 0x280000
  s_mov_b32 s7, 0x00020000
  s_mov_b32 s8, s66
  s_mov_b32 s9, s67
  s_mov_b32 s10, 0x141000
  s_mov_b32 s11, 0x00020000
  s_mov_b32 s12, s68
  s_mov_b32 s13, s69
  s_mov_b32 s14, 0x141000
  s_mov_b32 s15, 0x00020000
  s_mov_b32 s16, s72
  s_mov_b32 s17, s73
  s_mov_b32 s18, 0x21c000
  s_mov_b32 s19, 0x00020000
  s_mov_b32 s20, s74
  s_mov_b32 s21, s75
  s_mov_b32 s22, 0x21c000
  s_mov_b32 s23, 0x00020000
  s_mov_b32 s24, s76
  s_mov_b32 s25, s77
  s_mov_b32 s26, 0x21c000
  s_mov_b32 s27, 0x00020000
  s_mov_b32 s28, s78
  s_mov_b32 s29, s79
  s_mov_b32 s30, 0x500
  s_mov_b32 s31, 0x00020000
  s_mov_b32 s32, s80
  s_mov_b32 s33, s81
  s_mov_b32 s34, 0x4b0000
  s_mov_b32 s35, 0x00020000
  s_mov_b32 s36, s82
  s_mov_b32 s37, s83
  s_mov_b32 s38, 0x280000
  s_mov_b32 s39, 0x00020000
  s_mov_b32 s40, s84
  s_mov_b32 s41, s85
  s_mov_b32 s42, 0x100
  s_mov_b32 s43, 0x00020000
  s_mov_b32 s44, s86
  s_mov_b32 s45, s87
  s_mov_b32 s46, 0x1c80000
  s_mov_b32 s47, 0x00020000
  s_sub_u32 s55, s54, 120
  s_lshl_b32 s55, s55, 14
  s_lshl_b32 s56, s3, 12
  s_add_u32 s55, s55, s56
  s_add_u32 s55, s55, 0x1700000
  v_lshlrev_b32 v2, 4, v1
  v_mov_b32 v4, 0
  v_mov_b32 v5, 0
  v_mov_b32 v6, 0
  v_mov_b32 v7, 0
  buffer_store_dwordx4 v[4:7], v2, s[44:47], s55 offen offset:0 sc1
  buffer_store_dwordx4 v[4:7], v2, s[44:47], s55 offen offset:1024 sc1
  buffer_store_dwordx4 v[4:7], v2, s[44:47], s55 offen offset:2048 sc1
  buffer_store_dwordx4 v[4:7], v2, s[44:47], s55 offen offset:3072 sc1
  s_waitcnt vmcnt(0)
  s_barrier
  s_cmp_lg_u32 s3, 0
  s_cbranch_scc1 L_nw0_1
  v_mov_b32 v2, 1
  v_mov_b32 v3, 0
  s_mov_b64 s[50:51], exec
  s_mov_b64 exec, 1
  buffer_atomic_add v2, v3, s[40:43], 0 offen sc1
  s_mov_b64 exec, s[50:51]
L_nw0_1:
L_arr1:
  v_mov_b32 v3, 0
  s_cmp_lg_u32 s3, 0
  s_cbranch_scc1 L_nw0_2
  buffer_load_dword v2, v3, s[40:43], 0 offen sc1
L_nw0_2:
  s_waitcnt vmcnt(0) lgkmcnt(0)
  s_barrier
  s_cmp_lg_u32 s3, 0
  s_cbranch_scc1 L_nw0_3
  s_mov_b32 s49, 0
L_ini_4:
  v_readfirstlane_b32 s48, v2
  s_cmp_ge_u32 s48, 8
  s_cbranch_scc1 L_iniok_5
  s_add_u32 s49, s49, 1
  s_cmp_gt_u32 s49, 100000
  s_cbranch_scc1 L_iniok_5
  buffer_load_dword v2, v3, s[40:43], 0 offen sc1
  s_waitcnt vmcnt(0)
  s_branch L_ini_4
L_iniok_5:
  s_lshr_b32 s48, s2, 4
  s_lshl_b32 s48, s48, 8
  s_add_u32 s48, s48, 0x1700000
  v_lshlrev_b32 v3, 12, v1
  v_mov_b32 v2, 1
  s_mov_b64 s[50:51], exec
  s_mov_b64 exec, 0xff
  buffer_atomic_add v2, v3, s[44:47], s48 offen sc1
  s_mov_b64 exec, s[50:51]
L_nw0_3:
  s_cmp_ge_u32 s2, 216
  s_cbranch_scc1 L_rp13_i_done
  s_lshr_b32 s52, s2, 3
  s_and_b32 s53, s2, 7
  v_lshrrev_b32 v4, 3, v1
  v_and_b32 v5, 7, v1
  v_mul_u32_u24 v4, 3456, v4
  v_lshl_add_u32 v4, v5, 4, v4
  s_and_b32 s54, s3, 1
  s_mul_i32 s54, s54, 40
  s_mul_i32 s55, s53, 80
  s_add_u32 s54, s54, s55
  s_mul_i32 s54, s54, 3456
  s_lshl_b32 s55, s52, 7
  s_add_u32 s54, s54, s55
  s_mul_i32 s55, s3, 5120
  s_add_u32 s55, s55, 107520
  s_cmp_ge_u32 s3, 2
  s_cbranch_scc1 L_rp13_w3
  s_add_u32 m0, s55, 0
  s_nop 0
  buffer_load_dwordx4 v4, s[16:19], s54 offen lds
  s_add_u32 s54, s54, 27648
  s_add_u32 m0, s55, 1024
  s_nop 0
  buffer_load_dwordx4 v4, s[16:19], s54 offen lds
  s_add_u32 s54, s54, 27648
  s_add_u32 m0, s55, 2048
  s_nop 0
  buffer_load_dwordx4 v4, s[16:19], s54 offen lds
  s_add_u32 s54, s54, 27648
  s_add_u32 m0, s55, 3072
  s_nop 0
  buffer_load_dwordx4 v4, s[16:19], s54 offen lds
  s_add_u32 s54, s54, 27648
  s_add_u32 m0, s55, 4096
  s_nop 0
  buffer_load_dwordx4 v4, s[16:19], s54 offen lds
  s_add_u32 s54, s54, 27648
  s_branch L_rp13_i_done
L_rp13_w3:
  s_add_u32 m0, s55, 0
  s_nop 0
  buffer_load_dwordx4 v4, s[20:23], s54 offen lds
  s_add_u32 s54, s54, 27648
  s_add_u32 m0, s55, 1024
  s_nop 0
  buffer_load_dwordx4 v4, s[20:23], s54 offen lds
  s_add_u32 s54, s54, 27648
  s_add_u32 m0, s55, 2048
  s_nop 0
  buffer_load_dwordx4 v4, s[20:23], s54 offen lds
  s_add_u32 s54, s54, 27648
  s_add_u32 m0, s55, 3072
  s_nop 0
  buffer_load_dwordx4 v4, s[20:23], s54 offen lds
  s_add_u32 s54, s54, 27648
  s_add_u32 m0, s55, 4096
  s_nop 0
  buffer_load_dwordx4 v4, s[20:23], s54 offen lds
  s_add_u32 s54, s54, 27648
L_rp13_i_done:
  s_cmp_ge_u32 s95, 28
  s_cbranch_scc1 L_b1_now
  s_cmp_eq_u32 s3, 3
  s_cbranch_scc1 L_b1_now
  s_cmp_lt_u32 s95, 16
  s_cbranch_scc1 L_b1_now
  s_mov_b32 s58, 642
  v_lshrrev_b32 v2, 4, v1
  v_bfe_u32 v3, v1, 2, 2
  v_and_b32 v4, 3, v1
  v_lshlrev_b32 v2, 6, v2
  v_lshl_add_u32 v2, v3, 8, v2
  v_lshlrev_b32 v4, 4, v4
  s_lshl_b32 s59, s92, 5
  v_mov_b32 v5, s59
  s_movk_i32 s59, 642
  s_lshl_b32 s60, s3, 13
  s_add_u32 s60, s60, 82944
  s_add_u32 s61, s93, 0
  v_add_u32 v6, s61, v2
  v_and_b32 v6, 2047, v6
  v_mad_u32_u24 v7, v6, s59, v5
  v_and_b32 v7, -4, v7
  v_min_u32 v7, 1314752, v7
  v_add_u32 v7, v7, v4
  s_add_u32 s61, s93, 1024
  v_add_u32 v6, s61, v2
  v_and_b32 v6, 2047, v6
  v_mad_u32_u24 v8, v6, s59, v5
  v_and_b32 v8, -4, v8
  v_min_u32 v8, 1314752, v8
  v_add_u32 v8, v8, v4
  s_add_u32 s61, s94, 0
  v_add_u32 v6, s61, v2
  v_and_b32 v6, 2047, v6
  v_mad_u32_u24 v9, v6, s59, v5
  v_and_b32 v9, -4, v9
  v_min_u32 v9, 1314752, v9
  v_add_u32 v9, v9, v4
  s_add_u32 s61, s94, 1024
  v_add_u32 v6, s61, v2
  v_and_b32 v6, 2047, v6
  v_mad_u32_u24 v10, v6, s59, v5
  v_and_b32 v10, -4, v10
  v_min_u32 v10, 1314752, v10
  v_add_u32 v10, v10, v4
  s_add_u32 m0, s60, 0
  s_nop 0
  buffer_load_dwordx4 v7, s[8:11], 0 offen lds
  s_add_u32 m0, s60, 1024
  s_nop 0
  buffer_load_dwordx4 v8, s[8:11], 0 offen lds
  s_add_u32 m0, s60, 2048
  s_nop 0
  buffer_load_dwordx4 v9, s[8:11], 0 offen lds
  s_add_u32 m0, s60, 3072
  s_nop 0
  buffer_load_dwordx4 v10, s[8:11], 0 offen lds
  s_add_u32 m0, s60, 4096
  s_nop 0
  buffer_load_dwordx4 v7, s[12:15], 0 offen lds
  s_add_u32 m0, s60, 5120
  s_nop 0
  buffer_load_dwordx4 v8, s[12:15], 0 offen lds
  s_add_u32 m0, s60, 6144
  s_nop 0
  buffer_load_dwordx4 v9, s[12:15], 0 offen lds
  s_add_u32 m0, s60, 7168
  s_nop 0
  buffer_load_dwordx4 v10, s[12:15], 0 offen lds
L_b1_now:
  s_cmp_ge_u32 s95, 28
  s_cbranch_scc1 L_cs_end
  v_and_b32 v4, 15, v1
  v_lshrrev_b32 v5, 4, v1
  v_lshlrev_b32 v6, 2, v5
  v_cvt_f32_u32 v6, v6
  v_mul_f32 v6, 0x3a000000, v6
  s_and_b32 s56, s3, 1
  s_cmp_eq_u32 s56, 0
  s_cselect_b32 s57, s93, s94
  s_lshr_b32 s56, s3, 1
  s_cmp_eq_u32 s56, 0
  s_mov_b32 s60, 0x42800000
  s_cselect_b32 s58, 1.0, s60
  s_cselect_b32 s59, s60, 1.0
  s_cselect_b32 s61, 0, 0x3a000000
  s_cselect_b32 s62, 1.0, 0
  v_cvt_f32_u32 v9, s57
  v_mul_f32 v18, s61, v9
  v_mul_f32 v9, s62, v9
  v_fma_f32 v10, v6, s58, v18
  v_add_f32 v11, 0x3a000000, v6
  v_fma_f32 v11, v11, s58, v18
  v_add_f32 v12, 0x3a800000, v6
  v_fma_f32 v12, v12, s58, v18
  v_add_f32 v13, 0x3ac00000, v6
  v_fma_f32 v13, v13, s58, v18
  v_add_f32 v14, 0x3c000000, v6
  v_fma_f32 v14, v14, s58, v18
  v_add_f32 v15, 0x3c080000, v6
  v_fma_f32 v15, v15, s58, v18
  v_add_f32 v16, 0x3c100000, v6
  v_fma_f32 v16, v16, s58, v18
  v_add_f32 v17, 0x3c180000, v6
  v_fma_f32 v17, v17, s58, v18
  v_cvt_f32_u32 v7, v4
  v_add_f32 v8, 0x41800000, v7
  s_lshl_b32 s56, s3, 12
  s_add_u32 s56, s56, 128000
  v_lshlrev_b32 v46, 4, v1
  v_add_u32 v47, s56, v46
  v_fma_f32 v19, v7, s59, v9
  v_mul_f32 v20, v19, v10
  v_mul_f32 v21, v19, v11
  v_mul_f32 v22, v19, v12
  v_mul_f32 v23, v19, v13
  v_mul_f32 v24, v19, v14
  v_mul_f32 v25, v19, v15
  v_mul_f32 v26, v19, v16
  v_mul_f32 v27, v19, v17
  v_sin_f32 v28, v20
  v_sin_f32 v29, v21
  v_sin_f32 v30, v22
  v_sin_f32 v31, v23
  v_sin_f32 v32, v24
  v_sin_f32 v33, v25
  v_sin_f32 v34, v26
  v_sin_f32 v35, v27
  v_cos_f32 v20, v20
  v_cos_f32 v21, v21
  v_cos_f32 v22, v22
  v_cos_f32 v23, v23
  v_cos_f32 v24, v24
  v_cos_f32 v25, v25
  v_cos_f32 v26, v26
  v_cos_f32 v27, v27
  v_cvt_pk_bf16_f32 v36, v20, v21
  v_cvt_pk_bf16_f32 v37, v22, v23
  v_cvt_pk_bf16_f32 v38, v24, v25
  v_cvt_pk_bf16_f32 v39, v26, v27
  v_cvt_pk_bf16_f32 v40, v28, v29
  v_cvt_pk_bf16_f32 v41, v30, v31
  v_cvt_pk_bf16_f32 v42, v32, v33
  v_cvt_pk_bf16_f32 v43, v34, v35
  ds_write_b128 v47, v[36:39] offset:0
  ds_write_b128 v47, v[40:43] offset:1024
  v_fma_f32 v19, v8, s59, v9
  v_mul_f32 v20, v19, v10
  v_mul_f32 v21, v19, v11
  v_mul_f32 v22, v19, v12
  v_mul_f32 v23, v19, v13
  v_mul_f32 v24, v19, v14
  v_mul_f32 v25, v19, v15
  v_mul_f32 v26, v19, v16
  v_mul_f32 v27, v19, v17
  v_sin_f32 v28, v20
  v_sin_f32 v29, v21
  v_sin_f32 v30, v22
  v_sin_f32 v31, v23
  v_sin_f32 v32, v24
  v_sin_f32 v33, v25
  v_sin_f32 v34, v26
  v_sin_f32 v35, v27
  v_cos_f32 v20, v20
  v_cos_f32 v21, v21
  v_cos_f32 v22, v22
  v_cos_f32 v23, v23
  v_cos_f32 v24, v24
  v_cos_f32 v25, v25
  v_cos_f32 v26, v26
  v_cos_f32 v27, v27
  v_cvt_pk_bf16_f32 v48, v20, v21
  v_cvt_pk_bf16_f32 v49, v22, v23
  v_cvt_pk_bf16_f32 v50, v24, v25
  v_cvt_pk_bf16_f32 v51, v26, v27
  v_cvt_pk_bf16_f32 v52, v28, v29
  v_cvt_pk_bf16_f32 v53, v30, v31
  v_cvt_pk_bf16_f32 v54, v32, v33
  v_cvt_pk_bf16_f32 v55, v34, v35
  ds_write_b128 v47, v[48:51] offset:2048
  ds_write_b128 v47, v[52:55] offset:3072
  s_waitcnt lgkmcnt(0)
  s_barrier
  s_cmp_eq_u32 s3, 3
  s_cbranch_scc1 L_cs_end
  v_add_u32 v46, 128000, v46
  ds_read_b128 a[160:163], v46 offset:0
  ds_read_b128 a[164:167], v46 offset:1024
  ds_read_b128 a[168:171], v46 offset:2048
  ds_read_b128 a[172:175], v46 offset:3072
  ds_read_b128 a[176:179], v46 offset:4096
  ds_read_b128 a[180:183], v46 offset:5120
  ds_read_b128 a[184:187], v46 offset:6144
  ds_read_b128 a[188:191], v46 offset:7168
  ds_read_b128 a[192:195], v46 offset:8192
  ds_read_b128 a[196:199], v46 offset:9216
  ds_read_b128 a[200:203], v46 offset:10240
  ds_read_b128 a[204:207], v46 offset:11264
  ds_read_b128 a[208:211], v46 offset:12288
  ds_read_b128 a[212:215], v46 offset:13312
  ds_read_b128 a[216:219], v46 offset:14336
  ds_read_b128 a[220:223], v46 offset:15360
L_cs_end:
  s_waitcnt lgkmcnt(0)
  s_cmp_ge_u32 s95, 28
  s_cbranch_scc1 L_wd_end
  s_cmp_eq_u32 s3, 3
  s_cbranch_scc1 L_wd_end
  v_and_b32 v4, 15, v1
  v_lshrrev_b32 v5, 4, v1
  s_lshl_b32 s60, s3, 13
  s_add_u32 s60, s60, 82944
  v_lshlrev_b32 v6, 6, v5
  v_lshl_add_u32 v6, v4, 1, v6
  v_add_u32 v6, s60, v6
  s_and_b32 s61, s93, 1
  s_lshl_b32 s61, s61, 1
  v_add_u32 v10, s61, v6
  s_and_b32 s61, s94, 1
  s_lshl_b32 s61, s61, 1
  v_add_u32 v11, s61, v6
  s_lshl_b32 s59, s92, 5
  v_mov_b32 v7, s59
  s_mov_b32 s58, 642
  v_lshl_add_u32 v8, v5, 8, s94
  v_and_b32 v8, 2047, v8
  v_mad_u32_u24 v8, v8, s58, v7
  v_and_b32 v9, -4, v8
  v_min_u32 v9, 1314752, v9
  v_sub_u32 v8, v8, v9
  v_add_u32 v12, v8, v6
  v_mov_b32 v200, 0
  v_mov_b32 v201, 0
  v_mov_b32 v202, 0
  v_mov_b32 v203, 0
  v_mov_b32 v204, 0
  v_mov_b32 v205, 0
  v_mov_b32 v206, 0
  v_mov_b32 v207, 0
  v_mov_b32 v208, 0
  v_mov_b32 v209, 0
  v_mov_b32 v210, 0
  v_mov_b32 v211, 0
  v_mov_b32 v212, 0
  v_mov_b32 v213, 0
  v_mov_b32 v214, 0
  v_mov_b32 v215, 0
  v_mov_b32 v216, 0
  v_mov_b32 v217, 0
  v_mov_b32 v218, 0
  v_mov_b32 v219, 0
  v_mov_b32 v220, 0
  v_mov_b32 v221, 0
  v_mov_b32 v222, 0
  v_mov_b32 v223, 0
  v_mov_b32 v224, 0
  v_mov_b32 v225, 0
  v_mov_b32 v226, 0
  v_mov_b32 v227, 0
  v_mov_b32 v228, 0
  v_mov_b32 v229, 0
  v_mov_b32 v230, 0
  v_mov_b32 v231, 0
  s_waitcnt vmcnt(0)
  ds_read_u16_d16_hi v200, v10 offset:0
  ds_read_u16_d16_hi v208, v10 offset:4096
  ds_read_u16_d16_hi v201, v10 offset:256
  ds_read_u16_d16_hi v209, v10 offset:4352
  ds_read_u16_d16_hi v202, v10 offset:512
  ds_read_u16_d16_hi v210, v10 offset:4608
  ds_read_u16_d16_hi v203, v10 offset:768
  ds_read_u16_d16_hi v211, v10 offset:4864
  ds_read_u16_d16_hi v204, v10 offset:1024
  ds_read_u16_d16_hi v212, v10 offset:5120
  ds_read_u16_d16_hi v205, v10 offset:1280
  ds_read_u16_d16_hi v213, v10 offset:5376
  ds_read_u16_d16_hi v206, v10 offset:1536
  ds_read_u16_d16_hi v214, v10 offset:5632
  ds_read_u16_d16_hi v207, v10 offset:1792
  ds_read_u16_d16_hi v215, v10 offset:5888
  ds_read_u16_d16_hi v216, v12 offset:2048
  ds_read_u16_d16_hi v224, v12 offset:6144
  ds_read_u16_d16_hi v217, v11 offset:2304
  ds_read_u16_d16_hi v225, v11 offset:6400
  ds_read_u16_d16_hi v218, v11 offset:2560
  ds_read_u16_d16_hi v226, v11 offset:6656
  ds_read_u16_d16_hi v219, v11 offset:2816
  ds_read_u16_d16_hi v227, v11 offset:6912
  ds_read_u16_d16_hi v220, v11 offset:3072
  ds_read_u16_d16_hi v228, v11 offset:7168
  ds_read_u16_d16_hi v221, v11 offset:3328
  ds_read_u16_d16_hi v229, v11 offset:7424
  ds_read_u16_d16_hi v222, v11 offset:3584
  ds_read_u16_d16_hi v230, v11 offset:7680
  ds_read_u16_d16_hi v223, v11 offset:3840
  ds_read_u16_d16_hi v231, v11 offset:7936
  s_waitcnt lgkmcnt(0)
L_wd_end:
  s_cmp_lg_u32 s3, 0
  s_cbranch_scc1 L_nw0_6
  v_and_b32 v3, 15, v1
  v_lshlrev_b32 v3, 8, v3
  s_and_b32 s48, s2, 7
  s_mul_i32 s48, s48, 4096
  s_add_u32 s48, s48, 0x1700000
  s_mov_b32 s49, 0
L_poll_7:
  s_add_u32 s49, s49, 1
  s_cmp_gt_u32 s49, 100000
  s_cbranch_scc1 L_pexit_8
  buffer_load_dword v2, v3, s[44:47], s48 offen sc1
  s_waitcnt vmcnt(0)
  v_cmp_gt_u32 vcc, 16, v2
  s_nop 4
  s_cbranch_vccz L_pexit_8
  s_branch L_poll_7
L_pexit_8:
L_nw0_6:
  s_waitcnt vmcnt(0)
  s_barrier
  s_cmp_ge_u32 s95, 28
  s_cbranch_scc1 L_p2_done
  v_lshlrev_b32 v2, 4, v1
  s_lshr_b32 s56, s3, 1
  s_lshl_b32 s57, s56, 5
  s_add_u32 s57, s57, s90
  s_mul_i32 s57, s57, 40960
  s_and_b32 s58, s3, 1
  s_lshl_b32 s58, s58, 10
  s_add_u32 s57, s57, s58
  s_mul_i32 s56, s56, 40960
  s_add_u32 s58, s58, s56
  s_mul_i32 s59, s92, 40960
  s_add_u32 s59, s59, 0x280000
  s_cmp_eq_u32 s3, 3
  s_cbranch_scc1 L_p2_w3
  s_cmp_lg_u32 s90, 0
  s_cbranch_scc1 L_p2_nosa
  v_and_b32 v4, 15, v1
  v_lshrrev_b32 v5, 4, v1
  v_mul_u32_u24 v10, 13440, v5
  v_lshl_add_u32 v10, v4, 2, v10
  s_lshl_b32 s60, s92, 6
  s_add_u32 s60, s60, 0x440000
  buffer_load_dword v184, v10, s[44:47], s60 offen offset:0 sc1
  buffer_load_dword v185, v10, s[44:47], s60 offen offset:1344 sc1
  s_add_u32 s60, s60, 2688
  buffer_load_dword v186, v10, s[44:47], s60 offen offset:0 sc1
  buffer_load_dword v187, v10, s[44:47], s60 offen offset:1344 sc1
  s_add_u32 s60, s60, 2688
  buffer_load_dword v188, v10, s[44:47], s60 offen offset:0 sc1
  buffer_load_dword v189, v10, s[44:47], s60 offen offset:1344 sc1
  s_add_u32 s60, s60, 2688
  buffer_load_dword v190, v10, s[44:47], s60 offen offset:0 sc1
  buffer_load_dword v191, v10, s[44:47], s60 offen offset:1344 sc1
  s_add_u32 s60, s60, 2688
  buffer_load_dword v192, v10, s[44:47], s60 offen offset:0 sc1
  buffer_load_dword v193, v10, s[44:47], s60 offen offset:1344 sc1
  s_add_u32 s60, s60, 2688
L_p2_nosa:
  s_add_u32 m0, s58, 0
  s_nop 0
  buffer_load_dwordx4 v2, s[44:47], s57 offen sc1 lds
  buffer_load_dwordx4 v2, s[44:47], s57 offen offset:2048 sc1 lds
  s_add_u32 s57, s57, 4096
  s_add_u32 m0, s58, 4096
  s_nop 0
  buffer_load_dwordx4 v2, s[44:47], s57 offen sc1 lds
  buffer_load_dwordx4 v2, s[44:47], s57 offen offset:2048 sc1 lds
  s_add_u32 s57, s57, 4096
  buffer_load_dwordx4 a[0:3], v2, s[44:47], s59 offen sc1
  buffer_load_dwordx4 a[4:7], v2, s[44:47], s59 offen offset:1024 sc1
  buffer_load_dwordx4 a[8:11], v2, s[44:47], s59 offen offset:2048 sc1
  buffer_load_dwordx4 a[12:15], v2, s[44:47], s59 offen offset:3072 sc1
  s_add_u32 s59, s59, 4096
  buffer_load_dwordx4 a[16:19], v2, s[44:47], s59 offen sc1
  buffer_load_dwordx4 a[20:23], v2, s[44:47], s59 offen offset:1024 sc1
  s_add_u32 m0, s58, 8192
  s_nop 0
  buffer_load_dwordx4 v2, s[44:47], s57 offen sc1 lds
  buffer_load_dwordx4 v2, s[44:47], s57 offen offset:2048 sc1 lds
  s_add_u32 s57, s57, 4096
  s_add_u32 m0, s58, 12288
  s_nop 0
  buffer_load_dwordx4 v2, s[44:47], s57 offen sc1 lds
  buffer_load_dwordx4 v2, s[44:47], s57 offen offset:2048 sc1 lds
  s_add_u32 s57, s57, 4096
  buffer_load_dwordx4 a[24:27], v2, s[44:47], s59 offen offset:2048 sc1
  buffer_load_dwordx4 a[28:31], v2, s[44:47], s59 offen offset:3072 sc1
  s_add_u32 s59, s59, 4096
  buffer_load_dwordx4 a[32:35], v2, s[44:47], s59 offen sc1
  buffer_load_dwordx4 a[36:39], v2, s[44:47], s59 offen offset:1024 sc1
  buffer_load_dwordx4 a[40:43], v2, s[44:47], s59 offen offset:2048 sc1
  buffer_load_dwordx4 a[44:47], v2, s[44:47], s59 offen offset:3072 sc1
  s_add_u32 s59, s59, 4096
  v_and_b32 v4, 15, v1
  v_lshrrev_b32 v5, 4, v1
  v_lshrrev_b32 v6, 2, v4
  v_lshrrev_b32 v7, 1, v6
  v_xor_b32 v8, v6, v7
  v_and_b32 v8, 1, v8
  v_lshl_or_b32 v7, v8, 1, v7
  v_xor_b32 v7, v7, v5
  v_lshlrev_b32 v7, 4, v7
  v_lshl_add_u32 v3, v4, 6, v7
  v_add_u32 v9, 40960, v3
  s_waitcnt vmcnt(16)
  s_barrier
  ds_read_b128 v[40:43], v3 offset:0
  ds_read_b128 v[44:47], v3 offset:1024
  ds_read_b128 v[48:51], v9 offset:0
  ds_read_b128 v[52:55], v9 offset:1024
  ds_read_b128 v[56:59], v3 offset:2048
  ds_read_b128 v[60:63], v3 offset:3072
  ds_read_b128 v[64:67], v9 offset:2048
  ds_read_b128 v[68:71], v9 offset:3072
  s_waitcnt vmcnt(14) lgkmcnt(4)
  v_mfma_f32_16x16x32_bf16 v[72:75], v[40:43], a[0:3], 0
  v_mfma_f32_16x16x32_bf16 v[76:79], v[40:43], a[4:7], 0
  buffer_load_dwordx4 a[48:51], v2, s[44:47], s59 offen sc1
  v_mfma_f32_16x16x32_bf16 v[80:83], v[44:47], a[0:3], 0
  v_mfma_f32_16x16x32_bf16 v[84:87], v[44:47], a[4:7], 0
  buffer_load_dwordx4 a[52:55], v2, s[44:47], s59 offen offset:1024 sc1
  v_mfma_f32_16x16x32_bf16 v[88:91], v[48:51], a[0:3], 0
  v_mfma_f32_16x16x32_bf16 v[92:95], v[48:51], a[4:7], 0
  s_add_u32 m0, s58, 16384
  s_nop 0
  buffer_load_dwordx4 v2, s[44:47], s57 offen sc1 lds
  v_mfma_f32_16x16x32_bf16 v[96:99], v[52:55], a[0:3], 0
  v_mfma_f32_16x16x32_bf16 v[100:103], v[52:55], a[4:7], 0
  ds_read_b128 v[40:43], v3 offset:4096
  ds_read_b128 v[44:47], v3 offset:5120
  ds_read_b128 v[48:51], v9 offset:4096
  ds_read_b128 v[52:55], v9 offset:5120
  s_waitcnt vmcnt(15) lgkmcnt(4)
  v_mfma_f32_16x16x32_bf16 v[72:75], v[56:59], a[8:11], v[72:75]
  v_mfma_f32_16x16x32_bf16 v[76:79], v[56:59], a[12:15], v[76:79]
  buffer_load_dwordx4 v2, s[44:47], s57 offen offset:2048 sc1 lds
  s_add_u32 s57, s57, 4096
  v_mfma_f32_16x16x32_bf16 v[80:83], v[60:63], a[8:11], v[80:83]
  v_mfma_f32_16x16x32_bf16 v[84:87], v[60:63], a[12:15], v[84:87]
  s_add_u32 m0, s58, 20480
  s_nop 0
  buffer_load_dwordx4 v2, s[44:47], s57 offen sc1 lds
  v_mfma_f32_16x16x32_bf16 v[88:91], v[64:67], a[8:11], v[88:91]
  v_mfma_f32_16x16x32_bf16 v[92:95], v[64:67], a[12:15], v[92:95]
  buffer_load_dwordx4 v2, s[44:47], s57 offen offset:2048 sc1 lds
  s_add_u32 s57, s57, 4096
  v_mfma_f32_16x16x32_bf16 v[96:99], v[68:71], a[8:11], v[96:99]
  v_mfma_f32_16x16x32_bf16 v[100:103], v[68:71], a[12:15], v[100:103]
  ds_read_b128 v[56:59], v3 offset:6144
  ds_read_b128 v[60:63], v3 offset:7168
  ds_read_b128 v[64:67], v9 offset:6144
  ds_read_b128 v[68:71], v9 offset:7168
  s_waitcnt vmcnt(16) lgkmcnt(4)
  v_mfma_f32_16x16x32_bf16 v[72:75], v[40:43], a[16:19], v[72:75]
  v_mfma_f32_16x16x32_bf16 v[76:79], v[40:43], a[20:23], v[76:79]
  buffer_load_dwordx4 a[56:59], v2, s[44:47], s59 offen offset:2048 sc1
  v_mfma_f32_16x16x32_bf16 v[80:83], v[44:47], a[16:19], v[80:83]
  v_mfma_f32_16x16x32_bf16 v[84:87], v[44:47], a[20:23], v[84:87]
  buffer_load_dwordx4 a[60:63], v2, s[44:47], s59 offen offset:3072 sc1
  s_add_u32 s59, s59, 4096
  v_mfma_f32_16x16x32_bf16 v[88:91], v[48:51], a[16:19], v[88:91]
  v_mfma_f32_16x16x32_bf16 v[92:95], v[48:51], a[20:23], v[92:95]
  buffer_load_dwordx4 a[64:67], v2, s[44:47], s59 offen sc1
  v_mfma_f32_16x16x32_bf16 v[96:99], v[52:55], a[16:19], v[96:99]
  v_mfma_f32_16x16x32_bf16 v[100:103], v[52:55], a[20:23], v[100:103]
  s_waitcnt vmcnt(15)
  s_barrier
  ds_read_b128 v[40:43], v3 offset:8192
  ds_read_b128 v[44:47], v3 offset:9216
  ds_read_b128 v[48:51], v9 offset:8192
  ds_read_b128 v[52:55], v9 offset:9216
  s_waitcnt vmcnt(13) lgkmcnt(4)
  v_mfma_f32_16x16x32_bf16 v[72:75], v[56:59], a[24:27], v[72:75]
  v_mfma_f32_16x16x32_bf16 v[76:79], v[56:59], a[28:31], v[76:79]
  buffer_load_dwordx4 a[68:71], v2, s[44:47], s59 offen offset:1024 sc1
  v_mfma_f32_16x16x32_bf16 v[80:83], v[60:63], a[24:27], v[80:83]
  v_mfma_f32_16x16x32_bf16 v[84:87], v[60:63], a[28:31], v[84:87]
  buffer_load_dwordx4 a[72:75], v2, s[44:47], s59 offen offset:2048 sc1
  v_mfma_f32_16x16x32_bf16 v[88:91], v[64:67], a[24:27], v[88:91]
  v_mfma_f32_16x16x32_bf16 v[92:95], v[64:67], a[28:31], v[92:95]
  buffer_load_dwordx4 a[76:79], v2, s[44:47], s59 offen offset:3072 sc1
  s_add_u32 s59, s59, 4096
  v_mfma_f32_16x16x32_bf16 v[96:99], v[68:71], a[24:27], v[96:99]
  v_mfma_f32_16x16x32_bf16 v[100:103], v[68:71], a[28:31], v[100:103]
  ds_read_b128 v[56:59], v3 offset:10240
  ds_read_b128 v[60:63], v3 offset:11264
  ds_read_b128 v[64:67], v9 offset:10240
  ds_read_b128 v[68:71], v9 offset:11264
  s_waitcnt vmcnt(14) lgkmcnt(4)
  v_mfma_f32_16x16x32_bf16 v[72:75], v[40:43], a[32:35], v[72:75]
  v_mfma_f32_16x16x32_bf16 v[76:79], v[40:43], a[36:39], v[76:79]
  buffer_load_dwordx4 a[80:83], v2, s[44:47], s59 offen sc1
  v_mfma_f32_16x16x32_bf16 v[80:83], v[44:47], a[32:35], v[80:83]
  v_mfma_f32_16x16x32_bf16 v[84:87], v[44:47], a[36:39], v[84:87]
  buffer_load_dwordx4 a[84:87], v2, s[44:47], s59 offen offset:1024 sc1
  v_mfma_f32_16x16x32_bf16 v[88:91], v[48:51], a[32:35], v[88:91]
  v_mfma_f32_16x16x32_bf16 v[92:95], v[48:51], a[36:39], v[92:95]
  s_add_u32 m0, s58, 24576
  s_nop 0
  buffer_load_dwordx4 v2, s[44:47], s57 offen sc1 lds
  v_mfma_f32_16x16x32_bf16 v[96:99], v[52:55], a[32:35], v[96:99]
  v_mfma_f32_16x16x32_bf16 v[100:103], v[52:55], a[36:39], v[100:103]
  ds_read_b128 v[40:43], v3 offset:12288
  ds_read_b128 v[44:47], v3 offset:13312
  ds_read_b128 v[48:51], v9 offset:12288
  ds_read_b128 v[52:55], v9 offset:13312
  s_waitcnt vmcnt(15) lgkmcnt(4)
  v_mfma_f32_16x16x32_bf16 v[72:75], v[56:59], a[40:43], v[72:75]
  v_mfma_f32_16x16x32_bf16 v[76:79], v[56:59], a[44:47], v[76:79]
  buffer_load_dwordx4 v2, s[44:47], s57 offen offset:2048 sc1 lds
  s_add_u32 s57, s57, 4096
  v_mfma_f32_16x16x32_bf16 v[80:83], v[60:63], a[40:43], v[80:83]
  v_mfma_f32_16x16x32_bf16 v[84:87], v[60:63], a[44:47], v[84:87]
  s_add_u32 m0, s58, 28672
  s_nop 0
  buffer_load_dwordx4 v2, s[44:47], s57 offen sc1 lds
  v_mfma_f32_16x16x32_bf16 v[88:91], v[64:67], a[40:43], v[88:91]
  v_mfma_f32_16x16x32_bf16 v[92:95], v[64:67], a[44:47], v[92:95]
  buffer_load_dwordx4 v2, s[44:47], s57 offen offset:2048 sc1 lds
  s_add_u32 s57, s57, 4096
  v_mfma_f32_16x16x32_bf16 v[96:99], v[68:71], a[40:43], v[96:99]
  v_mfma_f32_16x16x32_bf16 v[100:103], v[68:71], a[44:47], v[100:103]
  ds_read_b128 v[56:59], v3 offset:14336
  ds_read_b128 v[60:63], v3 offset:15360
  ds_read_b128 v[64:67], v9 offset:14336
  ds_read_b128 v[68:71], v9 offset:15360
  s_waitcnt vmcnt(16) lgkmcnt(4)
  v_mfma_f32_16x16x32_bf16 v[72:75], v[40:43], a[48:51], v[72:75]
  v_mfma_f32_16x16x32_bf16 v[76:79], v[40:43], a[52:55], v[76:79]
  buffer_load_dwordx4 a[88:91], v2, s[44:47], s59 offen offset:2048 sc1
  v_mfma_f32_16x16x32_bf16 v[80:83], v[44:47], a[48:51], v[80:83]
  v_mfma_f32_16x16x32_bf16 v[84:87], v[44:47], a[52:55], v[84:87]
  buffer_load_dwordx4 a[92:95], v2, s[44:47], s59 offen offset:3072 sc1
  s_add_u32 s59, s59, 4096
  v_mfma_f32_16x16x32_bf16 v[88:91], v[48:51], a[48:51], v[88:91]
  v_mfma_f32_16x16x32_bf16 v[92:95], v[48:51], a[52:55], v[92:95]
  buffer_load_dwordx4 a[96:99], v2, s[44:47], s59 offen sc1
  v_mfma_f32_16x16x32_bf16 v[96:99], v[52:55], a[48:51], v[96:99]
  v_mfma_f32_16x16x32_bf16 v[100:103], v[52:55], a[52:55], v[100:103]
  s_waitcnt vmcnt(15)
  s_barrier
  ds_read_b128 v[40:43], v3 offset:16384
  ds_read_b128 v[44:47], v3 offset:17408
  ds_read_b128 v[48:51], v9 offset:16384
  ds_read_b128 v[52:55], v9 offset:17408
  s_waitcnt vmcnt(13) lgkmcnt(4)
  v_mfma_f32_16x16x32_bf16 v[72:75], v[56:59], a[56:59], v[72:75]
  v_mfma_f32_16x16x32_bf16 v[76:79], v[56:59], a[60:63], v[76:79]
  buffer_load_dwordx4 a[100:103], v2, s[44:47], s59 offen offset:1024 sc1
  v_mfma_f32_16x16x32_bf16 v[80:83], v[60:63], a[56:59], v[80:83]
  v_mfma_f32_16x16x32_bf16 v[84:87], v[60:63], a[60:63], v[84:87]
  buffer_load_dwordx4 a[104:107], v2, s[44:47], s59 offen offset:2048 sc1
  v_mfma_f32_16x16x32_bf16 v[88:91], v[64:67], a[56:59], v[88:91]
  v_mfma_f32_16x16x32_bf16 v[92:95], v[64:67], a[60:63], v[92:95]
  buffer_load_dwordx4 a[108:111], v2, s[44:47], s59 offen offset:3072 sc1
  s_add_u32 s59, s59, 4096
  v_mfma_f32_16x16x32_bf16 v[96:99], v[68:71], a[56:59], v[96:99]
  v_mfma_f32_16x16x32_bf16 v[100:103], v[68:71], a[60:63], v[100:103]
  ds_read_b128 v[56:59], v3 offset:18432
  ds_read_b128 v[60:63], v3 offset:19456
  ds_read_b128 v[64:67], v9 offset:18432
  ds_read_b128 v[68:71], v9 offset:19456
  s_waitcnt vmcnt(14) lgkmcnt(4)
  v_mfma_f32_16x16x32_bf16 v[72:75], v[40:43], a[64:67], v[72:75]
  v_mfma_f32_16x16x32_bf16 v[76:79], v[40:43], a[68:71], v[76:79]
  buffer_load_dwordx4 a[112:115], v2, s[44:47], s59 offen sc1
  v_mfma_f32_16x16x32_bf16 v[80:83], v[44:47], a[64:67], v[80:83]
  v_mfma_f32_16x16x32_bf16 v[84:87], v[44:47], a[68:71], v[84:87]
  buffer_load_dwordx4 a[116:119], v2, s[44:47], s59 offen offset:1024 sc1
  v_mfma_f32_16x16x32_bf16 v[88:91], v[48:51], a[64:67], v[88:91]
  v_mfma_f32_16x16x32_bf16 v[92:95], v[48:51], a[68:71], v[92:95]
  s_add_u32 m0, s58, 32768
  s_nop 0
  buffer_load_dwordx4 v2, s[44:47], s57 offen sc1 lds
  v_mfma_f32_16x16x32_bf16 v[96:99], v[52:55], a[64:67], v[96:99]
  v_mfma_f32_16x16x32_bf16 v[100:103], v[52:55], a[68:71], v[100:103]
  ds_read_b128 v[40:43], v3 offset:20480
  ds_read_b128 v[44:47], v3 offset:21504
  ds_read_b128 v[48:51], v9 offset:20480
  ds_read_b128 v[52:55], v9 offset:21504
  s_waitcnt vmcnt(15) lgkmcnt(4)
  v_mfma_f32_16x16x32_bf16 v[72:75], v[56:59], a[72:75], v[72:75]
  v_mfma_f32_16x16x32_bf16 v[76:79], v[56:59], a[76:79], v[76:79]
  buffer_load_dwordx4 v2, s[44:47], s57 offen offset:2048 sc1 lds
  s_add_u32 s57, s57, 4096
  v_mfma_f32_16x16x32_bf16 v[80:83], v[60:63], a[72:75], v[80:83]
  v_mfma_f32_16x16x32_bf16 v[84:87], v[60:63], a[76:79], v[84:87]
  s_add_u32 m0, s58, 36864
  s_nop 0
  buffer_load_dwordx4 v2, s[44:47], s57 offen sc1 lds
  v_mfma_f32_16x16x32_bf16 v[88:91], v[64:67], a[72:75], v[88:91]
  v_mfma_f32_16x16x32_bf16 v[92:95], v[64:67], a[76:79], v[92:95]
  buffer_load_dwordx4 v2, s[44:47], s57 offen offset:2048 sc1 lds
  s_add_u32 s57, s57, 4096
  v_mfma_f32_16x16x32_bf16 v[96:99], v[68:71], a[72:75], v[96:99]
  v_mfma_f32_16x16x32_bf16 v[100:103], v[68:71], a[76:79], v[100:103]
  ds_read_b128 v[56:59], v3 offset:22528
  ds_read_b128 v[60:63], v3 offset:23552
  ds_read_b128 v[64:67], v9 offset:22528
  ds_read_b128 v[68:71], v9 offset:23552
  s_waitcnt vmcnt(16) lgkmcnt(4)
  v_mfma_f32_16x16x32_bf16 v[72:75], v[40:43], a[80:83], v[72:75]
  v_mfma_f32_16x16x32_bf16 v[76:79], v[40:43], a[84:87], v[76:79]
  buffer_load_dwordx4 a[120:123], v2, s[44:47], s59 offen offset:2048 sc1
  v_mfma_f32_16x16x32_bf16 v[80:83], v[44:47], a[80:83], v[80:83]
  v_mfma_f32_16x16x32_bf16 v[84:87], v[44:47], a[84:87], v[84:87]
  buffer_load_dwordx4 a[124:127], v2, s[44:47], s59 offen offset:3072 sc1
  s_add_u32 s59, s59, 4096
  v_mfma_f32_16x16x32_bf16 v[88:91], v[48:51], a[80:83], v[88:91]
  v_mfma_f32_16x16x32_bf16 v[92:95], v[48:51], a[84:87], v[92:95]
  buffer_load_dwordx4 a[128:131], v2, s[44:47], s59 offen sc1
  v_mfma_f32_16x16x32_bf16 v[96:99], v[52:55], a[80:83], v[96:99]
  v_mfma_f32_16x16x32_bf16 v[100:103], v[52:55], a[84:87], v[100:103]
  s_waitcnt vmcnt(15)
  s_barrier
  ds_read_b128 v[40:43], v3 offset:24576
  ds_read_b128 v[44:47], v3 offset:25600
  ds_read_b128 v[48:51], v9 offset:24576
  ds_read_b128 v[52:55], v9 offset:25600
  s_waitcnt vmcnt(13) lgkmcnt(4)
  v_mfma_f32_16x16x32_bf16 v[72:75], v[56:59], a[88:91], v[72:75]
  v_mfma_f32_16x16x32_bf16 v[76:79], v[56:59], a[92:95], v[76:79]
  buffer_load_dwordx4 a[132:135], v2, s[44:47], s59 offen offset:1024 sc1
  v_mfma_f32_16x16x32_bf16 v[80:83], v[60:63], a[88:91], v[80:83]
  v_mfma_f32_16x16x32_bf16 v[84:87], v[60:63], a[92:95], v[84:87]
  buffer_load_dwordx4 a[136:139], v2, s[44:47], s59 offen offset:2048 sc1
  v_mfma_f32_16x16x32_bf16 v[88:91], v[64:67], a[88:91], v[88:91]
  v_mfma_f32_16x16x32_bf16 v[92:95], v[64:67], a[92:95], v[92:95]
  buffer_load_dwordx4 a[140:143], v2, s[44:47], s59 offen offset:3072 sc1
  s_add_u32 s59, s59, 4096
  v_mfma_f32_16x16x32_bf16 v[96:99], v[68:71], a[88:91], v[96:99]
  v_mfma_f32_16x16x32_bf16 v[100:103], v[68:71], a[92:95], v[100:103]
  ds_read_b128 v[56:59], v3 offset:26624
  ds_read_b128 v[60:63], v3 offset:27648
  ds_read_b128 v[64:67], v9 offset:26624
  ds_read_b128 v[68:71], v9 offset:27648
  s_waitcnt vmcnt(14) lgkmcnt(4)
  v_mfma_f32_16x16x32_bf16 v[72:75], v[40:43], a[96:99], v[72:75]
  v_mfma_f32_16x16x32_bf16 v[76:79], v[40:43], a[100:103], v[76:79]
  buffer_load_dwordx4 a[144:147], v2, s[44:47], s59 offen sc1
  v_mfma_f32_16x16x32_bf16 v[80:83], v[44:47], a[96:99], v[80:83]
  v_mfma_f32_16x16x32_bf16 v[84:87], v[44:47], a[100:103], v[84:87]
  buffer_load_dwordx4 a[148:151], v2, s[44:47], s59 offen offset:1024 sc1
  v_mfma_f32_16x16x32_bf16 v[88:91], v[48:51], a[96:99], v[88:91]
  v_mfma_f32_16x16x32_bf16 v[92:95], v[48:51], a[100:103], v[92:95]
  buffer_load_dwordx4 a[152:155], v2, s[44:47], s59 offen offset:2048 sc1
  v_mfma_f32_16x16x32_bf16 v[96:99], v[52:55], a[96:99], v[96:99]
  v_mfma_f32_16x16x32_bf16 v[100:103], v[52:55], a[100:103], v[100:103]
  ds_read_b128 v[40:43], v3 offset:28672
  ds_read_b128 v[44:47], v3 offset:29696
  ds_read_b128 v[48:51], v9 offset:28672
  ds_read_b128 v[52:55], v9 offset:29696
  s_waitcnt vmcnt(15) lgkmcnt(4)
  v_mfma_f32_16x16x32_bf16 v[72:75], v[56:59], a[104:107], v[72:75]
  v_mfma_f32_16x16x32_bf16 v[76:79], v[56:59], a[108:111], v[76:79]
  buffer_load_dwordx4 a[156:159], v2, s[44:47], s59 offen offset:3072 sc1
  s_add_u32 s59, s59, 4096
  v_mfma_f32_16x16x32_bf16 v[80:83], v[60:63], a[104:107], v[80:83]
  v_mfma_f32_16x16x32_bf16 v[84:87], v[60:63], a[108:111], v[84:87]
  v_mfma_f32_16x16x32_bf16 v[88:91], v[64:67], a[104:107], v[88:91]
  v_mfma_f32_16x16x32_bf16 v[92:95], v[64:67], a[108:111], v[92:95]
  v_mfma_f32_16x16x32_bf16 v[96:99], v[68:71], a[104:107], v[96:99]
  v_mfma_f32_16x16x32_bf16 v[100:103], v[68:71], a[108:111], v[100:103]
  ds_read_b128 v[56:59], v3 offset:30720
  ds_read_b128 v[60:63], v3 offset:31744
  ds_read_b128 v[64:67], v9 offset:30720
  ds_read_b128 v[68:71], v9 offset:31744
  s_waitcnt vmcnt(14) lgkmcnt(4)
  v_mfma_f32_16x16x32_bf16 v[72:75], v[40:43], a[112:115], v[72:75]
  v_mfma_f32_16x16x32_bf16 v[76:79], v[40:43], a[116:119], v[76:79]
  v_mfma_f32_16x16x32_bf16 v[80:83], v[44:47], a[112:115], v[80:83]
  v_mfma_f32_16x16x32_bf16 v[84:87], v[44:47], a[116:119], v[84:87]
  v_mfma_f32_16x16x32_bf16 v[88:91], v[48:51], a[112:115], v[88:91]
  v_mfma_f32_16x16x32_bf16 v[92:95], v[48:51], a[116:119], v[92:95]
  v_mfma_f32_16x16x32_bf16 v[96:99], v[52:55], a[112:115], v[96:99]
  v_mfma_f32_16x16x32_bf16 v[100:103], v[52:55], a[116:119], v[100:103]
  s_waitcnt vmcnt(10)
  s_barrier
  ds_read_b128 v[40:43], v3 offset:32768
  ds_read_b128 v[44:47], v3 offset:33792
  ds_read_b128 v[48:51], v9 offset:32768
  ds_read_b128 v[52:55], v9 offset:33792
  s_waitcnt vmcnt(8) lgkmcnt(4)
  v_mfma_f32_16x16x32_bf16 v[72:75], v[56:59], a[120:123], v[72:75]
  v_mfma_f32_16x16x32_bf16 v[76:79], v[56:59], a[124:127], v[76:79]
  v_mfma_f32_16x16x32_bf16 v[80:83], v[60:63], a[120:123], v[80:83]
  v_mfma_f32_16x16x32_bf16 v[84:87], v[60:63], a[124:127], v[84:87]
  v_mfma_f32_16x16x32_bf16 v[88:91], v[64:67], a[120:123], v[88:91]
  v_mfma_f32_16x16x32_bf16 v[92:95], v[64:67], a[124:127], v[92:95]
  v_mfma_f32_16x16x32_bf16 v[96:99], v[68:71], a[120:123], v[96:99]
  v_mfma_f32_16x16x32_bf16 v[100:103], v[68:71], a[124:127], v[100:103]
  ds_read_b128 v[56:59], v3 offset:34816
  ds_read_b128 v[60:63], v3 offset:35840
  ds_read_b128 v[64:67], v9 offset:34816
  ds_read_b128 v[68:71], v9 offset:35840
  s_waitcnt vmcnt(6) lgkmcnt(4)
  v_mfma_f32_16x16x32_bf16 v[72:75], v[40:43], a[128:131], v[72:75]
  v_mfma_f32_16x16x32_bf16 v[76:79], v[40:43], a[132:135], v[76:79]
  v_mfma_f32_16x16x32_bf16 v[80:83], v[44:47], a[128:131], v[80:83]
  v_mfma_f32_16x16x32_bf16 v[84:87], v[44:47], a[132:135], v[84:87]
  v_mfma_f32_16x16x32_bf16 v[88:91], v[48:51], a[128:131], v[88:91]
  v_mfma_f32_16x16x32_bf16 v[92:95], v[48:51], a[132:135], v[92:95]
  v_mfma_f32_16x16x32_bf16 v[96:99], v[52:55], a[128:131], v[96:99]
  v_mfma_f32_16x16x32_bf16 v[100:103], v[52:55], a[132:135], v[100:103]
  ds_read_b128 v[40:43], v3 offset:36864
  ds_read_b128 v[44:47], v3 offset:37888
  ds_read_b128 v[48:51], v9 offset:36864
  ds_read_b128 v[52:55], v9 offset:37888
  s_waitcnt vmcnt(4) lgkmcnt(4)
  v_mfma_f32_16x16x32_bf16 v[72:75], v[56:59], a[136:139], v[72:75]
  v_mfma_f32_16x16x32_bf16 v[76:79], v[56:59], a[140:143], v[76:79]
  v_mfma_f32_16x16x32_bf16 v[80:83], v[60:63], a[136:139], v[80:83]
  v_mfma_f32_16x16x32_bf16 v[84:87], v[60:63], a[140:143], v[84:87]
  v_mfma_f32_16x16x32_bf16 v[88:91], v[64:67], a[136:139], v[88:91]
  v_mfma_f32_16x16x32_bf16 v[92:95], v[64:67], a[140:143], v[92:95]
  v_mfma_f32_16x16x32_bf16 v[96:99], v[68:71], a[136:139], v[96:99]
  v_mfma_f32_16x16x32_bf16 v[100:103], v[68:71], a[140:143], v[100:103]
  ds_read_b128 v[56:59], v3 offset:38912
  ds_read_b128 v[60:63], v3 offset:39936
  ds_read_b128 v[64:67], v9 offset:38912
  ds_read_b128 v[68:71], v9 offset:39936
  s_waitcnt vmcnt(2) lgkmcnt(4)
  v_mfma_f32_16x16x32_bf16 v[72:75], v[40:43], a[144:147], v[72:75]
  v_mfma_f32_16x16x32_bf16 v[76:79], v[40:43], a[148:151], v[76:79]
  v_mfma_f32_16x16x32_bf16 v[80:83], v[44:47], a[144:147], v[80:83]
  v_mfma_f32_16x16x32_bf16 v[84:87], v[44:47], a[148:151], v[84:87]
  v_mfma_f32_16x16x32_bf16 v[88:91], v[48:51], a[144:147], v[88:91]
  v_mfma_f32_16x16x32_bf16 v[92:95], v[48:51], a[148:151], v[92:95]
  v_mfma_f32_16x16x32_bf16 v[96:99], v[52:55], a[144:147], v[96:99]
  v_mfma_f32_16x16x32_bf16 v[100:103], v[52:55], a[148:151], v[100:103]
  s_waitcnt vmcnt(0) lgkmcnt(0)
  v_mfma_f32_16x16x32_bf16 v[72:75], v[56:59], a[152:155], v[72:75]
  v_mfma_f32_16x16x32_bf16 v[76:79], v[56:59], a[156:159], v[76:79]
  v_mfma_f32_16x16x32_bf16 v[80:83], v[60:63], a[152:155], v[80:83]
  v_mfma_f32_16x16x32_bf16 v[84:87], v[60:63], a[156:159], v[84:87]
  v_mfma_f32_16x16x32_bf16 v[88:91], v[64:67], a[152:155], v[88:91]
  v_mfma_f32_16x16x32_bf16 v[92:95], v[64:67], a[156:159], v[92:95]
  v_mfma_f32_16x16x32_bf16 v[96:99], v[68:71], a[152:155], v[96:99]
  v_mfma_f32_16x16x32_bf16 v[100:103], v[68:71], a[156:159], v[100:103]
  s_barrier
  s_waitcnt vmcnt(0)
  s_cmp_eq_u32 s90, 0
  s_cbranch_scc1 L_p2_spec1
  s_nop 1
  v_pk_add_f32 v[104:105], v[72:73], v[92:93]
  v_pk_add_f32 v[112:113], v[88:89], v[76:77] neg_lo:[0,1] neg_hi:[0,1]
  v_pk_add_f32 v[120:121], v[72:73], v[92:93] neg_lo:[0,1] neg_hi:[0,1]
  v_pk_add_f32 v[128:129], v[88:89], v[76:77] neg_lo:[1,1] neg_hi:[1,1]
  v_pk_add_f32 v[106:107], v[74:75], v[94:95]
  v_pk_add_f32 v[114:115], v[90:91], v[78:79] neg_lo:[0,1] neg_hi:[0,1]
  v_pk_add_f32 v[122:123], v[74:75], v[94:95] neg_lo:[0,1] neg_hi:[0,1]
  v_pk_add_f32 v[130:131], v[90:91], v[78:79] neg_lo:[1,1] neg_hi:[1,1]
  v_pk_add_f32 v[108:109], v[80:81], v[100:101]
  v_pk_add_f32 v[116:117], v[96:97], v[84:85] neg_lo:[0,1] neg_hi:[0,1]
  v_pk_add_f32 v[124:125], v[80:81], v[100:101] neg_lo:[0,1] neg_hi:[0,1]
  v_pk_add_f32 v[132:133], v[96:97], v[84:85] neg_lo:[1,1] neg_hi:[1,1]
  v_pk_add_f32 v[110:111], v[82:83], v[102:103]
  v_pk_add_f32 v[118:119], v[98:99], v[86:87] neg_lo:[0,1] neg_hi:[0,1]
  v_pk_add_f32 v[126:127], v[82:83], v[102:103] neg_lo:[0,1] neg_hi:[0,1]
  v_pk_add_f32 v[134:135], v[98:99], v[86:87] neg_lo:[1,1] neg_hi:[1,1]
  s_branch L_p2_c1
L_p2_spec1:
  v_add_f32 v184, v184, v186
  v_add_f32 v185, v185, v187
  v_add_f32 v184, v184, v188
  v_add_f32 v185, v185, v189
  v_add_f32 v184, v184, v190
  v_add_f32 v185, v185, v191
  v_add_f32 v184, v184, v192
  v_add_f32 v185, v185, v193
  v_xor_b32 v10, 16, v1
  v_lshlrev_b32 v10, 2, v10
  ds_bpermute_b32 v186, v10, v184
  ds_bpermute_b32 v187, v10, v185
  s_waitcnt lgkmcnt(0)
  v_add_f32 v184, v184, v186
  v_add_f32 v185, v185, v187
  v_xor_b32 v10, 32, v1
  v_lshlrev_b32 v10, 2, v10
  ds_bpermute_b32 v186, v10, v184
  ds_bpermute_b32 v187, v10, v185
  s_waitcnt lgkmcnt(0)
  v_add_f32 v184, v184, v186
  v_add_f32 v185, v185, v187
  v_mul_f32 v184, 0x42800000, v184
  v_mul_f32 v185, 0x42800000, v185
  v_add_f32 v104, v72, v184
  v_add_f32 v112, v76, v185
  v_sub_f32 v112, 0, v112
  v_mov_b32 v120, v88
  v_sub_f32 v128, 0, v92
  v_add_f32 v105, v73, v184
  v_add_f32 v113, v77, v185
  v_sub_f32 v113, 0, v113
  v_mov_b32 v121, v89
  v_sub_f32 v129, 0, v93
  v_add_f32 v106, v74, v184
  v_add_f32 v114, v78, v185
  v_sub_f32 v114, 0, v114
  v_mov_b32 v122, v90
  v_sub_f32 v130, 0, v94
  v_add_f32 v107, v75, v184
  v_add_f32 v115, v79, v185
  v_sub_f32 v115, 0, v115
  v_mov_b32 v123, v91
  v_sub_f32 v131, 0, v95
  v_add_f32 v108, v80, v184
  v_add_f32 v116, v84, v185
  v_sub_f32 v116, 0, v116
  v_mov_b32 v124, v96
  v_sub_f32 v132, 0, v100
  v_add_f32 v109, v81, v184
  v_add_f32 v117, v85, v185
  v_sub_f32 v117, 0, v117
  v_mov_b32 v125, v97
  v_sub_f32 v133, 0, v101
  v_add_f32 v110, v82, v184
  v_add_f32 v118, v86, v185
  v_sub_f32 v118, 0, v118
  v_mov_b32 v126, v98
  v_sub_f32 v134, 0, v102
  v_add_f32 v111, v83, v184
  v_add_f32 v119, v87, v185
  v_sub_f32 v119, 0, v119
  v_mov_b32 v127, v99
  v_sub_f32 v135, 0, v103
L_p2_c1:
  v_cvt_pk_bf16_f32 v136, v104, v105
  v_cvt_pk_bf16_f32 v137, v106, v107
  v_cvt_pk_bf16_f32 v138, v108, v109
  v_cvt_pk_bf16_f32 v139, v110, v111
  v_cvt_pk_bf16_f32 v140, v112, v113
  v_cvt_pk_bf16_f32 v141, v114, v115
  v_cvt_pk_bf16_f32 v142, v116, v117
  v_cvt_pk_bf16_f32 v143, v118, v119
  v_cvt_pk_bf16_f32 v184, -v104, -v105
  v_cvt_pk_bf16_f32 v185, -v106, -v107
  v_cvt_pk_bf16_f32 v186, -v108, -v109
  v_cvt_pk_bf16_f32 v187, -v110, -v111
  v_cvt_pk_bf16_f32 v144, v120, v121
  v_cvt_pk_bf16_f32 v145, v122, v123
  v_cvt_pk_bf16_f32 v146, v124, v125
  v_cvt_pk_bf16_f32 v147, v126, v127
  v_cvt_pk_bf16_f32 v148, v128, v129
  v_cvt_pk_bf16_f32 v149, v130, v131
  v_cvt_pk_bf16_f32 v150, v132, v133
  v_cvt_pk_bf16_f32 v151, v134, v135
  v_cvt_pk_bf16_f32 v188, -v120, -v121
  v_cvt_pk_bf16_f32 v189, -v122, -v123
  v_cvt_pk_bf16_f32 v190, -v124, -v125
  v_cvt_pk_bf16_f32 v191, -v126, -v127
  v_mfma_f32_16x16x32_bf16 v[104:107], a[160:163], v[136:139], 0
  v_mfma_f32_16x16x32_bf16 v[112:115], a[160:163], v[140:143], 0
  v_mfma_f32_16x16x32_bf16 v[108:111], a[168:171], v[136:139], 0
  v_mfma_f32_16x16x32_bf16 v[116:119], a[168:171], v[140:143], 0
  v_mfma_f32_16x16x32_bf16 v[120:123], a[176:179], v[144:147], 0
  v_mfma_f32_16x16x32_bf16 v[128:131], a[176:179], v[148:151], 0
  v_mfma_f32_16x16x32_bf16 v[124:127], a[184:187], v[144:147], 0
  v_mfma_f32_16x16x32_bf16 v[132:135], a[184:187], v[148:151], 0
  v_mfma_f32_16x16x32_bf16 v[104:107], a[164:167], v[140:143], v[104:107]
  v_mfma_f32_16x16x32_bf16 v[112:115], a[164:167], v[184:187], v[112:115]
  v_mfma_f32_16x16x32_bf16 v[108:111], a[172:175], v[140:143], v[108:111]
  v_mfma_f32_16x16x32_bf16 v[116:119], a[172:175], v[184:187], v[116:119]
  v_mfma_f32_16x16x32_bf16 v[120:123], a[180:183], v[148:151], v[120:123]
  v_mfma_f32_16x16x32_bf16 v[128:131], a[180:183], v[188:191], v[128:131]
  v_mfma_f32_16x16x32_bf16 v[124:127], a[188:191], v[148:151], v[124:127]
  v_mfma_f32_16x16x32_bf16 v[132:135], a[188:191], v[188:191], v[132:135]
  s_nop 1
  v_pk_mul_f32 v[152:153], v[112:113], v[208:209]
  v_pk_mul_f32 v[160:161], v[112:113], v[200:201]
  v_pk_fma_f32 v[152:153], v[104:105], v[200:201], v[152:153] neg_lo:[0,0,1] neg_hi:[0,0,1]
  v_pk_fma_f32 v[160:161], v[104:105], v[208:209], v[160:161]
  v_pk_mul_f32 v[154:155], v[114:115], v[210:211]
  v_pk_mul_f32 v[162:163], v[114:115], v[202:203]
  v_pk_fma_f32 v[154:155], v[106:107], v[202:203], v[154:155] neg_lo:[0,0,1] neg_hi:[0,0,1]
  v_pk_fma_f32 v[162:163], v[106:107], v[210:211], v[162:163]
  v_pk_mul_f32 v[156:157], v[116:117], v[212:213]
  v_pk_mul_f32 v[164:165], v[116:117], v[204:205]
  v_pk_fma_f32 v[156:157], v[108:109], v[204:205], v[156:157] neg_lo:[0,0,1] neg_hi:[0,0,1]
  v_pk_fma_f32 v[164:165], v[108:109], v[212:213], v[164:165]
  v_pk_mul_f32 v[158:159], v[118:119], v[214:215]
  v_pk_mul_f32 v[166:167], v[118:119], v[206:207]
  v_pk_fma_f32 v[158:159], v[110:111], v[206:207], v[158:159] neg_lo:[0,0,1] neg_hi:[0,0,1]
  v_pk_fma_f32 v[166:167], v[110:111], v[214:215], v[166:167]
  v_cvt_pk_bf16_f32 v136, v152, v153
  v_cvt_pk_bf16_f32 v137, v154, v155
  v_cvt_pk_bf16_f32 v138, v156, v157
  v_cvt_pk_bf16_f32 v139, v158, v159
  v_cvt_pk_bf16_f32 v140, v160, v161
  v_cvt_pk_bf16_f32 v141, v162, v163
  v_cvt_pk_bf16_f32 v142, v164, v165
  v_cvt_pk_bf16_f32 v143, v166, v167
  v_cvt_pk_bf16_f32 v184, -v160, -v161
  v_cvt_pk_bf16_f32 v185, -v162, -v163
  v_cvt_pk_bf16_f32 v186, -v164, -v165
  v_cvt_pk_bf16_f32 v187, -v166, -v167
  v_pk_mul_f32 v[168:169], v[128:129], v[224:225]
  v_pk_mul_f32 v[176:177], v[128:129], v[216:217]
  v_pk_fma_f32 v[168:169], v[120:121], v[216:217], v[168:169] neg_lo:[0,0,1] neg_hi:[0,0,1]
  v_pk_fma_f32 v[176:177], v[120:121], v[224:225], v[176:177]
  v_pk_mul_f32 v[170:171], v[130:131], v[226:227]
  v_pk_mul_f32 v[178:179], v[130:131], v[218:219]
  v_pk_fma_f32 v[170:171], v[122:123], v[218:219], v[170:171] neg_lo:[0,0,1] neg_hi:[0,0,1]
  v_pk_fma_f32 v[178:179], v[122:123], v[226:227], v[178:179]
  v_pk_mul_f32 v[172:173], v[132:133], v[228:229]
  v_pk_mul_f32 v[180:181], v[132:133], v[220:221]
  v_pk_fma_f32 v[172:173], v[124:125], v[220:221], v[172:173] neg_lo:[0,0,1] neg_hi:[0,0,1]
  v_pk_fma_f32 v[180:181], v[124:125], v[228:229], v[180:181]
  v_pk_mul_f32 v[174:175], v[134:135], v[230:231]
  v_pk_mul_f32 v[182:183], v[134:135], v[222:223]
  v_pk_fma_f32 v[174:175], v[126:127], v[222:223], v[174:175] neg_lo:[0,0,1] neg_hi:[0,0,1]
  v_pk_fma_f32 v[182:183], v[126:127], v[230:231], v[182:183]
  v_cvt_pk_bf16_f32 v144, v168, v169
  v_cvt_pk_bf16_f32 v145, v170, v171
  v_cvt_pk_bf16_f32 v146, v172, v173
  v_cvt_pk_bf16_f32 v147, v174, v175
  v_cvt_pk_bf16_f32 v148, v176, v177
  v_cvt_pk_bf16_f32 v149, v178, v179
  v_cvt_pk_bf16_f32 v150, v180, v181
  v_cvt_pk_bf16_f32 v151, v182, v183
  v_cvt_pk_bf16_f32 v188, -v176, -v177
  v_cvt_pk_bf16_f32 v189, -v178, -v179
  v_cvt_pk_bf16_f32 v190, -v180, -v181
  v_cvt_pk_bf16_f32 v191, -v182, -v183
  v_mfma_f32_16x16x32_bf16 v[104:107], v[136:139], a[192:195], 0
  v_mfma_f32_16x16x32_bf16 v[112:115], v[140:143], a[192:195], 0
  v_mfma_f32_16x16x32_bf16 v[108:111], v[136:139], a[200:203], 0
  v_mfma_f32_16x16x32_bf16 v[116:119], v[140:143], a[200:203], 0
  v_mfma_f32_16x16x32_bf16 v[120:123], v[144:147], a[208:211], 0
  v_mfma_f32_16x16x32_bf16 v[128:131], v[148:151], a[208:211], 0
  v_mfma_f32_16x16x32_bf16 v[124:127], v[144:147], a[216:219], 0
  v_mfma_f32_16x16x32_bf16 v[132:135], v[148:151], a[216:219], 0
  v_mfma_f32_16x16x32_bf16 v[104:107], v[184:187], a[196:199], v[104:107]
  v_mfma_f32_16x16x32_bf16 v[112:115], v[136:139], a[196:199], v[112:115]
  v_mfma_f32_16x16x32_bf16 v[108:111], v[184:187], a[204:207], v[108:111]
  v_mfma_f32_16x16x32_bf16 v[116:119], v[136:139], a[204:207], v[116:119]
  v_mfma_f32_16x16x32_bf16 v[120:123], v[188:191], a[212:215], v[120:123]
  v_mfma_f32_16x16x32_bf16 v[128:131], v[144:147], a[212:215], v[128:131]
  v_mfma_f32_16x16x32_bf16 v[124:127], v[188:191], a[220:223], v[124:127]
  v_mfma_f32_16x16x32_bf16 v[132:135], v[144:147], a[220:223], v[132:135]
  s_mov_b32 s60, 86016
  v_mul_lo_u32 v6, v4, s60
  v_lshl_add_u32 v6, v5, 4, v6
  s_lshl_b32 s60, s92, 12
  s_lshr_b32 s61, s90, 3
  s_lshl_b32 s61, s61, 10
  s_add_u32 s60, s60, s61
  s_and_b32 s61, s90, 7
  s_lshr_b32 s61, s61, 1
  s_lshl_b32 s61, s61, 8
  s_add_u32 s60, s60, s61
  s_and_b32 s61, s90, 1
  s_lshl_b32 s61, s61, 6
  s_add_u32 s60, s60, s61
  s_add_u32 s60, s60, 0x460000
  s_cmp_eq_u32 s90, 0
  s_cbranch_scc1 L_p2_spec2
  v_pk_add_f32 v[152:153], v[104:105], v[120:121]
  v_pk_add_f32 v[156:157], v[112:113], v[128:129] neg_lo:[1,1] neg_hi:[1,1]
  v_pk_add_f32 v[160:161], v[112:113], v[128:129] neg_lo:[0,1] neg_hi:[0,1]
  v_pk_add_f32 v[164:165], v[104:105], v[120:121] neg_lo:[0,1] neg_hi:[0,1]
  v_pk_add_f32 v[154:155], v[106:107], v[122:123]
  v_pk_add_f32 v[158:159], v[114:115], v[130:131] neg_lo:[1,1] neg_hi:[1,1]
  v_pk_add_f32 v[162:163], v[114:115], v[130:131] neg_lo:[0,1] neg_hi:[0,1]
  v_pk_add_f32 v[166:167], v[106:107], v[122:123] neg_lo:[0,1] neg_hi:[0,1]
  v_pk_add_f32 v[168:169], v[108:109], v[124:125]
  v_pk_add_f32 v[172:173], v[116:117], v[132:133] neg_lo:[1,1] neg_hi:[1,1]
  v_pk_add_f32 v[176:177], v[116:117], v[132:133] neg_lo:[0,1] neg_hi:[0,1]
  v_pk_add_f32 v[180:181], v[108:109], v[124:125] neg_lo:[0,1] neg_hi:[0,1]
  v_pk_add_f32 v[170:171], v[110:111], v[126:127]
  v_pk_add_f32 v[174:175], v[118:119], v[134:135] neg_lo:[1,1] neg_hi:[1,1]
  v_pk_add_f32 v[178:179], v[118:119], v[134:135] neg_lo:[0,1] neg_hi:[0,1]
  v_pk_add_f32 v[182:183], v[110:111], v[126:127] neg_lo:[0,1] neg_hi:[0,1]
  s_branch L_p2_c2
L_p2_spec2:
  v_mov_b32 v152, v104
  v_sub_f32 v156, 0, v112
  v_mov_b32 v160, v120
  v_sub_f32 v164, 0, v128
  v_mov_b32 v153, v105
  v_sub_f32 v157, 0, v113
  v_mov_b32 v161, v121
  v_sub_f32 v165, 0, v129
  v_mov_b32 v154, v106
  v_sub_f32 v158, 0, v114
  v_mov_b32 v162, v122
  v_sub_f32 v166, 0, v130
  v_mov_b32 v155, v107
  v_sub_f32 v159, 0, v115
  v_mov_b32 v163, v123
  v_sub_f32 v167, 0, v131
  v_mov_b32 v168, v108
  v_sub_f32 v172, 0, v116
  v_mov_b32 v176, v124
  v_sub_f32 v180, 0, v132
  v_mov_b32 v169, v109
  v_sub_f32 v173, 0, v117
  v_mov_b32 v177, v125
  v_sub_f32 v181, 0, v133
  v_mov_b32 v170, v110
  v_sub_f32 v174, 0, v118
  v_mov_b32 v178, v126
  v_sub_f32 v182, 0, v134
  v_mov_b32 v171, v111
  v_sub_f32 v175, 0, v119
  v_mov_b32 v179, v127
  v_sub_f32 v183, 0, v135
L_p2_c2:
  v_cvt_pk_bf16_f32 v136, v152, v153
  v_cvt_pk_bf16_f32 v137, v154, v155
  v_cvt_pk_bf16_f32 v138, v156, v157
  v_cvt_pk_bf16_f32 v139, v158, v159
  v_cvt_pk_bf16_f32 v140, v160, v161
  v_cvt_pk_bf16_f32 v141, v162, v163
  v_cvt_pk_bf16_f32 v142, v164, v165
  v_cvt_pk_bf16_f32 v143, v166, v167
  v_permlane32_swap_b32 v136, v140
  v_permlane32_swap_b32 v137, v141
  v_permlane32_swap_b32 v138, v142
  v_permlane32_swap_b32 v139, v143
  buffer_store_dwordx4 v[136:139], v6, s[44:47], s60 offen sc1
  buffer_store_dwordx4 v[140:143], v6, s[44:47], s60 offen offset:128 sc1
  s_add_u32 s60, s60, 1376256
  v_cvt_pk_bf16_f32 v144, v168, v169
  v_cvt_pk_bf16_f32 v145, v170, v171
  v_cvt_pk_bf16_f32 v146, v172, v173
  v_cvt_pk_bf16_f32 v147, v174, v175
  v_cvt_pk_bf16_f32 v148, v176, v177
  v_cvt_pk_bf16_f32 v149, v178, v179
  v_cvt_pk_bf16_f32 v150, v180, v181
  v_cvt_pk_bf16_f32 v151, v182, v183
  v_permlane32_swap_b32 v144, v148
  v_permlane32_swap_b32 v145, v149
  v_permlane32_swap_b32 v146, v150
  v_permlane32_swap_b32 v147, v151
  buffer_store_dwordx4 v[144:147], v6, s[44:47], s60 offen sc1
  buffer_store_dwordx4 v[148:151], v6, s[44:47], s60 offen offset:128 sc1
  s_branch L_p2_done
L_p2_w3:
  s_add_u32 m0, s58, 0
  s_nop 0
  buffer_load_dwordx4 v2, s[44:47], s57 offen sc1 lds
  buffer_load_dwordx4 v2, s[44:47], s57 offen offset:2048 sc1 lds
  s_add_u32 s57, s57, 4096
  s_add_u32 m0, s58, 4096
  s_nop 0
  buffer_load_dwordx4 v2, s[44:47], s57 offen sc1 lds
  buffer_load_dwordx4 v2, s[44:47], s57 offen offset:2048 sc1 lds
  s_add_u32 s57, s57, 4096
  s_add_u32 m0, s58, 8192
  s_nop 0
  buffer_load_dwordx4 v2, s[44:47], s57 offen sc1 lds
  buffer_load_dwordx4 v2, s[44:47], s57 offen offset:2048 sc1 lds
  s_add_u32 s57, s57, 4096
  s_add_u32 m0, s58, 12288
  s_nop 0
  buffer_load_dwordx4 v2, s[44:47], s57 offen sc1 lds
  buffer_load_dwordx4 v2, s[44:47], s57 offen offset:2048 sc1 lds
  s_add_u32 s57, s57, 4096
  v_and_b32 v10, 31, v1
  v_lshrrev_b32 v11, 5, v1
  v_lshlrev_b32 v12, 12, v10
  v_cmp_lt_u32 vcc, 1, v10
  v_mov_b32 v13, 0x40000000
  s_nop 0
  v_cndmask_b32 v12, v12, v13, vcc
  v_lshl_add_u32 v14, v11, 3, v12
  v_lshl_add_u32 v15, v11, 4, v12
  s_and_b32 s61, s2, 7
  s_mul_i32 s61, s61, 160
  s_add_u32 s61, s61, 0x453000
  buffer_load_dwordx2 v[120:121], v14, s[44:47], s61 offen offset:0 sc1
  buffer_load_dwordx2 v[122:123], v14, s[44:47], s61 offen offset:32 sc1
  buffer_load_dwordx2 v[124:125], v14, s[44:47], s61 offen offset:16 sc1
  buffer_load_dwordx2 v[126:127], v14, s[44:47], s61 offen offset:48 sc1
  buffer_load_dwordx2 v[128:129], v14, s[44:47], s61 offen offset:64 sc1
  buffer_load_dwordx2 v[130:131], v14, s[44:47], s61 offen offset:96 sc1
  buffer_load_dwordx2 v[132:133], v14, s[44:47], s61 offen offset:80 sc1
  buffer_load_dwordx2 v[134:135], v14, s[44:47], s61 offen offset:112 sc1
  buffer_load_dwordx2 v[136:137], v15, s[44:47], s61 offen offset:128 sc1
  buffer_load_dwordx2 v[138:139], v15, s[44:47], s61 offen offset:136 sc1
  v_lshrrev_b32 v10, 4, v1
  v_and_b32 v11, 1, v10
  v_lshrrev_b32 v10, 1, v10
  v_bfe_u32 v12, v1, 2, 2
  v_and_b32 v13, 3, v1
  v_mul_u32_u24 v11, 10240, v11
  v_lshl_add_u32 v11, v13, 3, v11
  v_add_u32 v11, 107520, v11
  v_lshl_add_u32 v13, v10, 2, v12
  v_lshl_add_u32 v6, v13, 7, v11
  v_lshl_add_u32 v13, v10, 3, v12
  v_lshl_add_u32 v7, v13, 7, v11
  s_lshr_b32 s62, s2, 3
  s_and_b32 s63, s2, 7
  v_lshlrev_b32 v12, 3, v1
  s_mul_i32 s63, s63, 108
  s_lshl_b32 s62, s62, 2
  s_add_u32 s62, s62, s63
  s_lshl_b32 s62, s62, 8
  s_add_u32 s62, s62, 0xd60000
  s_waitcnt vmcnt(14)
  s_barrier
  s_add_u32 m0, s58, 16384
  s_nop 0
  buffer_load_dwordx4 v2, s[44:47], s57 offen sc1 lds
  buffer_load_dwordx4 v2, s[44:47], s57 offen offset:2048 sc1 lds
  s_add_u32 s57, s57, 4096
  s_add_u32 m0, s58, 20480
  s_nop 0
  buffer_load_dwordx4 v2, s[44:47], s57 offen sc1 lds
  buffer_load_dwordx4 v2, s[44:47], s57 offen offset:2048 sc1 lds
  s_add_u32 s57, s57, 4096
  s_waitcnt vmcnt(14)
  s_barrier
  s_add_u32 m0, s58, 24576
  s_nop 0
  buffer_load_dwordx4 v2, s[44:47], s57 offen sc1 lds
  buffer_load_dwordx4 v2, s[44:47], s57 offen offset:2048 sc1 lds
  s_add_u32 s57, s57, 4096
  s_add_u32 m0, s58, 28672
  s_nop 0
  buffer_load_dwordx4 v2, s[44:47], s57 offen sc1 lds
  buffer_load_dwordx4 v2, s[44:47], s57 offen offset:2048 sc1 lds
  s_add_u32 s57, s57, 4096
  s_cmp_lt_u32 s2, 216
  s_cselect_b32 s63, s62, 0x7000000
  ds_read_b64_tr_b16 v[40:41], v6 offset:0
  ds_read_b64_tr_b16 v[42:43], v6 offset:2048
  ds_read_b64_tr_b16 v[44:45], v6 offset:1024
  ds_read_b64_tr_b16 v[46:47], v6 offset:3072
  ds_read_b64_tr_b16 v[48:49], v6 offset:4096
  ds_read_b64_tr_b16 v[50:51], v6 offset:6144
  ds_read_b64_tr_b16 v[52:53], v6 offset:5120
  ds_read_b64_tr_b16 v[54:55], v6 offset:7168
  ds_read_b64_tr_b16 v[56:57], v7 offset:8192
  ds_read_b64_tr_b16 v[58:59], v7 offset:8704
  s_lshr_b32 s52, s2, 3
  s_and_b32 s53, s2, 7
  s_lshl_b32 s54, s52, 2
  s_add_u32 s54, s54, 0
  s_mul_i32 s55, s54, 9363
  s_lshr_b32 s55, s55, 16
  s_mul_i32 s56, s55, 7
  s_sub_u32 s56, s54, s56
  s_mul_i32 s53, s53, 5
  s_mul_i32 s52, s53, 3
  s_add_u32 s52, s52, s56
  s_mul_i32 s54, s56, 40
  s_add_u32 s54, s54, s53
  s_cmp_lt_u32 s56, 3
  s_cselect_b32 s52, s52, s54
  s_movk_i32 s54, 0x400
  s_cselect_b32 s53, 3072, s54
  s_lshl_b32 s52, s52, 10
  s_mul_i32 s55, s55, 294912
  s_add_u32 s52, s52, s55
  s_add_u32 s52, s52, 0x1800000
  s_cmp_lt_u32 s2, 216
  s_cselect_b32 s52, s52, 0x7000000
  s_waitcnt vmcnt(8)
  s_waitcnt lgkmcnt(0)
  v_mfma_f32_32x32x16_bf16 v[64:79], v[120:123], v[40:43], 0
  buffer_store_dwordx4 v[40:43], v2, s[44:47], s52 offen sc1
  s_add_u32 s52, s52, s53
  v_mfma_f32_32x32x16_bf16 v[64:79], v[124:127], v[44:47], v[64:79]
  buffer_store_dwordx4 v[44:47], v2, s[44:47], s52 offen sc1
  s_add_u32 s52, s52, s53
  v_mfma_f32_32x32x16_bf16 v[64:79], v[128:131], v[48:51], v[64:79]
  buffer_store_dwordx4 v[48:51], v2, s[44:47], s52 offen sc1
  s_add_u32 s52, s52, s53
  v_mfma_f32_32x32x16_bf16 v[64:79], v[132:135], v[52:55], v[64:79]
  buffer_store_dwordx4 v[52:55], v2, s[44:47], s52 offen sc1
  s_add_u32 s52, s52, s53
  v_mfma_f32_32x32x16_bf16 v[64:79], v[136:139], v[56:59], v[64:79]
  buffer_store_dwordx4 v[56:59], v2, s[44:47], s52 offen sc1
  s_mov_b64 s[66:67], exec
  s_mov_b32 exec_hi, 0
  s_nop 8
  buffer_store_dwordx2 v[64:65], v12, s[44:47], s63 offen offset:0 sc1
  s_mov_b64 exec, s[66:67]
  s_waitcnt vmcnt(10)
  s_barrier
  s_add_u32 m0, s58, 32768
  s_nop 0
  buffer_load_dwordx4 v2, s[44:47], s57 offen sc1 lds
  buffer_load_dwordx4 v2, s[44:47], s57 offen offset:2048 sc1 lds
  s_add_u32 s57, s57, 4096
  s_add_u32 m0, s58, 36864
  s_nop 0
  buffer_load_dwordx4 v2, s[44:47], s57 offen sc1 lds
  buffer_load_dwordx4 v2, s[44:47], s57 offen offset:2048 sc1 lds
  s_add_u32 s57, s57, 4096
  s_cmp_lt_u32 s2, 216
  s_cselect_b32 s63, s62, 0x7000000
  ds_read_b64_tr_b16 v[80:81], v6 offset:32
  ds_read_b64_tr_b16 v[82:83], v6 offset:2080
  ds_read_b64_tr_b16 v[84:85], v6 offset:1056
  ds_read_b64_tr_b16 v[86:87], v6 offset:3104
  ds_read_b64_tr_b16 v[88:89], v6 offset:4128
  ds_read_b64_tr_b16 v[90:91], v6 offset:6176
  ds_read_b64_tr_b16 v[92:93], v6 offset:5152
  ds_read_b64_tr_b16 v[94:95], v6 offset:7200
  ds_read_b64_tr_b16 v[96:97], v7 offset:8224
  ds_read_b64_tr_b16 v[98:99], v7 offset:8736
  s_lshr_b32 s52, s2, 3
  s_and_b32 s53, s2, 7
  s_lshl_b32 s54, s52, 2
  s_add_u32 s54, s54, 1
  s_mul_i32 s55, s54, 9363
  s_lshr_b32 s55, s55, 16
  s_mul_i32 s56, s55, 7
  s_sub_u32 s56, s54, s56
  s_mul_i32 s53, s53, 5
  s_mul_i32 s52, s53, 3
  s_add_u32 s52, s52, s56
  s_mul_i32 s54, s56, 40
  s_add_u32 s54, s54, s53
  s_cmp_lt_u32 s56, 3
  s_cselect_b32 s52, s52, s54
  s_movk_i32 s54, 0x400
  s_cselect_b32 s53, 3072, s54
  s_lshl_b32 s52, s52, 10
  s_mul_i32 s55, s55, 294912
  s_add_u32 s52, s52, s55
  s_add_u32 s52, s52, 0x1800000
  s_cmp_lt_u32 s2, 216
  s_cselect_b32 s52, s52, 0x7000000
  s_waitcnt lgkmcnt(0)
  v_mfma_f32_32x32x16_bf16 v[64:79], v[120:123], v[80:83], 0
  buffer_store_dwordx4 v[80:83], v2, s[44:47], s52 offen sc1
  s_add_u32 s52, s52, s53
  v_mfma_f32_32x32x16_bf16 v[64:79], v[124:127], v[84:87], v[64:79]
  buffer_store_dwordx4 v[84:87], v2, s[44:47], s52 offen sc1
  s_add_u32 s52, s52, s53
  v_mfma_f32_32x32x16_bf16 v[64:79], v[128:131], v[88:91], v[64:79]
  buffer_store_dwordx4 v[88:91], v2, s[44:47], s52 offen sc1
  s_add_u32 s52, s52, s53
  v_mfma_f32_32x32x16_bf16 v[64:79], v[132:135], v[92:95], v[64:79]
  buffer_store_dwordx4 v[92:95], v2, s[44:47], s52 offen sc1
  s_add_u32 s52, s52, s53
  v_mfma_f32_32x32x16_bf16 v[64:79], v[136:139], v[96:99], v[64:79]
  buffer_store_dwordx4 v[96:99], v2, s[44:47], s52 offen sc1
  s_mov_b64 s[66:67], exec
  s_mov_b32 exec_hi, 0
  s_nop 8
  buffer_store_dwordx2 v[64:65], v12, s[44:47], s63 offen offset:256 sc1
  s_mov_b64 exec, s[66:67]
  s_waitcnt vmcnt(16)
  s_barrier
  s_cmp_lt_u32 s2, 216
  s_cselect_b32 s63, s62, 0x7000000
  ds_read_b64_tr_b16 v[40:41], v6 offset:64
  ds_read_b64_tr_b16 v[42:43], v6 offset:2112
  ds_read_b64_tr_b16 v[44:45], v6 offset:1088
  ds_read_b64_tr_b16 v[46:47], v6 offset:3136
  ds_read_b64_tr_b16 v[48:49], v6 offset:4160
  ds_read_b64_tr_b16 v[50:51], v6 offset:6208
  ds_read_b64_tr_b16 v[52:53], v6 offset:5184
  ds_read_b64_tr_b16 v[54:55], v6 offset:7232
  ds_read_b64_tr_b16 v[56:57], v7 offset:8256
  ds_read_b64_tr_b16 v[58:59], v7 offset:8768
  s_lshr_b32 s52, s2, 3
  s_and_b32 s53, s2, 7
  s_lshl_b32 s54, s52, 2
  s_add_u32 s54, s54, 2
  s_mul_i32 s55, s54, 9363
  s_lshr_b32 s55, s55, 16
  s_mul_i32 s56, s55, 7
  s_sub_u32 s56, s54, s56
  s_mul_i32 s53, s53, 5
  s_mul_i32 s52, s53, 3
  s_add_u32 s52, s52, s56
  s_mul_i32 s54, s56, 40
  s_add_u32 s54, s54, s53
  s_cmp_lt_u32 s56, 3
  s_cselect_b32 s52, s52, s54
  s_movk_i32 s54, 0x400
  s_cselect_b32 s53, 3072, s54
  s_lshl_b32 s52, s52, 10
  s_mul_i32 s55, s55, 294912
  s_add_u32 s52, s52, s55
  s_add_u32 s52, s52, 0x1800000
  s_cmp_lt_u32 s2, 216
  s_cselect_b32 s52, s52, 0x7000000
  s_waitcnt lgkmcnt(0)
  v_mfma_f32_32x32x16_bf16 v[64:79], v[120:123], v[40:43], 0
  buffer_store_dwordx4 v[40:43], v2, s[44:47], s52 offen sc1
  s_add_u32 s52, s52, s53
  v_mfma_f32_32x32x16_bf16 v[64:79], v[124:127], v[44:47], v[64:79]
  buffer_store_dwordx4 v[44:47], v2, s[44:47], s52 offen sc1
  s_add_u32 s52, s52, s53
  v_mfma_f32_32x32x16_bf16 v[64:79], v[128:131], v[48:51], v[64:79]
  buffer_store_dwordx4 v[48:51], v2, s[44:47], s52 offen sc1
  s_add_u32 s52, s52, s53
  v_mfma_f32_32x32x16_bf16 v[64:79], v[132:135], v[52:55], v[64:79]
  buffer_store_dwordx4 v[52:55], v2, s[44:47], s52 offen sc1
  s_add_u32 s52, s52, s53
  v_mfma_f32_32x32x16_bf16 v[64:79], v[136:139], v[56:59], v[64:79]
  buffer_store_dwordx4 v[56:59], v2, s[44:47], s52 offen sc1
  s_mov_b64 s[66:67], exec
  s_mov_b32 exec_hi, 0
  s_nop 8
  buffer_store_dwordx2 v[64:65], v12, s[44:47], s63 offen offset:512 sc1
  s_mov_b64 exec, s[66:67]
  s_waitcnt vmcnt(12)
  s_barrier
  s_cmp_lt_u32 s2, 216
  s_cselect_b32 s63, s62, 0x7000000
  ds_read_b64_tr_b16 v[80:81], v6 offset:96
  ds_read_b64_tr_b16 v[82:83], v6 offset:2144
  ds_read_b64_tr_b16 v[84:85], v6 offset:1120
  ds_read_b64_tr_b16 v[86:87], v6 offset:3168
  ds_read_b64_tr_b16 v[88:89], v6 offset:4192
  ds_read_b64_tr_b16 v[90:91], v6 offset:6240
  ds_read_b64_tr_b16 v[92:93], v6 offset:5216
  ds_read_b64_tr_b16 v[94:95], v6 offset:7264
  ds_read_b64_tr_b16 v[96:97], v7 offset:8288
  ds_read_b64_tr_b16 v[98:99], v7 offset:8800
  s_lshr_b32 s52, s2, 3
  s_and_b32 s53, s2, 7
  s_lshl_b32 s54, s52, 2
  s_add_u32 s54, s54, 3
  s_mul_i32 s55, s54, 9363
  s_lshr_b32 s55, s55, 16
  s_mul_i32 s56, s55, 7
  s_sub_u32 s56, s54, s56
  s_mul_i32 s53, s53, 5
  s_mul_i32 s52, s53, 3
  s_add_u32 s52, s52, s56
  s_mul_i32 s54, s56, 40
  s_add_u32 s54, s54, s53
  s_cmp_lt_u32 s56, 3
  s_cselect_b32 s52, s52, s54
  s_movk_i32 s54, 0x400
  s_cselect_b32 s53, 3072, s54
  s_lshl_b32 s52, s52, 10
  s_mul_i32 s55, s55, 294912
  s_add_u32 s52, s52, s55
  s_add_u32 s52, s52, 0x1800000
  s_cmp_lt_u32 s2, 216
  s_cselect_b32 s52, s52, 0x7000000
  s_waitcnt lgkmcnt(0)
  v_mfma_f32_32x32x16_bf16 v[64:79], v[120:123], v[80:83], 0
  buffer_store_dwordx4 v[80:83], v2, s[44:47], s52 offen sc1
  s_add_u32 s52, s52, s53
  v_mfma_f32_32x32x16_bf16 v[64:79], v[124:127], v[84:87], v[64:79]
  buffer_store_dwordx4 v[84:87], v2, s[44:47], s52 offen sc1
  s_add_u32 s52, s52, s53
  v_mfma_f32_32x32x16_bf16 v[64:79], v[128:131], v[88:91], v[64:79]
  buffer_store_dwordx4 v[88:91], v2, s[44:47], s52 offen sc1
  s_add_u32 s52, s52, s53
  v_mfma_f32_32x32x16_bf16 v[64:79], v[132:135], v[92:95], v[64:79]
  buffer_store_dwordx4 v[92:95], v2, s[44:47], s52 offen sc1
  s_add_u32 s52, s52, s53
  v_mfma_f32_32x32x16_bf16 v[64:79], v[136:139], v[96:99], v[64:79]
  buffer_store_dwordx4 v[96:99], v2, s[44:47], s52 offen sc1
  s_mov_b64 s[66:67], exec
  s_mov_b32 exec_hi, 0
  s_nop 8
  buffer_store_dwordx2 v[64:65], v12, s[44:47], s63 offen offset:768 sc1
  s_mov_b64 exec, s[66:67]
  s_barrier
L_p2_done:
  s_cmp_lg_u32 s3, 3
  s_cbranch_scc1 L_sm3_9
  s_lshr_b32 s54, s95, 3
  s_lshl_b32 s54, s54, 3
  s_add_u32 s54, s54, s96
  s_and_b32 s55, s95, 7
  s_mul_i32 s56, s54, 1280
  s_mul_i32 s57, s55, 160
  s_add_u32 s56, s56, s57
  s_movk_i32 s58, 6554
  s_mov_b32 s59, 40960
  v_add_u32 v4, 0, v1
  v_mul_u32_u24 v5, s58, v4
  v_lshrrev_b32 v5, 16, v5
  v_mul_u32_u24 v6, 10, v5
  v_sub_u32 v6, v4, v6
  v_lshlrev_b32 v6, 4, v6
  v_mad_u32_u24 v6, v5, s59, v6
  s_mov_b32 m0, 110592
  s_nop 0
  buffer_load_dwordx4 v6, s[4:7], s56 offen lds
  v_add_u32 v4, 64, v1
  v_mul_u32_u24 v5, s58, v4
  v_lshrrev_b32 v5, 16, v5
  v_mul_u32_u24 v6, 10, v5
  v_sub_u32 v6, v4, v6
  v_lshlrev_b32 v6, 4, v6
  v_mad_u32_u24 v6, v5, s59, v6
  s_mov_b32 m0, 111616
  s_nop 0
  buffer_load_dwordx4 v6, s[4:7], s56 offen lds
  v_add_u32 v4, 128, v1
  v_mul_u32_u24 v5, s58, v4
  v_lshrrev_b32 v5, 16, v5
  v_mul_u32_u24 v6, 10, v5
  v_sub_u32 v6, v4, v6
  v_lshlrev_b32 v6, 4, v6
  v_mad_u32_u24 v6, v5, s59, v6
  s_mov_b32 m0, 112640
  s_nop 0
  buffer_load_dwordx4 v6, s[4:7], s56 offen lds
  v_add_u32 v4, 192, v1
  v_mul_u32_u24 v5, s58, v4
  v_lshrrev_b32 v5, 16, v5
  v_mul_u32_u24 v6, 10, v5
  v_sub_u32 v6, v4, v6
  v_lshlrev_b32 v6, 4, v6
  v_mad_u32_u24 v6, v5, s59, v6
  s_mov_b32 m0, 113664
  s_nop 0
  buffer_load_dwordx4 v6, s[4:7], s56 offen lds
  v_add_u32 v4, 256, v1
  v_mul_u32_u24 v5, s58, v4
  v_lshrrev_b32 v5, 16, v5
  v_mul_u32_u24 v6, 10, v5
  v_sub_u32 v6, v4, v6
  v_lshlrev_b32 v6, 4, v6
  v_mad_u32_u24 v6, v5, s59, v6
  s_mov_b32 m0, 114688
  s_nop 0
  buffer_load_dwordx4 v6, s[4:7], s56 offen lds
  v_add_u32 v4, 320, v1
  v_mul_u32_u24 v5, s58, v4
  v_lshrrev_b32 v5, 16, v5
  v_mul_u32_u24 v6, 10, v5
  v_sub_u32 v6, v4, v6
  v_lshlrev_b32 v6, 4, v6
  v_mad_u32_u24 v6, v5, s59, v6
  s_mov_b32 m0, 115712
  s_nop 0
  buffer_load_dwordx4 v6, s[4:7], s56 offen lds
  v_add_u32 v4, 384, v1
  v_mul_u32_u24 v5, s58, v4
  v_lshrrev_b32 v5, 16, v5
  v_mul_u32_u24 v6, 10, v5
  v_sub_u32 v6, v4, v6
  v_lshlrev_b32 v6, 4, v6
  v_mad_u32_u24 v6, v5, s59, v6
  s_mov_b32 m0, 116736
  s_nop 0
  buffer_load_dwordx4 v6, s[4:7], s56 offen lds
  v_add_u32 v4, 448, v1
  v_mul_u32_u24 v5, s58, v4
  v_lshrrev_b32 v5, 16, v5
  v_mul_u32_u24 v6, 10, v5
  v_sub_u32 v6, v4, v6
  v_lshlrev_b32 v6, 4, v6
  v_mad_u32_u24 v6, v5, s59, v6
  s_mov_b32 m0, 117760
  s_nop 0
  buffer_load_dwordx4 v6, s[4:7], s56 offen lds
  v_add_u32 v4, 512, v1
  v_mul_u32_u24 v5, s58, v4
  v_lshrrev_b32 v5, 16, v5
  v_mul_u32_u24 v6, 10, v5
  v_sub_u32 v6, v4, v6
  v_lshlrev_b32 v6, 4, v6
  v_mad_u32_u24 v6, v5, s59, v6
  s_mov_b32 m0, 118784
  s_nop 0
  buffer_load_dwordx4 v6, s[4:7], s56 offen lds
  v_add_u32 v4, 576, v1
  v_mul_u32_u24 v5, s58, v4
  v_lshrrev_b32 v5, 16, v5
  v_mul_u32_u24 v6, 10, v5
  v_sub_u32 v6, v4, v6
  v_lshlrev_b32 v6, 4, v6
  v_mad_u32_u24 v6, v5, s59, v6
  s_mov_b32 m0, 119808
  s_nop 0
  buffer_load_dwordx4 v6, s[4:7], s56 offen lds
  v_min_u32 v4, 39, v1
  v_lshlrev_b32 v5, 4, v4
  v_add_u32 v6, 7872, v5
  v_cmp_gt_u32 vcc, 20, v4
  s_nop 1
  v_cndmask_b32 v6, v6, v5, vcc
  s_mul_i32 s56, s55, 320
  s_add_u32 s56, s56, 0x450000
  s_mov_b32 m0, 120832
  s_nop 0
  buffer_load_dwordx4 v6, s[44:47], s56 offen sc1 lds
  v_min_u32 v4, 19, v1
  v_lshlrev_b32 v6, 4, v4
  s_add_u32 s56, s56, 4096
  s_mov_b32 m0, 161280
  s_nop 0
  buffer_load_dwordx4 v6, s[44:47], s56 offen sc1 lds
  v_lshlrev_b32 v2, 4, v1
  s_mul_i32 s56, s55, 107520
  s_add_u32 s56, s56, 0x360000
  s_mov_b32 m0, 0
  s_nop 0
  buffer_load_dwordx4 v2, s[44:47], s56 offen sc1 lds
  buffer_load_dwordx4 v2, s[44:47], s56 offen offset:1024 sc1 lds
  buffer_load_dwordx4 v2, s[44:47], s56 offen offset:2048 sc1 lds
  buffer_load_dwordx4 v2, s[44:47], s56 offen offset:3072 sc1 lds
  s_add_u32 s56, s56, 4096
  s_mov_b32 m0, 4096
  s_nop 0
  buffer_load_dwordx4 v2, s[44:47], s56 offen sc1 lds
  buffer_load_dwordx4 v2, s[44:47], s56 offen offset:1024 sc1 lds
  buffer_load_dwordx4 v2, s[44:47], s56 offen offset:2048 sc1 lds
  buffer_load_dwordx4 v2, s[44:47], s56 offen offset:3072 sc1 lds
  s_add_u32 s56, s56, 4096
  s_mov_b32 m0, 8192
  s_nop 0
  buffer_load_dwordx4 v2, s[44:47], s56 offen sc1 lds
  buffer_load_dwordx4 v2, s[44:47], s56 offen offset:1024 sc1 lds
  buffer_load_dwordx4 v2, s[44:47], s56 offen offset:2048 sc1 lds
  buffer_load_dwordx4 v2, s[44:47], s56 offen offset:3072 sc1 lds
  s_add_u32 s56, s56, 4096
  s_mov_b32 m0, 12288
  s_nop 0
  buffer_load_dwordx4 v2, s[44:47], s56 offen sc1 lds
  buffer_load_dwordx4 v2, s[44:47], s56 offen offset:1024 sc1 lds
  buffer_load_dwordx4 v2, s[44:47], s56 offen offset:2048 sc1 lds
  buffer_load_dwordx4 v2, s[44:47], s56 offen offset:3072 sc1 lds
  s_add_u32 s56, s56, 4096
  s_mov_b32 m0, 16384
  s_nop 0
  buffer_load_dwordx4 v2, s[44:47], s56 offen sc1 lds
  buffer_load_dwordx4 v2, s[44:47], s56 offen offset:1024 sc1 lds
  buffer_load_dwordx4 v2, s[44:47], s56 offen offset:2048 sc1 lds
  buffer_load_dwordx4 v2, s[44:47], s56 offen offset:3072 sc1 lds
  s_add_u32 s56, s56, 4096
  s_mov_b32 m0, 20480
  s_nop 0
  buffer_load_dwordx4 v2, s[44:47], s56 offen sc1 lds
  buffer_load_dwordx4 v2, s[44:47], s56 offen offset:1024 sc1 lds
  buffer_load_dwordx4 v2, s[44:47], s56 offen offset:2048 sc1 lds
  buffer_load_dwordx4 v2, s[44:47], s56 offen offset:3072 sc1 lds
  s_add_u32 s56, s56, 4096
  s_mov_b32 m0, 24576
  s_nop 0
  buffer_load_dwordx4 v2, s[44:47], s56 offen sc1 lds
  buffer_load_dwordx4 v2, s[44:47], s56 offen offset:1024 sc1 lds
  buffer_load_dwordx4 v2, s[44:47], s56 offen offset:2048 sc1 lds
  buffer_load_dwordx4 v2, s[44:47], s56 offen offset:3072 sc1 lds
  s_add_u32 s56, s56, 4096
  s_mov_b32 m0, 28672
  s_nop 0
  buffer_load_dwordx4 v2, s[44:47], s56 offen sc1 lds
  buffer_load_dwordx4 v2, s[44:47], s56 offen offset:1024 sc1 lds
  buffer_load_dwordx4 v2, s[44:47], s56 offen offset:2048 sc1 lds
  buffer_load_dwordx4 v2, s[44:47], s56 offen offset:3072 sc1 lds
L_sm3_9:
  s_cmp_ge_u32 s2, 216
  s_cbranch_scc1 L_rp2u_10
  s_lshl_b32 s63, s2, 1
  s_add_u32 s63, s63, s3
  s_cmp_ge_u32 s3, 2
  s_cselect_b32 s63, 1000, s63
  s_branch L_rp2v_11
L_rp2u_10:
  s_sub_u32 s63, s2, 216
  s_lshl_b32 s63, s63, 2
  s_add_u32 s63, s63, s3
  s_add_u32 s63, s63, 432
L_rp2v_11:
  s_mul_i32 s55, s63, 205
  s_lshr_b32 s55, s55, 11
  s_mul_i32 s56, s55, 10
  s_sub_u32 s56, s63, s56
  s_cmp_ge_u32 s63, 540
  s_cbranch_scc1 L_rp2_i_done
  v_lshrrev_b32 v4, 3, v1
  v_and_b32 v5, 7, v1
  v_mul_u32_u24 v4, 1280, v4
  v_lshl_add_u32 v4, v5, 4, v4
  s_lshl_b32 s54, s3, 12
  s_add_u32 s54, s54, 128000
  s_lshl_b32 s58, s56, 7
  s_lshl_b32 s60, s55, 1
  s_lshr_b32 s61, s60, 4
  s_and_b32 s62, s60, 15
  s_mul_i32 s62, s62, 7
  s_add_u32 s59, s61, s62
  s_sub_u32 s61, s60, 48
  s_mul_i32 s62, s61, 4370
  s_lshr_b32 s62, s62, 16
  s_mul_i32 s48, s62, 15
  s_sub_u32 s61, s61, s48
  s_mul_i32 s61, s61, 7
  s_add_u32 s61, s61, s62
  s_add_u32 s61, s61, 3
  s_cmp_lt_u32 s60, 48
  s_cselect_b32 s59, s59, s61
  s_mul_i32 s57, s59, 20480
  s_add_u32 s57, s57, s58
  s_add_u32 m0, s54, 0
  s_nop 0
  buffer_load_dwordx4 v4, s[24:27], s57 offen lds
  s_add_u32 s57, s57, 10240
  s_add_u32 m0, s54, 1024
  s_nop 0
  buffer_load_dwordx4 v4, s[24:27], s57 offen lds
  s_lshl_b32 s60, s55, 1
  s_add_u32 s60, s60, 1
  s_lshr_b32 s61, s60, 4
  s_and_b32 s62, s60, 15
  s_mul_i32 s62, s62, 7
  s_add_u32 s59, s61, s62
  s_sub_u32 s61, s60, 48
  s_mul_i32 s62, s61, 4370
  s_lshr_b32 s62, s62, 16
  s_mul_i32 s48, s62, 15
  s_sub_u32 s61, s61, s48
  s_mul_i32 s61, s61, 7
  s_add_u32 s61, s61, s62
  s_add_u32 s61, s61, 3
  s_cmp_lt_u32 s60, 48
  s_cselect_b32 s59, s59, s61
  s_mul_i32 s57, s59, 20480
  s_add_u32 s57, s57, s58
  s_add_u32 m0, s54, 2048
  s_nop 0
  buffer_load_dwordx4 v4, s[24:27], s57 offen lds
  s_add_u32 s57, s57, 10240
  s_add_u32 m0, s54, 3072
  s_nop 0
  buffer_load_dwordx4 v4, s[24:27], s57 offen lds
L_rp2_i_done:
  s_cmp_lg_u32 s3, 3
  s_cbranch_scc1 L_b2w_14
  s_cmp_ge_u32 s63, 540
  s_cbranch_scc1 L_b2x_15
  s_waitcnt vmcnt(36)
  s_branch L_b2v_13
L_b2x_15:
  s_waitcnt vmcnt(32)
  s_branch L_b2v_13
L_b2w_14:
  s_cmp_ge_u32 s63, 540
  s_cbranch_scc1 L_b2u_12
  s_waitcnt vmcnt(4)
  s_branch L_b2v_13
L_b2u_12:
  s_waitcnt vmcnt(0)
L_b2v_13:
  s_barrier
  s_cmp_lg_u32 s3, 0
  s_cbranch_scc1 L_nw0_16
  s_lshr_b32 s48, s2, 4
  s_lshl_b32 s48, s48, 8
  s_add_u32 s48, s48, 0x1708000
  v_lshlrev_b32 v3, 12, v1
  v_mov_b32 v2, 1
  s_mov_b64 s[50:51], exec
  s_mov_b64 exec, 0xff
  buffer_atomic_add v2, v3, s[44:47], s48 offen sc1
  s_mov_b64 exec, s[50:51]
L_nw0_16:
  v_and_b32 v4, 15, v1
  v_lshrrev_b32 v5, 4, v1
  s_lshl_b32 s56, s3, 4
  v_add_u32 v6, s56, v4
  v_mul_u32_u24 v6, 160, v6
  v_lshl_add_u32 v6, v5, 3, v6
  v_add_u32 v6, 110592, v6
  v_lshlrev_b32 v7, 4, v5
  v_add_u32 v7, 120832, v7
  ds_read_b64 v[200:201], v6 offset:0
  ds_read_b64 v[202:203], v6 offset:32
  ds_read_b64 v[204:205], v6 offset:64
  ds_read_b64 v[206:207], v6 offset:96
  ds_read_b64 v[208:209], v6 offset:128
  ds_read_b128 v[160:163], v7 offset:0
  ds_read_b128 v[180:183], v7 offset:320
  ds_read_b128 v[164:167], v7 offset:64
  ds_read_b128 v[184:187], v7 offset:384
  ds_read_b128 v[168:171], v7 offset:128
  ds_read_b128 v[188:191], v7 offset:448
  ds_read_b128 v[172:175], v7 offset:192
  ds_read_b128 v[192:195], v7 offset:512
  ds_read_b128 v[176:179], v7 offset:256
  ds_read_b128 v[196:199], v7 offset:576
  s_lshr_b32 s54, s95, 3
  s_lshl_b32 s54, s54, 3
  s_add_u32 s54, s54, s96
  s_and_b32 s55, s95, 7
  v_lshlrev_b32 v2, 4, v1
  s_mul_i32 s56, s55, 107520
  s_lshl_b32 s57, s3, 10
  s_add_u32 s56, s56, s57
  s_add_u32 s56, s56, 0x368000
  s_add_u32 m0, s57, 32768
  s_nop 0
  buffer_load_dwordx4 v2, s[44:47], s56 offen sc1 lds
  s_add_u32 s56, s56, 4096
  s_add_u32 m0, s57, 36864
  s_nop 0
  buffer_load_dwordx4 v2, s[44:47], s56 offen sc1 lds
  s_add_u32 s56, s56, 4096
  s_add_u32 m0, s57, 40960
  s_nop 0
  buffer_load_dwordx4 v2, s[44:47], s56 offen sc1 lds
  s_add_u32 s56, s56, 4096
  s_add_u32 m0, s57, 45056
  s_nop 0
  buffer_load_dwordx4 v2, s[44:47], s56 offen sc1 lds
  s_add_u32 s56, s56, 4096
  s_add_u32 m0, s57, 49152
  s_nop 0
  buffer_load_dwordx4 v2, s[44:47], s56 offen sc1 lds
  s_add_u32 s56, s56, 4096
  s_add_u32 m0, s57, 53248
  s_nop 0
  buffer_load_dwordx4 v2, s[44:47], s56 offen sc1 lds
  s_add_u32 s56, s56, 4096
  s_add_u32 m0, s57, 57344
  s_nop 0
  buffer_load_dwordx4 v2, s[44:47], s56 offen sc1 lds
  s_add_u32 s56, s56, 4096
  s_add_u32 m0, s57, 61440
  s_nop 0
  buffer_load_dwordx4 v2, s[44:47], s56 offen sc1 lds
  s_add_u32 s56, s56, 4096
  s_add_u32 m0, s57, 65536
  s_nop 0
  buffer_load_dwordx4 v2, s[44:47], s56 offen sc1 lds
  s_add_u32 s56, s56, 4096
  s_add_u32 m0, s57, 69632
  s_nop 0
  buffer_load_dwordx4 v2, s[44:47], s56 offen sc1 lds
  s_add_u32 s56, s56, 4096
  s_add_u32 m0, s57, 73728
  s_nop 0
  buffer_load_dwordx4 v2, s[44:47], s56 offen sc1 lds
  s_add_u32 s56, s56, 4096
  s_add_u32 m0, s57, 77824
  s_nop 0
  buffer_load_dwordx4 v2, s[44:47], s56 offen sc1 lds
  s_add_u32 s56, s56, 4096
  s_add_u32 m0, s57, 81920
  s_nop 0
  buffer_load_dwordx4 v2, s[44:47], s56 offen sc1 lds
  s_add_u32 s56, s56, 4096
  s_add_u32 m0, s57, 86016
  s_nop 0
  buffer_load_dwordx4 v2, s[44:47], s56 offen sc1 lds
  s_add_u32 s56, s56, 4096
  s_add_u32 m0, s57, 90112
  s_nop 0
  buffer_load_dwordx4 v2, s[44:47], s56 offen sc1 lds
  s_add_u32 s56, s56, 4096
  s_add_u32 m0, s57, 94208
  s_nop 0
  buffer_load_dwordx4 v2, s[44:47], s56 offen sc1 lds
  s_add_u32 s56, s56, 4096
  s_add_u32 m0, s57, 98304
  s_nop 0
  buffer_load_dwordx4 v2, s[44:47], s56 offen sc1 lds
  s_add_u32 s56, s56, 4096
  s_add_u32 m0, s57, 102400
  s_nop 0
  buffer_load_dwordx4 v2, s[44:47], s56 offen sc1 lds
  s_add_u32 s56, s56, 4096
  s_add_u32 m0, s57, 106496
  s_nop 0
  buffer_load_dwordx4 v2, s[44:47], s56 offen sc1 lds
  s_waitcnt vmcnt(19)
  s_cmp_ge_u32 s2, 216
  s_cbranch_scc1 L_rp2u_17
  s_lshl_b32 s63, s2, 1
  s_add_u32 s63, s63, s3
  s_cmp_ge_u32 s3, 2
  s_cselect_b32 s63, 1000, s63
  s_branch L_rp2v_18
L_rp2u_17:
  s_sub_u32 s63, s2, 216
  s_lshl_b32 s63, s63, 2
  s_add_u32 s63, s63, s3
  s_add_u32 s63, s63, 432
L_rp2v_18:
  s_mul_i32 s55, s63, 205
  s_lshr_b32 s55, s55, 11
  s_mul_i32 s56, s55, 10
  s_sub_u32 s56, s63, s56
  s_cmp_ge_u32 s63, 540
  s_cbranch_scc1 L_rp2_done
  v_lshrrev_b32 v10, 4, v1
  v_lshrrev_b32 v11, 1, v10
  v_and_b32 v10, 1, v10
  v_lshlrev_b32 v11, 4, v11
  v_lshl_add_u32 v11, v10, 2, v11
  v_bfe_u32 v12, v1, 2, 2
  v_add_u32 v11, v11, v12
  v_and_b32 v13, 3, v1
  v_lshlrev_b32 v13, 3, v13
  v_lshl_add_u32 v6, v11, 7, v13
  s_lshl_b32 s54, s3, 12
  s_add_u32 s54, s54, 128000
  v_add_u32 v6, s54, v6
  v_lshlrev_b32 v8, 4, v1
  ds_read_b64_tr_b16 v[60:61], v6 offset:0
  ds_read_b64_tr_b16 v[62:63], v6 offset:1024
  ds_read_b64_tr_b16 v[64:65], v6 offset:32
  ds_read_b64_tr_b16 v[66:67], v6 offset:1056
  ds_read_b64_tr_b16 v[68:69], v6 offset:64
  ds_read_b64_tr_b16 v[70:71], v6 offset:1088
  ds_read_b64_tr_b16 v[72:73], v6 offset:96
  ds_read_b64_tr_b16 v[74:75], v6 offset:1120
  s_lshl_b32 s57, s56, 2
  s_add_u32 s57, s57, 0
  s_mul_i32 s58, s57, 52
  s_lshr_b32 s58, s58, 8
  s_mul_i32 s59, s58, 5
  s_sub_u32 s59, s57, s59
  s_mul_i32 s58, s58, 54
  s_add_u32 s58, s58, s55
  s_mul_i32 s58, s58, 5
  s_add_u32 s58, s58, s59
  s_lshl_b32 s58, s58, 10
  s_add_u32 s58, s58, 0xb40000
  s_waitcnt lgkmcnt(6)
  buffer_store_dwordx4 v[60:63], v8, s[44:47], s58 offen sc1
  s_lshl_b32 s57, s56, 2
  s_add_u32 s57, s57, 1
  s_mul_i32 s58, s57, 52
  s_lshr_b32 s58, s58, 8
  s_mul_i32 s59, s58, 5
  s_sub_u32 s59, s57, s59
  s_mul_i32 s58, s58, 54
  s_add_u32 s58, s58, s55
  s_mul_i32 s58, s58, 5
  s_add_u32 s58, s58, s59
  s_lshl_b32 s58, s58, 10
  s_add_u32 s58, s58, 0xb40000
  s_waitcnt lgkmcnt(4)
  buffer_store_dwordx4 v[64:67], v8, s[44:47], s58 offen sc1
  s_lshl_b32 s57, s56, 2
  s_add_u32 s57, s57, 2
  s_mul_i32 s58, s57, 52
  s_lshr_b32 s58, s58, 8
  s_mul_i32 s59, s58, 5
  s_sub_u32 s59, s57, s59
  s_mul_i32 s58, s58, 54
  s_add_u32 s58, s58, s55
  s_mul_i32 s58, s58, 5
  s_add_u32 s58, s58, s59
  s_lshl_b32 s58, s58, 10
  s_add_u32 s58, s58, 0xb40000
  s_waitcnt lgkmcnt(2)
  buffer_store_dwordx4 v[68:71], v8, s[44:47], s58 offen sc1
  s_lshl_b32 s57, s56, 2
  s_add_u32 s57, s57, 3
  s_mul_i32 s58, s57, 52
  s_lshr_b32 s58, s58, 8
  s_mul_i32 s59, s58, 5
  s_sub_u32 s59, s57, s59
  s_mul_i32 s58, s58, 54
  s_add_u32 s58, s58, s55
  s_mul_i32 s58, s58, 5
  s_add_u32 s58, s58, s59
  s_lshl_b32 s58, s58, 10
  s_add_u32 s58, s58, 0xb40000
  s_waitcnt lgkmcnt(0)
  buffer_store_dwordx4 v[72:75], v8, s[44:47], s58 offen sc1
L_rp2_done:
  v_and_b32 v4, 15, v1
  v_lshrrev_b32 v5, 4, v1
  s_lshl_b32 s56, s3, 4
  v_add_u32 v8, s56, v4
  v_cvt_f32_u32 v8, v8
  v_mul_f32 v8, 0x3c000000, v8
  v_lshlrev_b32 v9, 2, v5
  v_cvt_f32_u32 v9, v9
  v_mov_b32 v10, v9
  v_mul_f32 v11, v10, v8
  v_cos_f32 v20, v11
  v_mov_b32 v10, v9
  v_mul_f32 v11, v10, v8
  v_add_f32 v11, 0x3e800000, v11
  v_mul_f32 v12, 0x42800000, v8
  v_cmp_gt_u32 vcc, 16, v1
  s_nop 1
  v_cndmask_b32 v11, v11, v12, vcc
  v_cos_f32 v21, v11
  v_add_f32 v10, 0x40000000, v9
  v_mul_f32 v11, v10, v8
  v_cos_f32 v22, v11
  v_add_f32 v10, 0x40000000, v9
  v_mul_f32 v11, v10, v8
  v_add_f32 v11, 0x3e800000, v11
  v_cos_f32 v23, v11
  v_add_f32 v10, 0x41800000, v9
  v_mul_f32 v11, v10, v8
  v_cos_f32 v24, v11
  v_add_f32 v10, 0x41800000, v9
  v_mul_f32 v11, v10, v8
  v_add_f32 v11, 0x3e800000, v11
  v_cos_f32 v25, v11
  v_add_f32 v10, 0x41900000, v9
  v_mul_f32 v11, v10, v8
  v_cos_f32 v26, v11
  v_add_f32 v10, 0x41900000, v9
  v_mul_f32 v11, v10, v8
  v_add_f32 v11, 0x3e800000, v11
  v_cos_f32 v27, v11
  v_cvt_pk_bf16_f32 v210, v20, v21
  v_cvt_pk_bf16_f32 v211, v22, v23
  v_cvt_pk_bf16_f32 v212, v24, v25
  v_cvt_pk_bf16_f32 v213, v26, v27
  v_add_f32 v10, 0x42000000, v9
  v_mul_f32 v11, v10, v8
  v_cos_f32 v20, v11
  v_add_f32 v10, 0x42000000, v9
  v_mul_f32 v11, v10, v8
  v_add_f32 v11, 0x3e800000, v11
  v_cos_f32 v21, v11
  v_add_f32 v10, 0x42080000, v9
  v_mul_f32 v11, v10, v8
  v_cos_f32 v22, v11
  v_add_f32 v10, 0x42080000, v9
  v_mul_f32 v11, v10, v8
  v_add_f32 v11, 0x3e800000, v11
  v_cos_f32 v23, v11
  v_add_f32 v10, 0x42400000, v9
  v_mul_f32 v11, v10, v8
  v_cos_f32 v24, v11
  v_add_f32 v10, 0x42400000, v9
  v_mul_f32 v11, v10, v8
  v_add_f32 v11, 0x3e800000, v11
  v_cos_f32 v25, v11
  v_add_f32 v10, 0x42480000, v9
  v_mul_f32 v11, v10, v8
  v_cos_f32 v26, v11
  v_add_f32 v10, 0x42480000, v9
  v_mul_f32 v11, v10, v8
  v_add_f32 v11, 0x3e800000, v11
  v_cos_f32 v27, v11
  v_cvt_pk_bf16_f32 v214, v20, v21
  v_cvt_pk_bf16_f32 v215, v22, v23
  v_cvt_pk_bf16_f32 v216, v24, v25
  v_cvt_pk_bf16_f32 v217, v26, v27
  s_lshr_b32 s54, s95, 3
  s_lshl_b32 s54, s54, 2
  s_lshr_b32 s55, s96, 1
  s_add_u32 s54, s54, s55
  s_and_b32 s55, s96, 1
  s_lshl_b32 s55, s55, 3
  s_and_b32 s56, s95, 7
  s_add_u32 s55, s55, s56
  s_lshl_b32 s66, s3, 12
  s_mul_i32 s64, s55, 294912
  s_add_u32 s64, s64, s66
  s_add_u32 s64, s64, 0x1800000
  s_and_b32 s56, s95, 7
  s_mul_i32 s56, s56, 276480
  s_add_u32 s56, s56, s66
  s_add_u32 s65, s56, 0xb40000
  s_add_u32 m0, s66, 114688
  s_lshr_b32 s54, s95, 3
  s_lshl_b32 s54, s54, 3
  s_add_u32 s54, s54, s96
  s_and_b32 s55, s95, 7
  v_and_b32 v4, 15, v1
  v_lshrrev_b32 v5, 4, v1
  v_lshrrev_b32 v6, 2, v4
  v_lshlrev_b32 v6, 8, v6
  v_lshrrev_b32 v7, 1, v5
  v_lshl_add_u32 v6, v7, 7, v6
  v_and_b32 v7, 3, v4
  v_lshl_add_u32 v6, v7, 5, v6
  v_and_b32 v7, 1, v5
  v_lshl_add_u32 v6, v7, 4, v6
  s_mul_i32 s56, s54, 86016
  s_lshl_b32 s57, s3, 10
  s_add_u32 s56, s56, s57
  s_add_u32 s56, s56, 0x460000
  s_cmp_lg_u32 s3, 0
  s_cbranch_scc1 L_nw0_19
  v_and_b32 v3, 15, v1
  v_lshlrev_b32 v3, 8, v3
  s_and_b32 s48, s2, 7
  s_mul_i32 s48, s48, 4096
  s_add_u32 s48, s48, 0x1708000
  s_mov_b32 s49, 0
L_poll_20:
  s_add_u32 s49, s49, 1
  s_cmp_gt_u32 s49, 100000
  s_cbranch_scc1 L_pexit_21
  buffer_load_dword v2, v3, s[44:47], s48 offen sc1
  s_waitcnt vmcnt(0)
  v_cmp_gt_u32 vcc, 16, v2
  s_nop 4
  s_cbranch_vccz L_pexit_21
  s_branch L_poll_20
L_pexit_21:
L_nw0_19:
  s_waitcnt vmcnt(0)
  s_barrier
  buffer_load_dwordx4 a[0:3], v6, s[44:47], s56 offen sc1
  s_add_u32 s56, s56, 4096
  buffer_load_dwordx4 a[4:7], v6, s[44:47], s56 offen sc1
  s_add_u32 s56, s56, 4096
  buffer_load_dwordx4 a[8:11], v6, s[44:47], s56 offen sc1
  s_add_u32 s56, s56, 4096
  buffer_load_dwordx4 a[12:15], v6, s[44:47], s56 offen sc1
  s_add_u32 s56, s56, 4096
  buffer_load_dwordx4 a[16:19], v6, s[44:47], s56 offen sc1
  s_add_u32 s56, s56, 4096
  buffer_load_dwordx4 a[20:23], v6, s[44:47], s56 offen sc1
  s_add_u32 s56, s56, 4096
  buffer_load_dwordx4 a[24:27], v6, s[44:47], s56 offen sc1
  s_add_u32 s56, s56, 4096
  buffer_load_dwordx4 a[28:31], v6, s[44:47], s56 offen sc1
  s_add_u32 s56, s56, 4096
  v_lshlrev_b32 v2, 4, v1
  v_add_u32 v3, 56320, v2
  s_cmp_ge_u32 s2, 216
  s_cbranch_scc1 L_rp2u_22
  s_lshl_b32 s63, s2, 1
  s_add_u32 s63, s63, s3
  s_cmp_ge_u32 s3, 2
  s_cselect_b32 s63, 1000, s63
  s_branch L_rp2v_23
L_rp2u_22:
  s_sub_u32 s63, s2, 216
  s_lshl_b32 s63, s63, 2
  s_add_u32 s63, s63, s3
  s_add_u32 s63, s63, 432
L_rp2v_23:
  s_mul_i32 s55, s63, 205
  s_lshr_b32 s55, s55, 11
  s_mul_i32 s56, s55, 10
  s_sub_u32 s56, s63, s56
  s_lshl_b32 s62, s56, 8
  s_add_u32 s62, s62, 0x1712000
  s_cmp_ge_u32 s63, 540
  s_cselect_b32 s62, 0x7000000, s62
  v_mov_b32 v8, 1
  v_mov_b32 v9, 0
  s_mov_b64 s[50:51], exec
  s_mov_b64 exec, 1
  buffer_atomic_add v8, v9, s[44:47], s62 offen sc1
  s_mov_b64 exec, s[50:51]
  v_lshrrev_b32 v7, 5, v0
  v_and_b32 v8, 31, v0
  v_lshlrev_b32 v9, 8, v7
  v_lshl_add_u32 v9, v8, 3, v9
  s_lshr_b32 s54, s95, 3
  s_lshl_b32 s54, s54, 2
  s_lshr_b32 s55, s96, 1
  s_add_u32 s54, s54, s55
  s_and_b32 s55, s96, 1
  s_lshl_b32 s55, s55, 3
  s_and_b32 s56, s95, 7
  s_add_u32 s55, s55, s56
  s_mul_i32 s58, s55, 1792
  s_add_u32 s58, s58, 0xd60000
  s_lshr_b32 s54, s95, 3
  s_lshl_b32 s54, s54, 3
  s_add_u32 s54, s54, s96
  s_and_b32 s55, s95, 7
  s_mul_i32 s56, s54, 86016
  s_lshl_b32 s57, s3, 10
  s_add_u32 s56, s56, s57
  s_add_u32 s56, s56, 0x468000
  ds_read_b128 v[60:63], v2 offset:0
  ds_read_b128 v[64:67], v2 offset:1024
  ds_read_b128 v[68:71], v2 offset:2048
  ds_read_b128 v[72:75], v2 offset:3072
  ds_read_b128 v[76:79], v2 offset:4096
  ds_read_b128 v[80:83], v2 offset:5120
  ds_read_b128 v[84:87], v2 offset:6144
  ds_read_b128 v[88:91], v2 offset:7168
  ds_read_b128 v[92:95], v2 offset:8192
  ds_read_b128 v[96:99], v2 offset:9216
  s_waitcnt vmcnt(8) lgkmcnt(5)
  v_mfma_f32_16x16x32_bf16 v[40:43], a[0:3], v[60:63], 0
  v_mfma_f32_16x16x32_bf16 v[44:47], a[0:3], v[64:67], 0
  buffer_load_dwordx4 a[32:35], v6, s[44:47], s56 offen sc1
  s_add_u32 s56, s56, 4096
  v_mfma_f32_16x16x32_bf16 v[48:51], a[0:3], v[68:71], 0
  v_mfma_f32_16x16x32_bf16 v[52:55], a[0:3], v[72:75], 0
  v_mfma_f32_16x16x32_bf16 v[56:59], a[0:3], v[76:79], 0
  ds_read_b128 v[60:63], v2 offset:10240
  ds_read_b128 v[64:67], v2 offset:11264
  ds_read_b128 v[68:71], v2 offset:12288
  ds_read_b128 v[72:75], v2 offset:13312
  ds_read_b128 v[76:79], v2 offset:14336
  s_waitcnt vmcnt(8) lgkmcnt(5)
  v_mfma_f32_16x16x32_bf16 v[40:43], a[4:7], v[80:83], v[40:43]
  v_mfma_f32_16x16x32_bf16 v[44:47], a[4:7], v[84:87], v[44:47]
  buffer_load_dwordx4 a[36:39], v6, s[44:47], s56 offen sc1
  s_add_u32 s56, s56, 4096
  v_mfma_f32_16x16x32_bf16 v[48:51], a[4:7], v[88:91], v[48:51]
  v_mfma_f32_16x16x32_bf16 v[52:55], a[4:7], v[92:95], v[52:55]
  v_mfma_f32_16x16x32_bf16 v[56:59], a[4:7], v[96:99], v[56:59]
  ds_read_b128 v[80:83], v2 offset:15360
  ds_read_b128 v[84:87], v2 offset:16384
  ds_read_b128 v[88:91], v2 offset:17408
  ds_read_b128 v[92:95], v2 offset:18432
  ds_read_b128 v[96:99], v2 offset:19456
  s_waitcnt vmcnt(8) lgkmcnt(5)
  v_mfma_f32_16x16x32_bf16 v[40:43], a[8:11], v[60:63], v[40:43]
  v_mfma_f32_16x16x32_bf16 v[44:47], a[8:11], v[64:67], v[44:47]
  buffer_load_dwordx4 a[40:43], v6, s[44:47], s56 offen sc1
  s_add_u32 s56, s56, 4096
  v_mfma_f32_16x16x32_bf16 v[48:51], a[8:11], v[68:71], v[48:51]
  v_mfma_f32_16x16x32_bf16 v[52:55], a[8:11], v[72:75], v[52:55]
  v_mfma_f32_16x16x32_bf16 v[56:59], a[8:11], v[76:79], v[56:59]
  ds_read_b128 v[60:63], v2 offset:20480
  ds_read_b128 v[64:67], v2 offset:21504
  ds_read_b128 v[68:71], v2 offset:22528
  ds_read_b128 v[72:75], v2 offset:23552
  ds_read_b128 v[76:79], v2 offset:24576
  s_waitcnt vmcnt(8) lgkmcnt(5)
  v_mfma_f32_16x16x32_bf16 v[40:43], a[12:15], v[80:83], v[40:43]
  v_mfma_f32_16x16x32_bf16 v[44:47], a[12:15], v[84:87], v[44:47]
  buffer_load_dwordx4 a[44:47], v6, s[44:47], s56 offen sc1
  s_add_u32 s56, s56, 4096
  v_mfma_f32_16x16x32_bf16 v[48:51], a[12:15], v[88:91], v[48:51]
  v_mfma_f32_16x16x32_bf16 v[52:55], a[12:15], v[92:95], v[52:55]
  v_mfma_f32_16x16x32_bf16 v[56:59], a[12:15], v[96:99], v[56:59]
  ds_read_b128 v[80:83], v2 offset:25600
  ds_read_b128 v[84:87], v2 offset:26624
  ds_read_b128 v[88:91], v2 offset:27648
  ds_read_b128 v[92:95], v2 offset:28672
  ds_read_b128 v[96:99], v2 offset:29696
  s_waitcnt vmcnt(8) lgkmcnt(5)
  v_mfma_f32_16x16x32_bf16 v[40:43], a[16:19], v[60:63], v[40:43]
  v_mfma_f32_16x16x32_bf16 v[44:47], a[16:19], v[64:67], v[44:47]
  buffer_load_dwordx4 a[48:51], v6, s[44:47], s56 offen sc1
  s_add_u32 s56, s56, 4096
  v_mfma_f32_16x16x32_bf16 v[48:51], a[16:19], v[68:71], v[48:51]
  v_mfma_f32_16x16x32_bf16 v[52:55], a[16:19], v[72:75], v[52:55]
  v_mfma_f32_16x16x32_bf16 v[56:59], a[16:19], v[76:79], v[56:59]
  ds_read_b128 v[60:63], v2 offset:30720
  ds_read_b128 v[64:67], v2 offset:31744
  ds_read_b128 v[68:71], v2 offset:32768
  ds_read_b128 v[72:75], v2 offset:33792
  ds_read_b128 v[76:79], v2 offset:34816
  s_waitcnt vmcnt(8) lgkmcnt(5)
  v_mfma_f32_16x16x32_bf16 v[40:43], a[20:23], v[80:83], v[40:43]
  v_mfma_f32_16x16x32_bf16 v[44:47], a[20:23], v[84:87], v[44:47]
  buffer_load_dwordx4 a[52:55], v6, s[44:47], s56 offen sc1
  s_add_u32 s56, s56, 4096
  v_mfma_f32_16x16x32_bf16 v[48:51], a[20:23], v[88:91], v[48:51]
  v_mfma_f32_16x16x32_bf16 v[52:55], a[20:23], v[92:95], v[52:55]
  v_mfma_f32_16x16x32_bf16 v[56:59], a[20:23], v[96:99], v[56:59]
  ds_read_b128 v[80:83], v2 offset:35840
  ds_read_b128 v[84:87], v2 offset:36864
  ds_read_b128 v[88:91], v2 offset:37888
  ds_read_b128 v[92:95], v2 offset:38912
  ds_read_b128 v[96:99], v2 offset:39936
  s_waitcnt vmcnt(8) lgkmcnt(5)
  v_mfma_f32_16x16x32_bf16 v[40:43], a[24:27], v[60:63], v[40:43]
  v_mfma_f32_16x16x32_bf16 v[44:47], a[24:27], v[64:67], v[44:47]
  buffer_load_dwordx4 a[56:59], v6, s[44:47], s56 offen sc1
  s_add_u32 s56, s56, 4096
  v_mfma_f32_16x16x32_bf16 v[48:51], a[24:27], v[68:71], v[48:51]
  v_mfma_f32_16x16x32_bf16 v[52:55], a[24:27], v[72:75], v[52:55]
  v_mfma_f32_16x16x32_bf16 v[56:59], a[24:27], v[76:79], v[56:59]
  ds_read_b128 v[60:63], v2 offset:40960
  ds_read_b128 v[64:67], v2 offset:41984
  ds_read_b128 v[68:71], v2 offset:43008
  ds_read_b128 v[72:75], v2 offset:44032
  ds_read_b128 v[76:79], v2 offset:45056
  s_waitcnt vmcnt(8) lgkmcnt(5)
  v_mfma_f32_16x16x32_bf16 v[40:43], a[28:31], v[80:83], v[40:43]
  v_mfma_f32_16x16x32_bf16 v[44:47], a[28:31], v[84:87], v[44:47]
  buffer_load_dwordx4 a[60:63], v6, s[44:47], s56 offen sc1
  s_add_u32 s56, s56, 4096
  v_mfma_f32_16x16x32_bf16 v[48:51], a[28:31], v[88:91], v[48:51]
  v_mfma_f32_16x16x32_bf16 v[52:55], a[28:31], v[92:95], v[52:55]
  v_mfma_f32_16x16x32_bf16 v[56:59], a[28:31], v[96:99], v[56:59]
  ds_read_b128 v[80:83], v2 offset:46080
  ds_read_b128 v[84:87], v2 offset:47104
  ds_read_b128 v[88:91], v2 offset:48128
  ds_read_b128 v[92:95], v2 offset:49152
  ds_read_b128 v[96:99], v2 offset:50176
  s_waitcnt vmcnt(7) lgkmcnt(5)
  v_mfma_f32_16x16x32_bf16 v[40:43], a[32:35], v[60:63], v[40:43]
  v_mfma_f32_16x16x32_bf16 v[44:47], a[32:35], v[64:67], v[44:47]
  buffer_load_dwordx4 a[64:67], v6, s[44:47], s56 offen sc1
  s_add_u32 s56, s56, 4096
  v_mfma_f32_16x16x32_bf16 v[48:51], a[32:35], v[68:71], v[48:51]
  v_mfma_f32_16x16x32_bf16 v[52:55], a[32:35], v[72:75], v[52:55]
  v_mfma_f32_16x16x32_bf16 v[56:59], a[32:35], v[76:79], v[56:59]
  ds_read_b128 v[60:63], v2 offset:51200
  ds_read_b128 v[64:67], v2 offset:52224
  ds_read_b128 v[68:71], v2 offset:53248
  ds_read_b128 v[72:75], v2 offset:54272
  ds_read_b128 v[76:79], v2 offset:55296
  s_waitcnt vmcnt(7) lgkmcnt(5)
  v_mfma_f32_16x16x32_bf16 v[40:43], a[36:39], v[80:83], v[40:43]
  v_mfma_f32_16x16x32_bf16 v[44:47], a[36:39], v[84:87], v[44:47]
  buffer_load_dwordx4 a[68:71], v6, s[44:47], s56 offen sc1
  s_add_u32 s56, s56, 4096
  v_mfma_f32_16x16x32_bf16 v[48:51], a[36:39], v[88:91], v[48:51]
  v_mfma_f32_16x16x32_bf16 v[52:55], a[36:39], v[92:95], v[52:55]
  v_mfma_f32_16x16x32_bf16 v[56:59], a[36:39], v[96:99], v[56:59]
  ds_read_b128 v[80:83], v3 offset:0
  ds_read_b128 v[84:87], v3 offset:1024
  ds_read_b128 v[88:91], v3 offset:2048
  ds_read_b128 v[92:95], v3 offset:3072
  ds_read_b128 v[96:99], v3 offset:4096
  s_waitcnt vmcnt(7) lgkmcnt(5)
  v_mfma_f32_16x16x32_bf16 v[40:43], a[40:43], v[60:63], v[40:43]
  v_mfma_f32_16x16x32_bf16 v[44:47], a[40:43], v[64:67], v[44:47]
  buffer_load_dwordx4 a[72:75], v6, s[44:47], s56 offen sc1
  s_add_u32 s56, s56, 4096
  v_mfma_f32_16x16x32_bf16 v[48:51], a[40:43], v[68:71], v[48:51]
  v_mfma_f32_16x16x32_bf16 v[52:55], a[40:43], v[72:75], v[52:55]
  v_mfma_f32_16x16x32_bf16 v[56:59], a[40:43], v[76:79], v[56:59]
  ds_read_b128 v[60:63], v3 offset:5120
  ds_read_b128 v[64:67], v3 offset:6144
  ds_read_b128 v[68:71], v3 offset:7168
  ds_read_b128 v[72:75], v3 offset:8192
  ds_read_b128 v[76:79], v3 offset:9216
  s_waitcnt vmcnt(7) lgkmcnt(5)
  v_mfma_f32_16x16x32_bf16 v[40:43], a[44:47], v[80:83], v[40:43]
  v_mfma_f32_16x16x32_bf16 v[44:47], a[44:47], v[84:87], v[44:47]
  buffer_load_dwordx4 a[76:79], v6, s[44:47], s56 offen sc1
  s_add_u32 s56, s56, 4096
  v_mfma_f32_16x16x32_bf16 v[48:51], a[44:47], v[88:91], v[48:51]
  v_mfma_f32_16x16x32_bf16 v[52:55], a[44:47], v[92:95], v[52:55]
  v_mfma_f32_16x16x32_bf16 v[56:59], a[44:47], v[96:99], v[56:59]
  ds_read_b128 v[80:83], v3 offset:10240
  ds_read_b128 v[84:87], v3 offset:11264
  ds_read_b128 v[88:91], v3 offset:12288
  ds_read_b128 v[92:95], v3 offset:13312
  ds_read_b128 v[96:99], v3 offset:14336
  s_waitcnt vmcnt(7) lgkmcnt(5)
  v_mfma_f32_16x16x32_bf16 v[40:43], a[48:51], v[60:63], v[40:43]
  v_mfma_f32_16x16x32_bf16 v[44:47], a[48:51], v[64:67], v[44:47]
  buffer_load_dwordx4 a[80:83], v6, s[44:47], s56 offen sc1
  v_mfma_f32_16x16x32_bf16 v[48:51], a[48:51], v[68:71], v[48:51]
  v_mfma_f32_16x16x32_bf16 v[52:55], a[48:51], v[72:75], v[52:55]
  buffer_load_dwordx2 v[120:121], v9, s[44:47], s58 offen sc1
  s_add_u32 s58, s58, 27648
  v_mfma_f32_16x16x32_bf16 v[56:59], a[48:51], v[76:79], v[56:59]
  ds_read_b128 v[60:63], v3 offset:15360
  ds_read_b128 v[64:67], v3 offset:16384
  ds_read_b128 v[68:71], v3 offset:17408
  ds_read_b128 v[72:75], v3 offset:18432
  ds_read_b128 v[76:79], v3 offset:19456
  s_waitcnt vmcnt(8) lgkmcnt(5)
  v_mfma_f32_16x16x32_bf16 v[40:43], a[52:55], v[80:83], v[40:43]
  v_mfma_f32_16x16x32_bf16 v[44:47], a[52:55], v[84:87], v[44:47]
  buffer_load_dwordx2 v[122:123], v9, s[44:47], s58 offen sc1
  s_add_u32 s58, s58, 27648
  v_mfma_f32_16x16x32_bf16 v[48:51], a[52:55], v[88:91], v[48:51]
  v_mfma_f32_16x16x32_bf16 v[52:55], a[52:55], v[92:95], v[52:55]
  buffer_load_dwordx2 v[124:125], v9, s[44:47], s58 offen sc1
  s_add_u32 s58, s58, 27648
  v_mfma_f32_16x16x32_bf16 v[56:59], a[52:55], v[96:99], v[56:59]
  ds_read_b128 v[80:83], v3 offset:20480
  ds_read_b128 v[84:87], v3 offset:21504
  ds_read_b128 v[88:91], v3 offset:22528
  ds_read_b128 v[92:95], v3 offset:23552
  ds_read_b128 v[96:99], v3 offset:24576
  s_waitcnt vmcnt(9) lgkmcnt(5)
  v_mfma_f32_16x16x32_bf16 v[40:43], a[56:59], v[60:63], v[40:43]
  v_mfma_f32_16x16x32_bf16 v[44:47], a[56:59], v[64:67], v[44:47]
  buffer_load_dwordx2 v[126:127], v9, s[44:47], s58 offen sc1
  s_add_u32 s58, s58, 27648
  v_mfma_f32_16x16x32_bf16 v[48:51], a[56:59], v[68:71], v[48:51]
  v_mfma_f32_16x16x32_bf16 v[52:55], a[56:59], v[72:75], v[52:55]
  buffer_load_dwordx2 v[128:129], v9, s[44:47], s58 offen sc1
  s_add_u32 s58, s58, 27648
  v_mfma_f32_16x16x32_bf16 v[56:59], a[56:59], v[76:79], v[56:59]
  ds_read_b128 v[60:63], v3 offset:25600
  ds_read_b128 v[64:67], v3 offset:26624
  ds_read_b128 v[68:71], v3 offset:27648
  ds_read_b128 v[72:75], v3 offset:28672
  ds_read_b128 v[76:79], v3 offset:29696
  s_waitcnt vmcnt(10) lgkmcnt(5)
  v_mfma_f32_16x16x32_bf16 v[40:43], a[60:63], v[80:83], v[40:43]
  v_mfma_f32_16x16x32_bf16 v[44:47], a[60:63], v[84:87], v[44:47]
  buffer_load_dwordx2 v[130:131], v9, s[44:47], s58 offen sc1
  s_add_u32 s58, s58, 27648
  v_mfma_f32_16x16x32_bf16 v[48:51], a[60:63], v[88:91], v[48:51]
  v_mfma_f32_16x16x32_bf16 v[52:55], a[60:63], v[92:95], v[52:55]
  buffer_load_dwordx2 v[132:133], v9, s[44:47], s58 offen sc1
  s_add_u32 s58, s58, 27648
  v_mfma_f32_16x16x32_bf16 v[56:59], a[60:63], v[96:99], v[56:59]
  ds_read_b128 v[80:83], v3 offset:30720
  ds_read_b128 v[84:87], v3 offset:31744
  ds_read_b128 v[88:91], v3 offset:32768
  ds_read_b128 v[92:95], v3 offset:33792
  ds_read_b128 v[96:99], v3 offset:34816
  s_waitcnt vmcnt(11) lgkmcnt(5)
  v_mfma_f32_16x16x32_bf16 v[40:43], a[64:67], v[60:63], v[40:43]
  v_mfma_f32_16x16x32_bf16 v[44:47], a[64:67], v[64:67], v[44:47]
  buffer_load_dwordx2 v[134:135], v9, s[44:47], s58 offen sc1
  v_mfma_f32_16x16x32_bf16 v[48:51], a[64:67], v[68:71], v[48:51]
  v_mfma_f32_16x16x32_bf16 v[52:55], a[64:67], v[72:75], v[52:55]
  buffer_load_dwordx4 v2, s[44:47], s64 offen sc1 lds
  v_mfma_f32_16x16x32_bf16 v[56:59], a[64:67], v[76:79], v[56:59]
  ds_read_b128 v[60:63], v3 offset:35840
  ds_read_b128 v[64:67], v3 offset:36864
  ds_read_b128 v[68:71], v3 offset:37888
  ds_read_b128 v[72:75], v3 offset:38912
  ds_read_b128 v[76:79], v3 offset:39936
  s_waitcnt vmcnt(12) lgkmcnt(5)
  v_mfma_f32_16x16x32_bf16 v[40:43], a[68:71], v[80:83], v[40:43]
  v_mfma_f32_16x16x32_bf16 v[44:47], a[68:71], v[84:87], v[44:47]
  buffer_load_dwordx4 v2, s[44:47], s64 offen offset:1024 sc1 lds
  v_mfma_f32_16x16x32_bf16 v[48:51], a[68:71], v[88:91], v[48:51]
  v_mfma_f32_16x16x32_bf16 v[52:55], a[68:71], v[92:95], v[52:55]
  buffer_load_dwordx4 v2, s[44:47], s64 offen offset:2048 sc1 lds
  v_mfma_f32_16x16x32_bf16 v[56:59], a[68:71], v[96:99], v[56:59]
  ds_read_b128 v[80:83], v3 offset:40960
  ds_read_b128 v[84:87], v3 offset:41984
  ds_read_b128 v[88:91], v3 offset:43008
  ds_read_b128 v[92:95], v3 offset:44032
  ds_read_b128 v[96:99], v3 offset:45056
  s_waitcnt vmcnt(13) lgkmcnt(5)
  v_mfma_f32_16x16x32_bf16 v[40:43], a[72:75], v[60:63], v[40:43]
  v_mfma_f32_16x16x32_bf16 v[44:47], a[72:75], v[64:67], v[44:47]
  buffer_load_dwordx4 v2, s[44:47], s64 offen offset:3072 sc1 lds
  s_add_u32 s64, s64, 16384
  s_add_u32 m0, s66, 131072
  v_mfma_f32_16x16x32_bf16 v[48:51], a[72:75], v[68:71], v[48:51]
  v_mfma_f32_16x16x32_bf16 v[52:55], a[72:75], v[72:75], v[52:55]
  buffer_load_dwordx4 v2, s[44:47], s64 offen sc1 lds
  v_mfma_f32_16x16x32_bf16 v[56:59], a[72:75], v[76:79], v[56:59]
  ds_read_b128 v[60:63], v3 offset:46080
  ds_read_b128 v[64:67], v3 offset:47104
  ds_read_b128 v[68:71], v3 offset:48128
  ds_read_b128 v[72:75], v3 offset:49152
  ds_read_b128 v[76:79], v3 offset:50176
  s_waitcnt vmcnt(14) lgkmcnt(5)
  v_mfma_f32_16x16x32_bf16 v[40:43], a[76:79], v[80:83], v[40:43]
  v_mfma_f32_16x16x32_bf16 v[44:47], a[76:79], v[84:87], v[44:47]
  buffer_load_dwordx4 v2, s[44:47], s64 offen offset:1024 sc1 lds
  v_mfma_f32_16x16x32_bf16 v[48:51], a[76:79], v[88:91], v[48:51]
  v_mfma_f32_16x16x32_bf16 v[52:55], a[76:79], v[92:95], v[52:55]
  buffer_load_dwordx4 v2, s[44:47], s64 offen offset:2048 sc1 lds
  v_mfma_f32_16x16x32_bf16 v[56:59], a[76:79], v[96:99], v[56:59]
  s_waitcnt vmcnt(15) lgkmcnt(0)
  v_mfma_f32_16x16x32_bf16 v[40:43], a[80:83], v[60:63], v[40:43]
  v_mfma_f32_16x16x32_bf16 v[44:47], a[80:83], v[64:67], v[44:47]
  buffer_load_dwordx4 v2, s[44:47], s64 offen offset:3072 sc1 lds
  s_add_u32 s64, s64, 16384
  s_add_u32 m0, s66, 0
  v_mfma_f32_16x16x32_bf16 v[48:51], a[80:83], v[68:71], v[48:51]
  v_mfma_f32_16x16x32_bf16 v[52:55], a[80:83], v[72:75], v[52:55]
  v_mfma_f32_16x16x32_bf16 v[56:59], a[80:83], v[76:79], v[56:59]
  s_lshr_b32 s56, s3, 1
  s_mul_i32 s56, s56, 5120
  s_and_b32 s57, s3, 1
  s_lshl_b32 s57, s57, 3
  s_add_u32 s56, s56, s57
  s_add_u32 s56, s56, 147456
  v_add_u32 v8, s56, v2
  v_cvt_pk_bf16_f32 v60, v40, v41
  v_cvt_pk_bf16_f32 v61, v42, v43
  ds_write_b64 v8, v[60:61] offset:0
  v_cvt_pk_bf16_f32 v62, v44, v45
  v_cvt_pk_bf16_f32 v63, v46, v47
  ds_write_b64 v8, v[62:63] offset:1024
  v_cvt_pk_bf16_f32 v64, v48, v49
  v_cvt_pk_bf16_f32 v65, v50, v51
  ds_write_b64 v8, v[64:65] offset:2048
  v_cvt_pk_bf16_f32 v66, v52, v53
  v_cvt_pk_bf16_f32 v67, v54, v55
  ds_write_b64 v8, v[66:67] offset:3072
  v_cvt_pk_bf16_f32 v68, v56, v57
  v_cvt_pk_bf16_f32 v69, v58, v59
  ds_write_b64 v8, v[68:69] offset:4096
  s_waitcnt lgkmcnt(0)
  s_barrier
  v_add_u32 v8, 147456, v2
  ds_read_b128 v[60:63], v8 offset:0
  ds_read_b128 v[64:67], v8 offset:1024
  ds_read_b128 v[68:71], v8 offset:2048
  ds_read_b128 v[72:75], v8 offset:3072
  ds_read_b128 v[76:79], v8 offset:4096
  ds_read_b128 v[80:83], v8 offset:5120
  ds_read_b128 v[84:87], v8 offset:6144
  ds_read_b128 v[88:91], v8 offset:7168
  ds_read_b128 v[92:95], v8 offset:8192
  ds_read_b128 v[96:99], v8 offset:9216
  buffer_load_dwordx4 v2, s[44:47], s64 offen sc1 lds
  v_lshlrev_b32 v232, 16, v200
  v_and_b32 v233, 0xffff0000, v200
  v_lshlrev_b32 v234, 16, v201
  v_and_b32 v235, 0xffff0000, v201
  v_lshlrev_b32 v236, 16, v202
  v_and_b32 v237, 0xffff0000, v202
  v_lshlrev_b32 v238, 16, v203
  v_and_b32 v239, 0xffff0000, v203
  buffer_load_dwordx4 v2, s[44:47], s64 offen offset:1024 sc1 lds
  v_lshlrev_b32 v240, 16, v204
  v_and_b32 v241, 0xffff0000, v204
  v_lshlrev_b32 v242, 16, v205
  v_and_b32 v243, 0xffff0000, v205
  v_lshlrev_b32 v244, 16, v206
  v_and_b32 v245, 0xffff0000, v206
  v_lshlrev_b32 v246, 16, v207
  v_and_b32 v247, 0xffff0000, v207
  buffer_load_dwordx4 v2, s[44:47], s64 offen offset:2048 sc1 lds
  v_lshlrev_b32 v248, 16, v208
  v_and_b32 v249, 0xffff0000, v208
  v_lshlrev_b32 v250, 16, v209
  v_and_b32 v251, 0xffff0000, v209
  s_waitcnt lgkmcnt(5)
  v_mfma_f32_16x16x32_bf16 v[100:103], v[60:63], v[210:213], 0
  v_mfma_f32_16x16x32_bf16 v[104:107], v[64:67], v[210:213], 0
  v_mfma_f32_16x16x32_bf16 v[108:111], v[68:71], v[210:213], 0
  v_mfma_f32_16x16x32_bf16 v[112:115], v[72:75], v[210:213], 0
  v_mfma_f32_16x16x32_bf16 v[116:119], v[76:79], v[210:213], 0
  buffer_load_dwordx4 v2, s[44:47], s64 offen offset:3072 sc1 lds
  s_add_u32 s64, s64, 16384
  s_add_u32 m0, s66, 16384
  s_waitcnt lgkmcnt(0)
  v_mfma_f32_16x16x32_bf16 v[100:103], v[80:83], v[214:217], v[100:103]
  v_mfma_f32_16x16x32_bf16 v[104:107], v[84:87], v[214:217], v[104:107]
  v_mfma_f32_16x16x32_bf16 v[108:111], v[88:91], v[214:217], v[108:111]
  v_mfma_f32_16x16x32_bf16 v[112:115], v[92:95], v[214:217], v[112:115]
  v_mfma_f32_16x16x32_bf16 v[116:119], v[96:99], v[214:217], v[116:119]
  buffer_load_dwordx4 v2, s[44:47], s64 offen sc1 lds
  v_lshrrev_b32 v6, 1, v5
  v_and_b32 v7, 1, v5
  v_lshlrev_b32 v8, 10, v6
  v_lshl_add_u32 v8, v7, 9, v8
  v_lshl_add_u32 v8, v4, 4, v8
  v_lshlrev_b32 v10, 9, v6
  v_lshl_add_u32 v10, v4, 4, v10
  v_lshl_add_u32 v10, v7, 3, v10
  v_add_u32 v10, 4096, v10
  s_lshl_b32 s56, s54, 1
  s_lshr_b32 s57, s3, 1
  s_add_u32 s56, s56, s57
  s_mul_i32 s56, s56, 40960
  s_mul_i32 s57, s55, 5120
  s_add_u32 s56, s56, s57
  s_and_b32 s57, s3, 1
  s_lshl_b32 s57, s57, 8
  s_add_u32 s56, s56, s57
  s_add_u32 s56, s56, 0xda0000
  buffer_load_dwordx4 v2, s[44:47], s64 offen offset:1024 sc1 lds
  v_pk_fma_f32 v[232:233], v[160:161], v[100:101], v[232:233]
  v_pk_fma_f32 v[234:235], v[162:163], v[102:103], v[234:235]
  v_pk_fma_f32 v[236:237], v[164:165], v[104:105], v[236:237]
  v_pk_fma_f32 v[238:239], v[166:167], v[106:107], v[238:239]
  v_pk_fma_f32 v[240:241], v[168:169], v[108:109], v[240:241]
  v_pk_fma_f32 v[242:243], v[170:171], v[110:111], v[242:243]
  v_pk_fma_f32 v[244:245], v[172:173], v[112:113], v[244:245]
  v_pk_fma_f32 v[246:247], v[174:175], v[114:115], v[246:247]
  v_pk_fma_f32 v[248:249], v[176:177], v[116:117], v[248:249]
  v_pk_fma_f32 v[250:251], v[178:179], v[118:119], v[250:251]
  buffer_load_dwordx4 v2, s[44:47], s64 offen offset:2048 sc1 lds
  v_pk_mul_f32 v[100:101], v[232:233], v[180:181]
  v_pk_mul_f32 v[102:103], v[234:235], v[182:183]
  v_pk_mul_f32 v[104:105], v[236:237], v[184:185]
  v_pk_mul_f32 v[106:107], v[238:239], v[186:187]
  v_pk_mul_f32 v[108:109], v[240:241], v[188:189]
  v_pk_mul_f32 v[110:111], v[242:243], v[190:191]
  v_pk_mul_f32 v[112:113], v[244:245], v[192:193]
  v_pk_mul_f32 v[114:115], v[246:247], v[194:195]
  v_pk_mul_f32 v[116:117], v[248:249], v[196:197]
  v_pk_mul_f32 v[118:119], v[250:251], v[198:199]
  buffer_load_dwordx4 v2, s[44:47], s64 offen offset:3072 sc1 lds
  s_add_u32 s64, s64, 16384
  s_add_u32 m0, s66, 32768
  v_cvt_pk_bf16_f32 v60, v100, v101
  v_cvt_pk_bf16_f32 v61, v102, v103
  v_cvt_pk_bf16_f32 v62, v104, v105
  v_cvt_pk_bf16_f32 v63, v106, v107
  v_cvt_pk_bf16_f32 v64, v108, v109
  v_cvt_pk_bf16_f32 v65, v110, v111
  v_cvt_pk_bf16_f32 v66, v112, v113
  v_cvt_pk_bf16_f32 v67, v114, v115
  v_cvt_pk_bf16_f32 v68, v116, v117
  v_cvt_pk_bf16_f32 v69, v118, v119
  buffer_store_dwordx4 v[60:63], v8, s[44:47], s56 offen sc1
  buffer_store_dwordx4 v[64:67], v8, s[44:47], s56 offen offset:2048 sc1
  buffer_store_dwordx2 v[68:69], v10, s[44:47], s56 offen sc1
  v_pk_add_f32 v[20:21], v[232:233], v[234:235]
  v_pk_mul_f32 v[22:23], v[232:233], v[232:233]
  v_pk_fma_f32 v[22:23], v[234:235], v[234:235], v[22:23]
  v_pk_add_f32 v[20:21], v[20:21], v[236:237]
  v_pk_fma_f32 v[22:23], v[236:237], v[236:237], v[22:23]
  v_pk_add_f32 v[20:21], v[20:21], v[238:239]
  v_pk_fma_f32 v[22:23], v[238:239], v[238:239], v[22:23]
  v_pk_add_f32 v[20:21], v[20:21], v[240:241]
  v_pk_fma_f32 v[22:23], v[240:241], v[240:241], v[22:23]
  v_pk_add_f32 v[20:21], v[20:21], v[242:243]
  v_pk_fma_f32 v[22:23], v[242:243], v[242:243], v[22:23]
  v_pk_add_f32 v[20:21], v[20:21], v[244:245]
  v_pk_fma_f32 v[22:23], v[244:245], v[244:245], v[22:23]
  v_pk_add_f32 v[20:21], v[20:21], v[246:247]
  v_pk_fma_f32 v[22:23], v[246:247], v[246:247], v[22:23]
  v_pk_add_f32 v[20:21], v[20:21], v[248:249]
  v_pk_fma_f32 v[22:23], v[248:249], v[248:249], v[22:23]
  v_pk_add_f32 v[20:21], v[20:21], v[250:251]
  v_pk_fma_f32 v[22:23], v[250:251], v[250:251], v[22:23]
  v_add_f32 v20, v20, v21
  v_add_f32 v21, v22, v23
  v_mov_b32 v22, v20
  v_mov_b32 v23, v21
  s_nop 0
  v_permlane16_swap_b32 v20, v22
  v_permlane16_swap_b32 v21, v23
  v_add_f32 v20, v20, v22
  v_add_f32 v21, v21, v23
  v_mov_b32 v22, v20
  v_mov_b32 v23, v21
  s_nop 0
  v_permlane32_swap_b32 v20, v22
  v_permlane32_swap_b32 v21, v23
  v_add_f32 v20, v20, v22
  v_add_f32 v21, v21, v23
  s_lshl_b32 s56, s55, 14
  s_lshl_b32 s57, s54, 9
  s_add_u32 s56, s56, s57
  s_lshl_b32 s57, s3, 7
  s_add_u32 s56, s56, s57
  s_add_u32 s56, s56, 0x1020000
  v_lshlrev_b32 v8, 3, v4
  s_mov_b64 s[60:61], exec
  s_mov_b64 exec, 0xffff
  buffer_store_dwordx2 v[20:21], v8, s[44:47], s56 offen sc1
  s_mov_b64 exec, s[60:61]
  s_lshl_b32 s76, s54, 1
  s_lshr_b32 s57, s3, 1
  s_add_u32 s76, s76, s57
  s_lshl_b32 s76, s76, 8
  s_lshl_b32 s57, s55, 3
  s_add_u32 s76, s76, s57
  s_and_b32 s57, s3, 1
  s_lshl_b32 s57, s57, 2
  s_add_u32 s76, s76, s57
  s_add_u32 s76, s76, 0x1714000
  buffer_load_dwordx4 v2, s[44:47], s64 offen sc1 lds
  buffer_load_dwordx4 v2, s[44:47], s64 offen offset:1024 sc1 lds
  buffer_load_dwordx4 v2, s[44:47], s64 offen offset:2048 sc1 lds
  s_waitcnt vmcnt(23)
  v_pk_add_f32 v[120:121], v[120:121], v[122:123]
  v_pk_add_f32 v[120:121], v[120:121], v[124:125]
  v_pk_add_f32 v[120:121], v[120:121], v[126:127]
  v_pk_add_f32 v[120:121], v[120:121], v[128:129]
  v_pk_add_f32 v[120:121], v[120:121], v[130:131]
  v_pk_add_f32 v[120:121], v[120:121], v[132:133]
  v_pk_add_f32 v[120:121], v[120:121], v[134:135]
  v_cvt_pk_bf16_f32 v11, v120, v120
  v_lshlrev_b32 v14, 16, v11
  v_sub_f32 v14, v120, v14
  v_cvt_pk_bf16_f32 v14, v14, v14
  v_and_b32 v11, 0xffff, v11
  v_lshl_or_b32 v26, v14, 16, v11
  v_cvt_pk_bf16_f32 v11, v121, v121
  v_lshlrev_b32 v14, 16, v11
  v_sub_f32 v14, v121, v14
  v_cvt_pk_bf16_f32 v14, v14, v14
  v_and_b32 v11, 0xffff, v11
  v_lshl_or_b32 v27, v14, 16, v11
  v_mov_b32 v28, 0
  v_mov_b32 v29, 0
  v_lshrrev_b32 v4, 5, v0
  v_and_b32 v5, 31, v0
  v_lshlrev_b32 v6, 9, v4
  v_lshl_add_u32 v6, v5, 4, v6
  v_add_u32 v6, 157696, v6
  v_cmp_gt_u32 vcc, 224, v0
  s_and_saveexec_b64 s[60:61], vcc
  ds_write_b128 v6, v[26:29]
  s_mov_b64 exec, s[60:61]
  buffer_load_dwordx4 v2, s[44:47], s64 offen offset:3072 sc1 lds
  s_add_u32 s64, s64, 16384
  s_add_u32 m0, s66, 49152
  s_nop 0
  buffer_load_dwordx4 v2, s[44:47], s64 offen sc1 lds
  buffer_load_dwordx4 v2, s[44:47], s64 offen offset:1024 sc1 lds
  s_lshr_b32 s54, s95, 3
  s_lshl_b32 s54, s54, 2
  s_lshr_b32 s55, s96, 1
  s_add_u32 s54, s54, s55
  s_and_b32 s55, s96, 1
  s_lshl_b32 s55, s55, 3
  s_and_b32 s56, s95, 7
  s_add_u32 s55, s55, s56
  s_lshl_b32 s57, s54, 2
  s_add_u32 s57, s57, s3
  s_mul_i32 s67, s57, 40960
  s_add_u32 s67, s67, 0xda0000
  s_lshl_b32 s79, s57, 8
  s_add_u32 s79, s79, 0x1020000
  s_lshl_b32 s81, s57, 8
  s_add_u32 s81, s81, 0x1714000
  s_lshl_b32 s75, s57, 9
  s_lshl_b32 s58, s55, 2
  s_add_u32 s75, s75, s58
  s_add_u32 s75, s75, 0x1718000
  s_mul_i32 s58, s57, 110592
  s_add_u32 s58, s58, 0x1040000
  s_add_u32 s59, s55, 0
  s_and_b32 s60, s59, 1
  s_lshl_b32 s60, s60, 9
  s_bfe_u32 s61, s59, 0x10001
  s_mul_i32 s61, s61, 55296
  s_lshr_b32 s59, s59, 2
  s_lshl_b32 s59, s59, 11
  s_add_u32 s60, s60, s61
  s_add_u32 s60, s60, s59
  s_add_u32 s68, s60, s58
  s_add_u32 s59, s55, 16
  s_and_b32 s60, s59, 1
  s_lshl_b32 s60, s60, 9
  s_bfe_u32 s61, s59, 0x10001
  s_mul_i32 s61, s61, 55296
  s_lshr_b32 s59, s59, 2
  s_lshl_b32 s59, s59, 11
  s_add_u32 s60, s60, s61
  s_add_u32 s60, s60, s59
  s_add_u32 s69, s60, s58
  s_add_u32 s59, s55, 32
  s_and_b32 s60, s59, 1
  s_lshl_b32 s60, s60, 9
  s_bfe_u32 s61, s59, 0x10001
  s_mul_i32 s61, s61, 55296
  s_lshr_b32 s59, s59, 2
  s_lshl_b32 s59, s59, 11
  s_add_u32 s60, s60, s61
  s_add_u32 s60, s60, s59
  s_add_u32 s70, s60, s58
  s_add_u32 s59, s55, 48
  s_and_b32 s60, s59, 1
  s_lshl_b32 s60, s60, 9
  s_bfe_u32 s61, s59, 0x10001
  s_mul_i32 s61, s61, 55296
  s_lshr_b32 s59, s59, 2
  s_lshl_b32 s59, s59, 11
  s_add_u32 s60, s60, s61
  s_add_u32 s60, s60, s59
  s_add_u32 s71, s60, s58
  s_cmp_eq_u32 s55, 15
  s_cselect_b32 s71, 0x7000000, s71
  s_add_u32 s59, s55, 63
  s_and_b32 s60, s59, 1
  s_lshl_b32 s60, s60, 9
  s_bfe_u32 s61, s59, 0x10001
  s_mul_i32 s61, s61, 55296
  s_lshr_b32 s59, s59, 2
  s_lshl_b32 s59, s59, 11
  s_add_u32 s60, s60, s61
  s_add_u32 s60, s60, s59
  s_add_u32 s72, s60, s58
  s_cmp_eq_u32 s55, 15
  s_cselect_b32 s72, 0x7000000, s72
  s_add_u32 s59, s55, 78
  s_and_b32 s60, s59, 1
  s_lshl_b32 s60, s60, 9
  s_bfe_u32 s61, s59, 0x10001
  s_mul_i32 s61, s61, 55296
  s_lshr_b32 s59, s59, 2
  s_lshl_b32 s59, s59, 11
  s_add_u32 s60, s60, s61
  s_add_u32 s60, s60, s59
  s_add_u32 s73, s60, s58
  s_cmp_eq_u32 s55, 15
  s_cselect_b32 s73, 0x7000000, s73
  s_add_u32 s59, s55, 93
  s_and_b32 s60, s59, 1
  s_lshl_b32 s60, s60, 9
  s_bfe_u32 s61, s59, 0x10001
  s_mul_i32 s61, s61, 55296
  s_lshr_b32 s59, s59, 2
  s_lshl_b32 s59, s59, 11
  s_add_u32 s60, s60, s61
  s_add_u32 s60, s60, s59
  s_add_u32 s74, s60, s58
  s_cmp_eq_u32 s55, 15
  s_cselect_b32 s74, 0x7000000, s74
  s_waitcnt vmcnt(6)
  v_mov_b32 v8, 1
  v_mov_b32 v9, 0
  s_mov_b64 s[50:51], exec
  s_mov_b64 exec, 1
  buffer_store_dword v8, v9, s[44:47], s76 offen sc1
  s_mov_b64 exec, s[50:51]
  buffer_load_dwordx4 v2, s[44:47], s64 offen offset:2048 sc1 lds
  buffer_load_dwordx4 v2, s[44:47], s64 offen offset:3072 sc1 lds
  s_add_u32 s64, s64, 16384
  s_add_u32 m0, s66, 65536
  s_nop 0
  buffer_load_dwordx4 v2, s[44:47], s64 offen sc1 lds
  buffer_load_dwordx4 v2, s[44:47], s64 offen offset:1024 sc1 lds
  buffer_load_dwordx4 v2, s[44:47], s64 offen offset:2048 sc1 lds
  buffer_load_dwordx4 v2, s[44:47], s64 offen offset:3072 sc1 lds
  s_add_u32 s64, s64, 16384
  s_add_u32 m0, s66, 81920
  s_nop 0
  buffer_load_dwordx4 v2, s[44:47], s64 offen sc1 lds
  buffer_load_dwordx4 v2, s[44:47], s64 offen offset:1024 sc1 lds
  buffer_load_dwordx4 v2, s[44:47], s64 offen offset:2048 sc1 lds
  buffer_load_dwordx4 v2, s[44:47], s64 offen offset:3072 sc1 lds
  s_add_u32 s64, s64, 16384
  s_add_u32 m0, s66, 98304
  s_nop 0
  buffer_load_dwordx4 v2, s[44:47], s64 offen sc1 lds
  buffer_load_dwordx4 v2, s[44:47], s64 offen offset:1024 sc1 lds
  buffer_load_dwordx4 v2, s[44:47], s64 offen offset:2048 sc1 lds
  buffer_load_dwordx4 v2, s[44:47], s64 offen offset:3072 sc1 lds
  s_add_u32 s64, s64, 16384
  s_add_u32 m0, s66, 114688
  s_lshr_b32 s54, s95, 3
  s_lshl_b32 s54, s54, 3
  s_add_u32 s54, s54, s96
  s_and_b32 s55, s95, 7
  s_lshl_b32 s57, s54, 1
  s_lshr_b32 s58, s3, 1
  s_add_u32 s57, s57, s58
  s_lshl_b32 s77, s57, 9
  s_add_u32 s77, s77, 0x1718000
  s_mul_i32 s78, s57, 110592
  s_and_b32 s58, s3, 1
  s_mul_i32 s59, s58, 55296
  s_add_u32 s78, s78, s59
  s_add_u32 s78, s78, 0x1040000
  s_waitcnt lgkmcnt(0)
  v_lshrrev_b32 v5, 4, v1
  v_lshlrev_b32 v7, 4, v5
  v_add_u32 v7, 161280, v7
  ds_read_b128 v[20:23], v7 offset:0
  ds_read_b128 v[24:27], v7 offset:64
  ds_read_b128 v[28:31], v7 offset:128
  ds_read_b128 v[32:35], v7 offset:192
  ds_read_b128 v[36:39], v7 offset:256
  s_mul_i32 s60, s55, 5
  s_add_u32 s61, s60, 4
  s_lshr_b32 s60, s60, 2
  s_lshr_b32 s61, s61, 2
  v_and_b32 v17, 1, v1
  v_add_u32 v17, s60, v17
  v_min_u32 v17, s61, v17
  v_lshlrev_b32 v17, 8, v17
  v_lshlrev_b32 v2, 4, v1
  v_add_u32 v3, 0x10000, v2
  v_add_u32 v4, 0x20000, v2
  v_and_b32 v5, 31, v1
  v_lshlrev_b32 v5, 4, v5
  v_add_u32 v5, 157696, v5
  v_bfe_u32 v6, v1, 4, 1
  v_lshlrev_b32 v6, 10, v6
  v_lshrrev_b32 v7, 5, v1
  v_lshl_add_u32 v6, v7, 8, v6
  v_and_b32 v7, 15, v1
  v_lshl_add_u32 v6, v7, 4, v6
  v_mov_b32 v7, 0x40000000
  v_cmp_eq_u32 vcc, 0, v1
  s_nop 1
  v_cndmask_b32 v7, v7, 0, vcc
  v_mov_b32 v8, 1
  s_mul_i32 s58, s58, 5120
  v_add_u32 v13, s58, v2
  v_add_u32 v14, 0x10000, v13
  v_add_u32 v15, 0x20000, v13
  s_and_b32 s58, s3, 1
  s_xor_b32 s58, s58, 1
  s_mul_i32 s58, s58, 142336
  v_add_u32 v16, s58, v2
  v_and_b32 v18, 15, v1
  v_lshlrev_b32 v18, 2, v18
  s_waitcnt vmcnt(0) lgkmcnt(0)
  s_barrier
  buffer_load_dword v19, v18, s[44:47], s81 offen sc1
  s_waitcnt vmcnt(0)
  v_cmp_gt_u32 vcc, 1, v19
  s_nop 4
  s_cbranch_vccz L_chk_24
  s_mov_b32 s49, 0
L_poll_25:
  s_add_u32 s49, s49, 1
  s_cmp_gt_u32 s49, 100000
  s_cbranch_scc1 L_pexit_26
  buffer_load_dword v19, v18, s[44:47], s81 offen sc1
  s_waitcnt vmcnt(0)
  v_cmp_gt_u32 vcc, 1, v19
  s_nop 4
  s_cbranch_vccz L_pexit_26
  s_branch L_poll_25
L_pexit_26:
L_chk_24:
  buffer_load_dwordx4 a[0:3], v2, s[44:47], s67 offen sc1
  buffer_load_dwordx4 a[4:7], v2, s[44:47], s67 offen offset:1024 sc1
  buffer_load_dwordx4 a[8:11], v2, s[44:47], s67 offen offset:2048 sc1
  buffer_load_dwordx4 a[12:15], v2, s[44:47], s67 offen offset:3072 sc1
  s_add_u32 s67, s67, 4096
  buffer_load_dwordx4 a[16:19], v2, s[44:47], s67 offen sc1
  buffer_load_dwordx4 a[20:23], v2, s[44:47], s67 offen offset:1024 sc1
  buffer_load_dwordx4 a[24:27], v2, s[44:47], s67 offen offset:2048 sc1
  buffer_load_dwordx4 a[28:31], v2, s[44:47], s67 offen offset:3072 sc1
  s_add_u32 s67, s67, 4096
  buffer_load_dwordx4 a[32:35], v2, s[44:47], s67 offen sc1
  buffer_load_dwordx4 a[36:39], v2, s[44:47], s67 offen offset:1024 sc1
  v_and_b32 v10, 31, v1
  v_lshlrev_b32 v10, 3, v10
  buffer_load_dwordx2 v[104:105], v10, s[44:47], s79 offen sc1
  s_add_u32 s79, s79, 16384
  buffer_load_dwordx2 v[106:107], v10, s[44:47], s79 offen sc1
  s_add_u32 s79, s79, 16384
  buffer_load_dwordx2 v[108:109], v10, s[44:47], s79 offen sc1
  s_add_u32 s79, s79, 16384
  buffer_load_dwordx2 v[110:111], v10, s[44:47], s79 offen sc1
  s_add_u32 s79, s79, 16384
  buffer_load_dwordx2 v[112:113], v10, s[44:47], s79 offen sc1
  s_add_u32 s79, s79, 16384
  buffer_load_dwordx2 v[114:115], v10, s[44:47], s79 offen sc1
  s_add_u32 s79, s79, 16384
  buffer_load_dwordx2 v[116:117], v10, s[44:47], s79 offen sc1
  s_add_u32 s79, s79, 16384
  buffer_load_dwordx2 v[118:119], v10, s[44:47], s79 offen sc1
  s_mov_b32 s80, 0x1712000
  buffer_load_dword v19, v17, s[44:47], s80 offen sc1
  v_and_b32 v9, 15, v1
  v_lshlrev_b32 v9, 2, v9
  ds_read_b128 v[144:147], v3 offset:49152
  ds_read_b128 v[148:151], v3 offset:50176
  ds_read_b128 v[152:155], v3 offset:51200
  s_waitcnt vmcnt(18) lgkmcnt(1)
  v_mfma_f32_32x32x16_bf16 v[40:55], v[144:147], a[0:3], 0
  ds_read_b128 v[156:159], v3 offset:52224
  buffer_load_dwordx4 a[40:43], v2, s[44:47], s67 offen offset:2048 sc1
  v_mfma_f32_32x32x16_bf16 v[56:71], v[148:151], a[0:3], 0
  ds_read_b128 v[160:163], v3 offset:53248
  s_waitcnt lgkmcnt(1)
  v_mfma_f32_32x32x16_bf16 v[72:87], v[152:155], a[0:3], 0
  ds_read_b128 v[164:167], v3 offset:54272
  buffer_load_dwordx4 a[44:47], v2, s[44:47], s67 offen offset:3072 sc1
  s_add_u32 s67, s67, 4096
  s_waitcnt vmcnt(19)
  v_mfma_f32_32x32x16_bf16 v[40:55], v[156:159], a[4:7], v[40:55]
  ds_read_b128 v[144:147], v3 offset:55296
  s_waitcnt lgkmcnt(1)
  v_mfma_f32_32x32x16_bf16 v[56:71], v[160:163], a[4:7], v[56:71]
  ds_read_b128 v[148:151], v3 offset:56320
  buffer_load_dwordx4 a[48:51], v2, s[44:47], s67 offen sc1
  v_mfma_f32_32x32x16_bf16 v[72:87], v[164:167], a[4:7], v[72:87]
  ds_read_b128 v[152:155], v3 offset:57344
  s_waitcnt vmcnt(19) lgkmcnt(1)
  v_mfma_f32_32x32x16_bf16 v[40:55], v[144:147], a[8:11], v[40:55]
  ds_read_b128 v[156:159], v3 offset:58368
  buffer_load_dwordx4 a[52:55], v2, s[44:47], s67 offen offset:1024 sc1
  v_mfma_f32_32x32x16_bf16 v[56:71], v[148:151], a[8:11], v[56:71]
  ds_read_b128 v[160:163], v3 offset:59392
  s_waitcnt lgkmcnt(1)
  v_mfma_f32_32x32x16_bf16 v[72:87], v[152:155], a[8:11], v[72:87]
  ds_read_b128 v[164:167], v3 offset:60416
  buffer_load_dwordx4 a[56:59], v2, s[44:47], s67 offen offset:2048 sc1
  s_waitcnt vmcnt(20)
  v_mfma_f32_32x32x16_bf16 v[40:55], v[156:159], a[12:15], v[40:55]
  ds_read_b128 v[144:147], v3 offset:61440
  s_waitcnt lgkmcnt(1)
  v_mfma_f32_32x32x16_bf16 v[56:71], v[160:163], a[12:15], v[56:71]
  ds_read_b128 v[148:151], v3 offset:62464
  buffer_load_dwordx4 a[60:63], v2, s[44:47], s67 offen offset:3072 sc1
  s_add_u32 s67, s67, 4096
  v_mfma_f32_32x32x16_bf16 v[72:87], v[164:167], a[12:15], v[72:87]
  ds_read_b128 v[152:155], v3 offset:63488
  s_waitcnt vmcnt(20) lgkmcnt(1)
  v_mfma_f32_32x32x16_bf16 v[40:55], v[144:147], a[16:19], v[40:55]
  ds_read_b128 v[156:159], v3 offset:64512
  buffer_load_dwordx4 a[64:67], v2, s[44:47], s67 offen sc1
  v_mfma_f32_32x32x16_bf16 v[56:71], v[148:151], a[16:19], v[56:71]
  ds_read_b128 v[160:163], v4 offset:0
  s_waitcnt lgkmcnt(1)
  v_mfma_f32_32x32x16_bf16 v[72:87], v[152:155], a[16:19], v[72:87]
  ds_read_b128 v[164:167], v4 offset:1024
  buffer_load_dwordx4 a[68:71], v2, s[44:47], s67 offen offset:1024 sc1
  s_waitcnt vmcnt(21)
  v_mfma_f32_32x32x16_bf16 v[40:55], v[156:159], a[20:23], v[40:55]
  ds_read_b128 v[144:147], v4 offset:2048
  s_waitcnt lgkmcnt(1)
  v_mfma_f32_32x32x16_bf16 v[56:71], v[160:163], a[20:23], v[56:71]
  ds_read_b128 v[148:151], v4 offset:3072
  buffer_load_dwordx4 a[72:75], v2, s[44:47], s67 offen offset:2048 sc1
  v_mfma_f32_32x32x16_bf16 v[72:87], v[164:167], a[20:23], v[72:87]
  ds_read_b128 v[152:155], v4 offset:4096
  s_waitcnt vmcnt(21) lgkmcnt(1)
  v_mfma_f32_32x32x16_bf16 v[40:55], v[144:147], a[24:27], v[40:55]
  ds_read_b128 v[156:159], v4 offset:5120
  buffer_load_dwordx4 a[76:79], v2, s[44:47], s67 offen offset:3072 sc1
  s_add_u32 s67, s67, 4096
  v_mfma_f32_32x32x16_bf16 v[56:71], v[148:151], a[24:27], v[56:71]
  ds_read_b128 v[160:163], v4 offset:6144
  s_waitcnt lgkmcnt(1)
  v_mfma_f32_32x32x16_bf16 v[72:87], v[152:155], a[24:27], v[72:87]
  ds_read_b128 v[164:167], v4 offset:7168
  buffer_load_dwordx4 a[80:83], v2, s[44:47], s67 offen sc1
  s_waitcnt vmcnt(22)
  v_mfma_f32_32x32x16_bf16 v[40:55], v[156:159], a[28:31], v[40:55]
  ds_read_b128 v[144:147], v4 offset:8192
  s_waitcnt lgkmcnt(1)
  v_mfma_f32_32x32x16_bf16 v[56:71], v[160:163], a[28:31], v[56:71]
  ds_read_b128 v[148:151], v4 offset:9216
  buffer_load_dwordx4 a[84:87], v2, s[44:47], s67 offen offset:1024 sc1
  v_mfma_f32_32x32x16_bf16 v[72:87], v[164:167], a[28:31], v[72:87]
  ds_read_b128 v[152:155], v4 offset:10240
  s_waitcnt vmcnt(22) lgkmcnt(1)
  v_mfma_f32_32x32x16_bf16 v[40:55], v[144:147], a[32:35], v[40:55]
  ds_read_b128 v[156:159], v4 offset:11264
  buffer_load_dwordx4 a[88:91], v2, s[44:47], s67 offen offset:2048 sc1
  v_mfma_f32_32x32x16_bf16 v[56:71], v[148:151], a[32:35], v[56:71]
  ds_read_b128 v[160:163], v4 offset:12288
  s_waitcnt lgkmcnt(1)
  v_mfma_f32_32x32x16_bf16 v[72:87], v[152:155], a[32:35], v[72:87]
  ds_read_b128 v[164:167], v4 offset:13312
  buffer_load_dwordx4 a[92:95], v2, s[44:47], s67 offen offset:3072 sc1
  s_add_u32 s67, s67, 4096
  s_waitcnt vmcnt(23)
  v_mfma_f32_32x32x16_bf16 v[40:55], v[156:159], a[36:39], v[40:55]
  ds_read_b128 v[144:147], v4 offset:14336
  s_waitcnt lgkmcnt(1)
  v_mfma_f32_32x32x16_bf16 v[56:71], v[160:163], a[36:39], v[56:71]
  ds_read_b128 v[148:151], v4 offset:15360
  buffer_load_dwordx4 a[96:99], v2, s[44:47], s67 offen sc1
  v_mfma_f32_32x32x16_bf16 v[72:87], v[164:167], a[36:39], v[72:87]
  s_barrier
  ds_read_b128 v[152:155], v2 offset:0
  s_waitcnt vmcnt(14) lgkmcnt(1)
  v_mfma_f32_32x32x16_bf16 v[40:55], v[144:147], a[40:43], v[40:55]
  ds_read_b128 v[156:159], v2 offset:1024
  buffer_load_dwordx4 a[100:103], v2, s[44:47], s67 offen offset:1024 sc1
  v_mfma_f32_32x32x16_bf16 v[56:71], v[148:151], a[40:43], v[56:71]
  ds_read_b128 v[160:163], v2 offset:2048
  s_waitcnt lgkmcnt(1)
  v_mfma_f32_32x32x16_bf16 v[72:87], v[152:155], a[40:43], v[72:87]
  ds_read_b128 v[164:167], v2 offset:3072
  buffer_load_dwordx4 a[104:107], v2, s[44:47], s67 offen offset:2048 sc1
  s_waitcnt vmcnt(15)
  v_mfma_f32_32x32x16_bf16 v[40:55], v[156:159], a[44:47], v[40:55]
  ds_read_b128 v[144:147], v2 offset:4096
  s_waitcnt lgkmcnt(1)
  v_mfma_f32_32x32x16_bf16 v[56:71], v[160:163], a[44:47], v[56:71]
  ds_read_b128 v[148:151], v2 offset:5120
  buffer_load_dwordx4 a[108:111], v2, s[44:47], s67 offen offset:3072 sc1
  s_add_u32 s67, s67, 4096
  v_mfma_f32_32x32x16_bf16 v[72:87], v[164:167], a[44:47], v[72:87]
  ds_read_b128 v[152:155], v2 offset:6144
  s_waitcnt vmcnt(15) lgkmcnt(1)
  v_mfma_f32_32x32x16_bf16 v[40:55], v[144:147], a[48:51], v[40:55]
  ds_read_b128 v[156:159], v2 offset:7168
  buffer_load_dwordx4 a[112:115], v2, s[44:47], s67 offen sc1
  v_add_f32 v104, v104, v106
  v_mfma_f32_32x32x16_bf16 v[56:71], v[148:151], a[48:51], v[56:71]
  ds_read_b128 v[160:163], v2 offset:8192
  v_add_f32 v105, v105, v107
  v_add_f32 v104, v104, v108
  v_add_f32 v105, v105, v109
  v_add_f32 v104, v104, v110
  v_add_f32 v105, v105, v111
  v_add_f32 v104, v104, v112
  s_waitcnt lgkmcnt(1)
  v_mfma_f32_32x32x16_bf16 v[72:87], v[152:155], a[48:51], v[72:87]
  ds_read_b128 v[164:167], v2 offset:9216
  buffer_load_dwordx4 a[116:119], v2, s[44:47], s67 offen offset:1024 sc1
  v_add_f32 v105, v105, v113
  s_waitcnt vmcnt(16)
  v_mfma_f32_32x32x16_bf16 v[40:55], v[156:159], a[52:55], v[40:55]
  ds_read_b128 v[144:147], v2 offset:10240
  v_add_f32 v104, v104, v114
  v_add_f32 v105, v105, v115
  v_add_f32 v104, v104, v116
  v_add_f32 v105, v105, v117
  v_add_f32 v104, v104, v118
  s_waitcnt lgkmcnt(1)
  v_mfma_f32_32x32x16_bf16 v[56:71], v[160:163], a[52:55], v[56:71]
  ds_read_b128 v[148:151], v2 offset:11264
  buffer_load_dwordx4 a[120:123], v2, s[44:47], s67 offen offset:2048 sc1
  v_add_f32 v105, v105, v119
  v_mfma_f32_32x32x16_bf16 v[72:87], v[164:167], a[52:55], v[72:87]
  ds_read_b128 v[152:155], v2 offset:12288
  v_mul_f32 v104, 0x3acccccd, v104
  v_mul_f32 v105, 0x3acccccd, v105
  v_fma_f32 v105, -v104, v104, v105
  v_max_f32 v105, 0, v105
  v_cvt_pk_bf16_f32 v105, v105, v105
  v_lshlrev_b32 v105, 16, v105
  s_waitcnt vmcnt(16) lgkmcnt(1)
  v_mfma_f32_32x32x16_bf16 v[40:55], v[144:147], a[56:59], v[40:55]
  ds_read_b128 v[156:159], v2 offset:13312
  buffer_load_dwordx4 a[124:127], v2, s[44:47], s67 offen offset:3072 sc1
  s_add_u32 s67, s67, 4096
  v_mfma_f32_32x32x16_bf16 v[56:71], v[148:151], a[56:59], v[56:71]
  ds_read_b128 v[160:163], v2 offset:14336
  v_add_f32 v105, 0x3727c5ac, v105
  v_cvt_pk_bf16_f32 v105, v105, v105
  v_lshlrev_b32 v105, 16, v105
  v_sqrt_f32 v105, v105
  v_cvt_pk_bf16_f32 v107, -v104, -v104
  s_waitcnt lgkmcnt(1)
  v_mfma_f32_32x32x16_bf16 v[72:87], v[152:155], a[56:59], v[72:87]
  ds_read_b128 v[164:167], v2 offset:15360
  buffer_load_dwordx4 a[128:131], v2, s[44:47], s67 offen sc1
  v_cvt_pk_bf16_f32 v106, v105, v105
  s_waitcnt vmcnt(17)
  v_mfma_f32_32x32x16_bf16 v[40:55], v[156:159], a[60:63], v[40:55]
  ds_read_b128 v[144:147], v2 offset:16384
  v_lshlrev_b32 v105, 16, v106
  v_cmp_gt_u32 vcc, 32, v1
  v_mul_f32 v12, v105, v105
  v_rcp_f32 v105, v105
  s_waitcnt lgkmcnt(1)
  v_mfma_f32_32x32x16_bf16 v[56:71], v[160:163], a[60:63], v[56:71]
  ds_read_b128 v[148:151], v2 offset:17408
  buffer_load_dwordx4 a[132:135], v2, s[44:47], s67 offen offset:1024 sc1
  v_cndmask_b32 v107, 0, v107, vcc
  v_mfma_f32_32x32x16_bf16 v[72:87], v[164:167], a[60:63], v[72:87]
  ds_read_b128 v[152:155], v2 offset:18432
  v_cndmask_b32 v106, 0, v106, vcc
  v_mov_b32 v108, 0
  v_mul_f32 v11, 0xbfb8aa3b, v105
  v_accvgpr_write_b32 a160, v107
  v_accvgpr_write_b32 a161, v106
  v_accvgpr_write_b32 a162, v108
  s_waitcnt vmcnt(17) lgkmcnt(1)
  v_mfma_f32_32x32x16_bf16 v[40:55], v[144:147], a[64:67], v[40:55]
  ds_read_b128 v[156:159], v2 offset:19456
  buffer_load_dwordx4 a[136:139], v2, s[44:47], s67 offen offset:2048 sc1
  v_accvgpr_write_b32 a163, v108
  v_mfma_f32_32x32x16_bf16 v[56:71], v[148:151], a[64:67], v[56:71]
  ds_read_b128 v[160:163], v2 offset:20480
  s_waitcnt lgkmcnt(1)
  v_mfma_f32_32x32x16_bf16 v[72:87], v[152:155], a[64:67], v[72:87]
  ds_read_b128 v[164:167], v2 offset:21504
  buffer_load_dwordx4 a[140:143], v2, s[44:47], s67 offen offset:3072 sc1
  s_add_u32 s67, s67, 4096
  s_waitcnt vmcnt(18)
  v_mfma_f32_32x32x16_bf16 v[40:55], v[156:159], a[68:71], v[40:55]
  ds_read_b128 v[144:147], v2 offset:22528
  s_waitcnt lgkmcnt(1)
  v_mfma_f32_32x32x16_bf16 v[56:71], v[160:163], a[68:71], v[56:71]
  ds_read_b128 v[148:151], v2 offset:23552
  buffer_load_dwordx4 a[144:147], v2, s[44:47], s67 offen sc1
  v_mfma_f32_32x32x16_bf16 v[72:87], v[164:167], a[68:71], v[72:87]
  ds_read_b128 v[152:155], v2 offset:24576
  s_waitcnt vmcnt(18) lgkmcnt(1)
  v_mfma_f32_32x32x16_bf16 v[40:55], v[144:147], a[72:75], v[40:55]
  ds_read_b128 v[156:159], v2 offset:25600
  buffer_load_dwordx4 a[148:151], v2, s[44:47], s67 offen offset:1024 sc1
  v_mfma_f32_32x32x16_bf16 v[56:71], v[148:151], a[72:75], v[56:71]
  ds_read_b128 v[160:163], v2 offset:26624
  s_waitcnt lgkmcnt(1)
  v_mfma_f32_32x32x16_bf16 v[72:87], v[152:155], a[72:75], v[72:87]
  ds_read_b128 v[164:167], v2 offset:27648
  buffer_load_dwordx4 a[152:155], v2, s[44:47], s67 offen offset:2048 sc1
  s_waitcnt vmcnt(19)
  v_mfma_f32_32x32x16_bf16 v[40:55], v[156:159], a[76:79], v[40:55]
  ds_read_b128 v[144:147], v2 offset:28672
  s_waitcnt lgkmcnt(1)
  v_mfma_f32_32x32x16_bf16 v[56:71], v[160:163], a[76:79], v[56:71]
  ds_read_b128 v[148:151], v2 offset:29696
  buffer_load_dwordx4 a[156:159], v2, s[44:47], s67 offen offset:3072 sc1
  s_add_u32 s67, s67, 4096
  v_mfma_f32_32x32x16_bf16 v[72:87], v[164:167], a[76:79], v[72:87]
  ds_read_b128 v[152:155], v2 offset:30720
  s_waitcnt vmcnt(19) lgkmcnt(1)
  v_mfma_f32_32x32x16_bf16 v[40:55], v[144:147], a[80:83], v[40:55]
  ds_read_b128 v[156:159], v2 offset:31744
  buffer_load_dwordx4 v2, s[44:47], s64 offen sc1 lds
  v_mfma_f32_32x32x16_bf16 v[56:71], v[148:151], a[80:83], v[56:71]
  s_barrier
  ds_read_b128 v[160:163], v2 offset:32768
  s_waitcnt lgkmcnt(1)
  v_mfma_f32_32x32x16_bf16 v[72:87], v[152:155], a[80:83], v[72:87]
  ds_read_b128 v[164:167], v2 offset:33792
  buffer_load_dwordx4 v2, s[44:47], s64 offen offset:1024 sc1 lds
  s_waitcnt vmcnt(20)
  v_mfma_f32_32x32x16_bf16 v[40:55], v[156:159], a[84:87], v[40:55]
  ds_read_b128 v[144:147], v2 offset:34816
  s_waitcnt lgkmcnt(1)
  v_mfma_f32_32x32x16_bf16 v[56:71], v[160:163], a[84:87], v[56:71]
  ds_read_b128 v[148:151], v2 offset:35840
  buffer_load_dwordx4 v2, s[44:47], s64 offen offset:2048 sc1 lds
  v_mfma_f32_32x32x16_bf16 v[72:87], v[164:167], a[84:87], v[72:87]
  ds_read_b128 v[152:155], v2 offset:36864
  s_waitcnt vmcnt(20) lgkmcnt(1)
  v_mfma_f32_32x32x16_bf16 v[40:55], v[144:147], a[88:91], v[40:55]
  ds_read_b128 v[156:159], v2 offset:37888
  buffer_load_dwordx4 v2, s[44:47], s64 offen offset:3072 sc1 lds
  s_add_u32 s64, s64, 16384
  s_add_u32 m0, s66, 131072
  v_mfma_f32_32x32x16_bf16 v[56:71], v[148:151], a[88:91], v[56:71]
  ds_read_b128 v[160:163], v2 offset:38912
  s_waitcnt lgkmcnt(1)
  v_mfma_f32_32x32x16_bf16 v[72:87], v[152:155], a[88:91], v[72:87]
  ds_read_b128 v[164:167], v2 offset:39936
  buffer_load_dwordx4 v2, s[44:47], s64 offen sc1 lds
  s_waitcnt vmcnt(21)
  v_mfma_f32_32x32x16_bf16 v[40:55], v[156:159], a[92:95], v[40:55]
  ds_read_b128 v[144:147], v2 offset:40960
  s_waitcnt lgkmcnt(1)
  v_mfma_f32_32x32x16_bf16 v[56:71], v[160:163], a[92:95], v[56:71]
  ds_read_b128 v[148:151], v2 offset:41984
  buffer_load_dwordx4 v2, s[44:47], s64 offen offset:1024 sc1 lds
  v_mfma_f32_32x32x16_bf16 v[72:87], v[164:167], a[92:95], v[72:87]
  ds_read_b128 v[152:155], v2 offset:43008
  s_waitcnt vmcnt(21) lgkmcnt(1)
  v_mfma_f32_32x32x16_bf16 v[40:55], v[144:147], a[96:99], v[40:55]
  ds_read_b128 v[156:159], v2 offset:44032
  buffer_load_dwordx4 v2, s[44:47], s64 offen offset:2048 sc1 lds
  v_mfma_f32_32x32x16_bf16 v[56:71], v[148:151], a[96:99], v[56:71]
  ds_read_b128 v[160:163], v2 offset:45056
  s_waitcnt lgkmcnt(1)
  v_mfma_f32_32x32x16_bf16 v[72:87], v[152:155], a[96:99], v[72:87]
  ds_read_b128 v[164:167], v2 offset:46080
  buffer_load_dwordx4 v2, s[44:47], s64 offen offset:3072 sc1 lds
  s_add_u32 s64, s64, 16384
  s_add_u32 m0, s66, 0
  s_waitcnt vmcnt(22)
  v_mfma_f32_32x32x16_bf16 v[40:55], v[156:159], a[100:103], v[40:55]
  ds_read_b128 v[144:147], v2 offset:47104
  s_waitcnt lgkmcnt(1)
  v_mfma_f32_32x32x16_bf16 v[56:71], v[160:163], a[100:103], v[56:71]
  ds_read_b128 v[148:151], v2 offset:48128
  buffer_load_dwordx4 v2, s[44:47], s64 offen sc1 lds
  v_mfma_f32_32x32x16_bf16 v[72:87], v[164:167], a[100:103], v[72:87]
  ds_read_b128 v[152:155], v2 offset:49152
  s_waitcnt vmcnt(22) lgkmcnt(1)
  v_mfma_f32_32x32x16_bf16 v[40:55], v[144:147], a[104:107], v[40:55]
  ds_read_b128 v[156:159], v2 offset:50176
  buffer_load_dwordx4 v2, s[44:47], s64 offen offset:1024 sc1 lds
  v_mfma_f32_32x32x16_bf16 v[56:71], v[148:151], a[104:107], v[56:71]
  ds_read_b128 v[160:163], v2 offset:51200
  s_waitcnt lgkmcnt(1)
  v_mfma_f32_32x32x16_bf16 v[72:87], v[152:155], a[104:107], v[72:87]
  ds_read_b128 v[164:167], v2 offset:52224
  buffer_load_dwordx4 v2, s[44:47], s64 offen offset:2048 sc1 lds
  s_waitcnt vmcnt(23)
  v_mfma_f32_32x32x16_bf16 v[40:55], v[156:159], a[108:111], v[40:55]
  ds_read_b128 v[144:147], v2 offset:53248
  s_waitcnt lgkmcnt(1)
  v_mfma_f32_32x32x16_bf16 v[56:71], v[160:163], a[108:111], v[56:71]
  ds_read_b128 v[148:151], v2 offset:54272
  buffer_load_dwordx4 v2, s[44:47], s64 offen offset:3072 sc1 lds
  s_add_u32 s64, s64, 16384
  s_add_u32 m0, s66, 16384
  v_mfma_f32_32x32x16_bf16 v[72:87], v[164:167], a[108:111], v[72:87]
  ds_read_b128 v[152:155], v2 offset:55296
  s_waitcnt vmcnt(23) lgkmcnt(1)
  v_mfma_f32_32x32x16_bf16 v[40:55], v[144:147], a[112:115], v[40:55]
  ds_read_b128 v[156:159], v2 offset:56320
  v_mfma_f32_32x32x16_bf16 v[56:71], v[148:151], a[112:115], v[56:71]
  ds_read_b128 v[160:163], v2 offset:57344
  s_waitcnt lgkmcnt(1)
  v_mfma_f32_32x32x16_bf16 v[72:87], v[152:155], a[112:115], v[72:87]
  ds_read_b128 v[164:167], v2 offset:58368
  s_waitcnt vmcnt(22)
  v_mfma_f32_32x32x16_bf16 v[40:55], v[156:159], a[116:119], v[40:55]
  ds_read_b128 v[144:147], v2 offset:59392
  s_waitcnt lgkmcnt(1)
  v_mfma_f32_32x32x16_bf16 v[56:71], v[160:163], a[116:119], v[56:71]
  ds_read_b128 v[148:151], v2 offset:60416
  v_mfma_f32_32x32x16_bf16 v[72:87], v[164:167], a[116:119], v[72:87]
  ds_read_b128 v[152:155], v2 offset:61440
  s_waitcnt vmcnt(21) lgkmcnt(1)
  v_mfma_f32_32x32x16_bf16 v[40:55], v[144:147], a[120:123], v[40:55]
  ds_read_b128 v[156:159], v2 offset:62464
  v_mfma_f32_32x32x16_bf16 v[56:71], v[148:151], a[120:123], v[56:71]
  ds_read_b128 v[160:163], v2 offset:63488
  s_waitcnt lgkmcnt(1)
  v_mfma_f32_32x32x16_bf16 v[72:87], v[152:155], a[120:123], v[72:87]
  ds_read_b128 v[164:167], v2 offset:64512
  s_waitcnt vmcnt(20)
  v_mfma_f32_32x32x16_bf16 v[40:55], v[156:159], a[124:127], v[40:55]
  s_barrier
  ds_read_b128 v[144:147], v3 offset:0
  s_waitcnt lgkmcnt(1)
  v_mfma_f32_32x32x16_bf16 v[56:71], v[160:163], a[124:127], v[56:71]
  ds_read_b128 v[148:151], v3 offset:1024
  buffer_load_dwordx4 v2, s[44:47], s64 offen sc1 lds
  v_mfma_f32_32x32x16_bf16 v[72:87], v[164:167], a[124:127], v[72:87]
  ds_read_b128 v[152:155], v3 offset:2048
  s_waitcnt vmcnt(20) lgkmcnt(1)
  v_mfma_f32_32x32x16_bf16 v[40:55], v[144:147], a[128:131], v[40:55]
  ds_read_b128 v[156:159], v3 offset:3072
  buffer_load_dwordx4 v2, s[44:47], s64 offen offset:1024 sc1 lds
  v_mfma_f32_32x32x16_bf16 v[56:71], v[148:151], a[128:131], v[56:71]
  ds_read_b128 v[160:163], v3 offset:4096
  s_waitcnt lgkmcnt(1)
  v_mfma_f32_32x32x16_bf16 v[72:87], v[152:155], a[128:131], v[72:87]
  ds_read_b128 v[164:167], v3 offset:5120
  buffer_load_dwordx4 v2, s[44:47], s64 offen offset:2048 sc1 lds
  s_waitcnt vmcnt(21)
  v_mfma_f32_32x32x16_bf16 v[40:55], v[156:159], a[132:135], v[40:55]
  ds_read_b128 v[144:147], v3 offset:6144
  s_waitcnt lgkmcnt(1)
  v_mfma_f32_32x32x16_bf16 v[56:71], v[160:163], a[132:135], v[56:71]
  ds_read_b128 v[148:151], v3 offset:7168
  buffer_load_dwordx4 v2, s[44:47], s64 offen offset:3072 sc1 lds
  s_add_u32 s64, s64, 16384
  s_add_u32 m0, s66, 32768
  v_mfma_f32_32x32x16_bf16 v[72:87], v[164:167], a[132:135], v[72:87]
  ds_read_b128 v[152:155], v3 offset:8192
  s_waitcnt vmcnt(21) lgkmcnt(1)
  v_mfma_f32_32x32x16_bf16 v[40:55], v[144:147], a[136:139], v[40:55]
  ds_read_b128 v[156:159], v3 offset:9216
  buffer_load_dwordx4 v2, s[44:47], s64 offen sc1 lds
  v_mfma_f32_32x32x16_bf16 v[56:71], v[148:151], a[136:139], v[56:71]
  ds_read_b128 v[160:163], v3 offset:10240
  s_waitcnt lgkmcnt(1)
  v_mfma_f32_32x32x16_bf16 v[72:87], v[152:155], a[136:139], v[72:87]
  ds_read_b128 v[164:167], v3 offset:11264
  buffer_load_dwordx4 v2, s[44:47], s64 offen offset:1024 sc1 lds
  s_waitcnt vmcnt(22)
  v_mfma_f32_32x32x16_bf16 v[40:55], v[156:159], a[140:143], v[40:55]
  ds_read_b128 v[144:147], v3 offset:12288
  s_waitcnt lgkmcnt(1)
  v_mfma_f32_32x32x16_bf16 v[56:71], v[160:163], a[140:143], v[56:71]
  ds_read_b128 v[148:151], v3 offset:13312
  buffer_load_dwordx4 v2, s[44:47], s64 offen offset:2048 sc1 lds
  v_mfma_f32_32x32x16_bf16 v[72:87], v[164:167], a[140:143], v[72:87]
  ds_read_b128 v[152:155], v3 offset:14336
  s_waitcnt vmcnt(22) lgkmcnt(1)
  v_mfma_f32_32x32x16_bf16 v[40:55], v[144:147], a[144:147], v[40:55]
  ds_read_b128 v[156:159], v3 offset:15360
  buffer_load_dwordx4 v2, s[44:47], s64 offen offset:3072 sc1 lds
  s_add_u32 s64, s64, 16384
  s_add_u32 m0, s66, 49152
  v_mfma_f32_32x32x16_bf16 v[56:71], v[148:151], a[144:147], v[56:71]
  ds_read_b128 v[160:163], v3 offset:16384
  s_waitcnt lgkmcnt(1)
  v_mfma_f32_32x32x16_bf16 v[72:87], v[152:155], a[144:147], v[72:87]
  ds_read_b128 v[164:167], v3 offset:17408
  s_waitcnt vmcnt(22)
  v_mfma_f32_32x32x16_bf16 v[40:55], v[156:159], a[148:151], v[40:55]
  ds_read_b128 v[144:147], v3 offset:18432
  s_waitcnt lgkmcnt(1)
  v_mfma_f32_32x32x16_bf16 v[56:71], v[160:163], a[148:151], v[56:71]
  ds_read_b128 v[148:151], v3 offset:19456
  v_mfma_f32_32x32x16_bf16 v[72:87], v[164:167], a[148:151], v[72:87]
  ds_read_b128 v[152:155], v3 offset:20480
  s_waitcnt vmcnt(21) lgkmcnt(1)
  v_mfma_f32_32x32x16_bf16 v[40:55], v[144:147], a[152:155], v[40:55]
  ds_read_b128 v[156:159], v3 offset:21504
  v_mfma_f32_32x32x16_bf16 v[56:71], v[148:151], a[152:155], v[56:71]
  ds_read_b128 v[160:163], v3 offset:22528
  s_waitcnt lgkmcnt(1)
  v_mfma_f32_32x32x16_bf16 v[72:87], v[152:155], a[152:155], v[72:87]
  ds_read_b128 v[164:167], v3 offset:23552
  s_waitcnt vmcnt(20)
  v_mfma_f32_32x32x16_bf16 v[40:55], v[156:159], a[156:159], v[40:55]
  ds_read_b128 v[144:147], v5 offset:0
  s_waitcnt lgkmcnt(1)
  v_mfma_f32_32x32x16_bf16 v[56:71], v[160:163], a[156:159], v[56:71]
  ds_read_b128 v[148:151], v5 offset:512
  v_mfma_f32_32x32x16_bf16 v[72:87], v[164:167], a[156:159], v[72:87]
  ds_read_b128 v[152:155], v5 offset:1024
  s_waitcnt lgkmcnt(1)
  v_mfma_f32_32x32x16_bf16 v[40:55], v[144:147], a[160:163], v[40:55]
  ds_read_b128 v[156:159], v3 offset:24576
  v_mfma_f32_32x32x16_bf16 v[56:71], v[148:151], a[160:163], v[56:71]
  ds_read_b128 v[160:163], v3 offset:25600
  s_waitcnt lgkmcnt(1)
  v_mfma_f32_32x32x16_bf16 v[72:87], v[152:155], a[160:163], v[72:87]
  ds_read_b128 v[164:167], v3 offset:26624
  v_mfma_f32_32x32x16_bf16 v[88:103], v[156:159], a[0:3], 0
  ds_read_b128 v[144:147], v3 offset:27648
  s_waitcnt lgkmcnt(1)
  v_mfma_f32_32x32x16_bf16 v[88:103], v[160:163], a[4:7], v[88:103]
  ds_read_b128 v[148:151], v3 offset:28672
  s_nop 0
  v_mul_f32 v176, v40, v11
  v_mul_f32 v48, v40, v48
  v_mul_f32 v177, v41, v11
  v_mul_f32 v49, v41, v49
  v_mfma_f32_32x32x16_bf16 v[88:103], v[164:167], a[8:11], v[88:103]
  ds_read_b128 v[152:155], v3 offset:29696
  v_exp_f32 v176, v176
  v_mul_f32 v178, v42, v11
  v_mul_f32 v50, v42, v50
  v_exp_f32 v177, v177
  s_waitcnt lgkmcnt(1)
  v_mfma_f32_32x32x16_bf16 v[88:103], v[144:147], a[12:15], v[88:103]
  ds_read_b128 v[156:159], v3 offset:30720
  v_fma_f32 v176, v176, v12, v12
  v_mul_f32 v179, v43, v11
  v_mul_f32 v51, v43, v51
  v_exp_f32 v178, v178
  v_mfma_f32_32x32x16_bf16 v[88:103], v[148:151], a[16:19], v[88:103]
  ds_read_b128 v[160:163], v3 offset:31744
  v_fma_f32 v177, v177, v12, v12
  v_rcp_f32 v176, v176
  v_mul_f32 v180, v44, v11
  v_mul_f32 v52, v44, v52
  s_waitcnt lgkmcnt(1)
  v_mfma_f32_32x32x16_bf16 v[88:103], v[152:155], a[20:23], v[88:103]
  s_waitcnt vmcnt(16)
  s_barrier
  ds_read_b128 v[164:167], v3 offset:32768
  v_exp_f32 v179, v179
  v_fma_f32 v178, v178, v12, v12
  v_rcp_f32 v177, v177
  v_mfma_f32_32x32x16_bf16 v[88:103], v[156:159], a[24:27], v[88:103]
  ds_read_b128 v[144:147], v3 offset:33792
  buffer_load_dwordx4 v2, s[44:47], s64 offen sc1 lds
  v_mul_f32 v48, v48, v176
  v_mul_f32 v181, v45, v11
  s_waitcnt lgkmcnt(1)
  v_mfma_f32_32x32x16_bf16 v[88:103], v[160:163], a[28:31], v[88:103]
  ds_read_b128 v[148:151], v3 offset:34816
  v_mul_f32 v53, v45, v53
  v_exp_f32 v180, v180
  v_fma_f32 v179, v179, v12, v12
  v_mfma_f32_32x32x16_bf16 v[88:103], v[164:167], a[32:35], v[88:103]
  ds_read_b128 v[152:155], v3 offset:35840
  buffer_load_dwordx4 v2, s[44:47], s64 offen offset:1024 sc1 lds
  v_rcp_f32 v178, v178
  s_waitcnt lgkmcnt(1)
  v_mfma_f32_32x32x16_bf16 v[88:103], v[144:147], a[36:39], v[88:103]
  ds_read_b128 v[156:159], v3 offset:36864
  v_mul_f32 v49, v49, v177
  v_mul_f32 v182, v46, v11
  v_mul_f32 v54, v46, v54
  v_exp_f32 v181, v181
  v_mfma_f32_32x32x16_bf16 v[88:103], v[148:151], a[40:43], v[88:103]
  ds_read_b128 v[160:163], v3 offset:37888
  buffer_load_dwordx4 v2, s[44:47], s64 offen offset:2048 sc1 lds
  v_fma_f32 v180, v180, v12, v12
  s_waitcnt lgkmcnt(1)
  v_mfma_f32_32x32x16_bf16 v[88:103], v[152:155], a[44:47], v[88:103]
  ds_read_b128 v[164:167], v3 offset:38912
  v_rcp_f32 v179, v179
  v_mul_f32 v50, v50, v178
  v_cvt_pk_bf16_f32 v40, v48, v49
  v_mul_f32 v183, v47, v11
  v_mfma_f32_32x32x16_bf16 v[88:103], v[156:159], a[48:51], v[88:103]
  ds_read_b128 v[144:147], v3 offset:39936
  buffer_load_dwordx4 v2, s[44:47], s64 offen offset:3072 sc1 lds
  s_add_u32 s64, s64, 16384
  s_add_u32 m0, s66, 65536
  s_waitcnt lgkmcnt(1)
  v_mfma_f32_32x32x16_bf16 v[88:103], v[160:163], a[52:55], v[88:103]
  ds_read_b128 v[148:151], v3 offset:40960
  v_mul_f32 v55, v47, v55
  v_exp_f32 v182, v182
  v_fma_f32 v181, v181, v12, v12
  v_mfma_f32_32x32x16_bf16 v[88:103], v[164:167], a[56:59], v[88:103]
  ds_read_b128 v[152:155], v3 offset:41984
  buffer_load_dwordx4 v2, s[44:47], s64 offen sc1 lds
  v_rcp_f32 v180, v180
  s_waitcnt lgkmcnt(1)
  v_mfma_f32_32x32x16_bf16 v[88:103], v[144:147], a[60:63], v[88:103]
  ds_read_b128 v[156:159], v3 offset:43008
  v_mul_f32 v51, v51, v179
  v_exp_f32 v183, v183
  v_fma_f32 v182, v182, v12, v12
  v_mfma_f32_32x32x16_bf16 v[88:103], v[148:151], a[64:67], v[88:103]
  ds_read_b128 v[160:163], v3 offset:44032
  buffer_load_dwordx4 v2, s[44:47], s64 offen offset:1024 sc1 lds
  v_rcp_f32 v181, v181
  s_waitcnt lgkmcnt(1)
  v_mfma_f32_32x32x16_bf16 v[88:103], v[152:155], a[68:71], v[88:103]
  ds_read_b128 v[164:167], v3 offset:45056
  v_mul_f32 v52, v52, v180
  v_cvt_pk_bf16_f32 v41, v50, v51
  v_fma_f32 v183, v183, v12, v12
  v_rcp_f32 v182, v182
  v_mfma_f32_32x32x16_bf16 v[88:103], v[156:159], a[72:75], v[88:103]
  ds_read_b128 v[144:147], v3 offset:46080
  buffer_load_dwordx4 v2, s[44:47], s64 offen offset:2048 sc1 lds
  v_mul_f32 v53, v53, v181
  s_waitcnt lgkmcnt(1)
  v_mfma_f32_32x32x16_bf16 v[88:103], v[160:163], a[76:79], v[88:103]
  ds_read_b128 v[148:151], v3 offset:47104
  v_rcp_f32 v183, v183
  v_mul_f32 v54, v54, v182
  v_cvt_pk_bf16_f32 v42, v52, v53
  v_mul_f32 v55, v55, v183
  v_mfma_f32_32x32x16_bf16 v[88:103], v[164:167], a[80:83], v[88:103]
  ds_read_b128 v[152:155], v3 offset:48128
  buffer_load_dwordx4 v2, s[44:47], s64 offen offset:3072 sc1 lds
  s_add_u32 s64, s64, 16384
  s_add_u32 m0, s66, 81920
  s_waitcnt lgkmcnt(1)
  v_mfma_f32_32x32x16_bf16 v[88:103], v[144:147], a[84:87], v[88:103]
  ds_read_b128 v[156:159], v3 offset:49152
  v_cvt_pk_bf16_f32 v43, v54, v55
  buffer_store_dwordx4 v[40:43], v6, s[44:47], s68 offen sc1
  v_mfma_f32_32x32x16_bf16 v[88:103], v[148:151], a[88:91], v[88:103]
  ds_read_b128 v[160:163], v3 offset:50176
  v_mul_f32 v176, v56, v11
  v_mul_f32 v64, v56, v64
  v_mul_f32 v177, v57, v11
  v_mul_f32 v65, v57, v65
  v_exp_f32 v176, v176
  s_waitcnt lgkmcnt(1)
  v_mfma_f32_32x32x16_bf16 v[88:103], v[152:155], a[92:95], v[88:103]
  ds_read_b128 v[164:167], v3 offset:51200
  v_mul_f32 v178, v58, v11
  v_mul_f32 v66, v58, v66
  v_exp_f32 v177, v177
  v_fma_f32 v176, v176, v12, v12
  v_mfma_f32_32x32x16_bf16 v[88:103], v[156:159], a[96:99], v[88:103]
  ds_read_b128 v[144:147], v3 offset:52224
  v_mul_f32 v179, v59, v11
  v_mul_f32 v67, v59, v67
  v_exp_f32 v178, v178
  v_fma_f32 v177, v177, v12, v12
  s_waitcnt lgkmcnt(1)
  v_mfma_f32_32x32x16_bf16 v[88:103], v[160:163], a[100:103], v[88:103]
  ds_read_b128 v[148:151], v3 offset:53248
  v_rcp_f32 v176, v176
  v_mul_f32 v180, v60, v11
  v_mul_f32 v68, v60, v68
  v_mfma_f32_32x32x16_bf16 v[88:103], v[164:167], a[104:107], v[88:103]
  ds_read_b128 v[152:155], v3 offset:54272
  v_exp_f32 v179, v179
  v_fma_f32 v178, v178, v12, v12
  v_rcp_f32 v177, v177
  v_mul_f32 v64, v64, v176
  s_waitcnt lgkmcnt(1)
  v_mfma_f32_32x32x16_bf16 v[88:103], v[144:147], a[108:111], v[88:103]
  ds_read_b128 v[156:159], v3 offset:55296
  s_waitcnt vmcnt(59)
  v_cmp_gt_u32 vcc, 54, v19
  v_mul_f32 v181, v61, v11
  v_mul_f32 v69, v61, v69
  v_exp_f32 v180, v180
  v_mfma_f32_32x32x16_bf16 v[88:103], v[148:151], a[112:115], v[88:103]
  ds_read_b128 v[160:163], v3 offset:56320
  v_fma_f32 v179, v179, v12, v12
  v_rcp_f32 v178, v178
  v_mul_f32 v65, v65, v177
  v_mul_f32 v182, v62, v11
  v_mul_f32 v70, v62, v70
  s_waitcnt lgkmcnt(1)
  v_mfma_f32_32x32x16_bf16 v[88:103], v[152:155], a[116:119], v[88:103]
  ds_read_b128 v[164:167], v3 offset:57344
  s_cbranch_vccnz L_slow_27
L_back_28:
  v_exp_f32 v181, v181
  v_fma_f32 v180, v180, v12, v12
  v_mfma_f32_32x32x16_bf16 v[88:103], v[156:159], a[120:123], v[88:103]
  ds_read_b128 v[144:147], v3 offset:58368
  v_rcp_f32 v179, v179
  v_mul_f32 v66, v66, v178
  v_cvt_pk_bf16_f32 v56, v64, v65
  v_mul_f32 v183, v63, v11
  v_mul_f32 v71, v63, v71
  s_waitcnt lgkmcnt(1)
  v_mfma_f32_32x32x16_bf16 v[88:103], v[160:163], a[124:127], v[88:103]
  ds_read_b128 v[148:151], v3 offset:59392
  v_exp_f32 v182, v182
  v_fma_f32 v181, v181, v12, v12
  v_rcp_f32 v180, v180
  v_mfma_f32_32x32x16_bf16 v[88:103], v[164:167], a[128:131], v[88:103]
  ds_read_b128 v[152:155], v3 offset:60416
  v_mul_f32 v67, v67, v179
  v_exp_f32 v183, v183
  v_fma_f32 v182, v182, v12, v12
  v_rcp_f32 v181, v181
  s_waitcnt lgkmcnt(1)
  v_mfma_f32_32x32x16_bf16 v[88:103], v[144:147], a[132:135], v[88:103]
  ds_read_b128 v[156:159], v3 offset:61440
  v_mul_f32 v68, v68, v180
  v_cvt_pk_bf16_f32 v57, v66, v67
  v_fma_f32 v183, v183, v12, v12
  v_rcp_f32 v182, v182
  v_mfma_f32_32x32x16_bf16 v[88:103], v[148:151], a[136:139], v[88:103]
  ds_read_b128 v[160:163], v3 offset:62464
  v_mul_f32 v69, v69, v181
  v_rcp_f32 v183, v183
  v_mul_f32 v70, v70, v182
  v_cvt_pk_bf16_f32 v58, v68, v69
  v_mul_f32 v71, v71, v183
  s_waitcnt lgkmcnt(1)
  v_mfma_f32_32x32x16_bf16 v[88:103], v[152:155], a[140:143], v[88:103]
  ds_read_b128 v[164:167], v3 offset:63488
  v_cvt_pk_bf16_f32 v59, v70, v71
  buffer_store_dwordx4 v[56:59], v6, s[44:47], s69 offen sc1
  v_mfma_f32_32x32x16_bf16 v[88:103], v[156:159], a[144:147], v[88:103]
  ds_read_b128 v[144:147], v3 offset:64512
  v_mul_f32 v176, v72, v11
  v_mul_f32 v80, v72, v80
  v_mul_f32 v177, v73, v11
  v_mul_f32 v81, v73, v81
  v_exp_f32 v176, v176
  s_waitcnt lgkmcnt(1)
  v_mfma_f32_32x32x16_bf16 v[88:103], v[160:163], a[148:151], v[88:103]
  ds_read_b128 v[148:151], v5 offset:1536
  v_mul_f32 v178, v74, v11
  v_mul_f32 v82, v74, v82
  v_exp_f32 v177, v177
  v_fma_f32 v176, v176, v12, v12
  v_mfma_f32_32x32x16_bf16 v[88:103], v[164:167], a[152:155], v[88:103]
  s_waitcnt vmcnt(18)
  s_barrier
  ds_read_b128 v[152:155], v4 offset:0
  v_mul_f32 v179, v75, v11
  v_mul_f32 v83, v75, v83
  v_exp_f32 v178, v178
  v_fma_f32 v177, v177, v12, v12
  s_waitcnt lgkmcnt(1)
  v_mfma_f32_32x32x16_bf16 v[88:103], v[144:147], a[156:159], v[88:103]
  ds_read_b128 v[156:159], v4 offset:1024
  buffer_load_dwordx4 v2, s[44:47], s64 offen sc1 lds
  v_mfma_f32_32x32x16_bf16 v[88:103], v[148:151], a[160:163], v[88:103]
  ds_read_b128 v[160:163], v4 offset:2048
  v_rcp_f32 v176, v176
  v_mul_f32 v180, v76, v11
  v_mul_f32 v84, v76, v84
  v_exp_f32 v179, v179
  s_waitcnt lgkmcnt(1)
  v_mfma_f32_32x32x16_bf16 v[40:55], v[152:155], a[0:3], 0
  ds_read_b128 v[164:167], v4 offset:3072
  buffer_load_dwordx4 v2, s[44:47], s64 offen offset:1024 sc1 lds
  v_fma_f32 v178, v178, v12, v12
  v_mfma_f32_32x32x16_bf16 v[40:55], v[156:159], a[4:7], v[40:55]
  ds_read_b128 v[144:147], v4 offset:4096
  v_rcp_f32 v177, v177
  v_mul_f32 v80, v80, v176
  v_mul_f32 v181, v77, v11
  v_mul_f32 v85, v77, v85
  s_waitcnt lgkmcnt(1)
  v_mfma_f32_32x32x16_bf16 v[40:55], v[160:163], a[8:11], v[40:55]
  ds_read_b128 v[148:151], v4 offset:5120
  buffer_load_dwordx4 v2, s[44:47], s64 offen offset:2048 sc1 lds
  v_mfma_f32_32x32x16_bf16 v[40:55], v[164:167], a[12:15], v[40:55]
  ds_read_b128 v[152:155], v4 offset:6144
  v_exp_f32 v180, v180
  v_fma_f32 v179, v179, v12, v12
  v_rcp_f32 v178, v178
  v_mul_f32 v81, v81, v177
  s_waitcnt lgkmcnt(1)
  v_mfma_f32_32x32x16_bf16 v[40:55], v[144:147], a[16:19], v[40:55]
  ds_read_b128 v[156:159], v4 offset:7168
  buffer_load_dwordx4 v2, s[44:47], s64 offen offset:3072 sc1 lds
  s_add_u32 s64, s64, 16384
  s_add_u32 m0, s66, 98304
  v_mfma_f32_32x32x16_bf16 v[40:55], v[148:151], a[20:23], v[40:55]
  ds_read_b128 v[160:163], v4 offset:8192
  v_mul_f32 v182, v78, v11
  v_mul_f32 v86, v78, v86
  v_exp_f32 v181, v181
  v_fma_f32 v180, v180, v12, v12
  s_waitcnt lgkmcnt(1)
  v_mfma_f32_32x32x16_bf16 v[40:55], v[152:155], a[24:27], v[40:55]
  ds_read_b128 v[164:167], v4 offset:9216
  buffer_load_dwordx4 v2, s[44:47], s64 offen sc1 lds
  v_mfma_f32_32x32x16_bf16 v[40:55], v[156:159], a[28:31], v[40:55]
  ds_read_b128 v[144:147], v4 offset:10240
  v_rcp_f32 v179, v179
  v_mul_f32 v82, v82, v178
  v_cvt_pk_bf16_f32 v72, v80, v81
  v_mul_f32 v183, v79, v11
  v_mul_f32 v87, v79, v87
  s_waitcnt lgkmcnt(1)
  v_mfma_f32_32x32x16_bf16 v[40:55], v[160:163], a[32:35], v[40:55]
  ds_read_b128 v[148:151], v4 offset:11264
  buffer_load_dwordx4 v2, s[44:47], s64 offen offset:1024 sc1 lds
  v_mfma_f32_32x32x16_bf16 v[40:55], v[164:167], a[36:39], v[40:55]
  ds_read_b128 v[152:155], v4 offset:12288
  v_exp_f32 v182, v182
  v_fma_f32 v181, v181, v12, v12
  v_rcp_f32 v180, v180
  v_mul_f32 v83, v83, v179
  s_waitcnt lgkmcnt(1)
  v_mfma_f32_32x32x16_bf16 v[40:55], v[144:147], a[40:43], v[40:55]
  ds_read_b128 v[156:159], v4 offset:13312
  buffer_load_dwordx4 v2, s[44:47], s64 offen offset:2048 sc1 lds
  v_mfma_f32_32x32x16_bf16 v[40:55], v[148:151], a[44:47], v[40:55]
  ds_read_b128 v[160:163], v4 offset:14336
  v_exp_f32 v183, v183
  v_fma_f32 v182, v182, v12, v12
  v_rcp_f32 v181, v181
  v_mul_f32 v84, v84, v180
  s_waitcnt lgkmcnt(1)
  v_mfma_f32_32x32x16_bf16 v[40:55], v[152:155], a[48:51], v[40:55]
  ds_read_b128 v[164:167], v4 offset:15360
  s_waitcnt vmcnt(8)
  buffer_store_dword v8, v7, s[44:47], s75 offen offset:0 sc1
  v_cvt_pk_bf16_f32 v73, v82, v83
  v_mfma_f32_32x32x16_bf16 v[40:55], v[156:159], a[52:55], v[40:55]
  ds_read_b128 v[144:147], v2 offset:0
  v_fma_f32 v183, v183, v12, v12
  v_rcp_f32 v182, v182
  v_mul_f32 v85, v85, v181
  v_rcp_f32 v183, v183
  s_waitcnt lgkmcnt(1)
  v_mfma_f32_32x32x16_bf16 v[40:55], v[160:163], a[56:59], v[40:55]
  ds_read_b128 v[148:151], v2 offset:1024
  buffer_load_dwordx4 v2, s[44:47], s64 offen offset:3072 sc1 lds
  s_mov_b32 s64, s65
  s_add_u32 m0, s66, 114688
  v_mfma_f32_32x32x16_bf16 v[40:55], v[164:167], a[60:63], v[40:55]
  ds_read_b128 v[152:155], v2 offset:2048
  v_mul_f32 v86, v86, v182
  v_cvt_pk_bf16_f32 v74, v84, v85
  v_mul_f32 v87, v87, v183
  v_cvt_pk_bf16_f32 v75, v86, v87
  buffer_store_dwordx4 v[72:75], v6, s[44:47], s70 offen sc1
  s_waitcnt lgkmcnt(1)
  v_mfma_f32_32x32x16_bf16 v[40:55], v[144:147], a[64:67], v[40:55]
  ds_read_b128 v[156:159], v2 offset:3072
  v_mul_f32 v176, v88, v11
  v_mul_f32 v96, v88, v96
  v_mul_f32 v177, v89, v11
  v_mul_f32 v97, v89, v97
  v_mfma_f32_32x32x16_bf16 v[40:55], v[148:151], a[68:71], v[40:55]
  ds_read_b128 v[160:163], v2 offset:4096
  v_exp_f32 v176, v176
  v_mul_f32 v178, v90, v11
  v_mul_f32 v98, v90, v98
  v_exp_f32 v177, v177
  s_waitcnt lgkmcnt(1)
  v_mfma_f32_32x32x16_bf16 v[40:55], v[152:155], a[72:75], v[40:55]
  ds_read_b128 v[164:167], v2 offset:5120
  v_fma_f32 v176, v176, v12, v12
  v_mul_f32 v179, v91, v11
  v_mul_f32 v99, v91, v99
  v_exp_f32 v178, v178
  v_mfma_f32_32x32x16_bf16 v[40:55], v[156:159], a[76:79], v[40:55]
  ds_read_b128 v[144:147], v2 offset:6144
  v_fma_f32 v177, v177, v12, v12
  v_rcp_f32 v176, v176
  v_mul_f32 v180, v92, v11
  v_mul_f32 v100, v92, v100
  s_waitcnt lgkmcnt(1)
  v_mfma_f32_32x32x16_bf16 v[40:55], v[160:163], a[80:83], v[40:55]
  ds_read_b128 v[148:151], v2 offset:7168
  v_exp_f32 v179, v179
  v_fma_f32 v178, v178, v12, v12
  v_rcp_f32 v177, v177
  v_mfma_f32_32x32x16_bf16 v[40:55], v[164:167], a[84:87], v[40:55]
  ds_read_b128 v[152:155], v2 offset:8192
  v_mul_f32 v96, v96, v176
  v_mul_f32 v181, v93, v11
  v_mul_f32 v101, v93, v101
  v_exp_f32 v180, v180
  v_fma_f32 v179, v179, v12, v12
  s_waitcnt lgkmcnt(1)
  v_mfma_f32_32x32x16_bf16 v[40:55], v[144:147], a[88:91], v[40:55]
  ds_read_b128 v[156:159], v2 offset:9216
  v_rcp_f32 v178, v178
  v_mul_f32 v97, v97, v177
  v_mul_f32 v182, v94, v11
  v_mul_f32 v102, v94, v102
  v_mfma_f32_32x32x16_bf16 v[40:55], v[148:151], a[92:95], v[40:55]
  ds_read_b128 v[160:163], v2 offset:10240
  v_exp_f32 v181, v181
  v_fma_f32 v180, v180, v12, v12
  v_rcp_f32 v179, v179
  v_mul_f32 v98, v98, v178
  s_waitcnt lgkmcnt(1)
  v_mfma_f32_32x32x16_bf16 v[40:55], v[152:155], a[96:99], v[40:55]
  ds_read_b128 v[164:167], v2 offset:11264
  v_cvt_pk_bf16_f32 v88, v96, v97
  v_mul_f32 v183, v95, v11
  v_mul_f32 v103, v95, v103
  v_exp_f32 v182, v182
  v_mfma_f32_32x32x16_bf16 v[40:55], v[156:159], a[100:103], v[40:55]
  ds_read_b128 v[144:147], v2 offset:12288
  v_fma_f32 v181, v181, v12, v12
  v_rcp_f32 v180, v180
  v_mul_f32 v99, v99, v179
  v_exp_f32 v183, v183
  s_waitcnt lgkmcnt(1)
  v_mfma_f32_32x32x16_bf16 v[40:55], v[160:163], a[104:107], v[40:55]
  ds_read_b128 v[148:151], v2 offset:13312
  s_waitcnt vmcnt(10)
  buffer_store_dword v8, v7, s[44:47], s75 offen offset:64 sc1
  v_fma_f32 v182, v182, v12, v12
  v_mfma_f32_32x32x16_bf16 v[40:55], v[164:167], a[108:111], v[40:55]
  ds_read_b128 v[152:155], v2 offset:14336
  v_rcp_f32 v181, v181
  v_mul_f32 v100, v100, v180
  v_cvt_pk_bf16_f32 v89, v98, v99
  v_fma_f32 v183, v183, v12, v12
  s_waitcnt lgkmcnt(1)
  v_mfma_f32_32x32x16_bf16 v[40:55], v[144:147], a[112:115], v[40:55]
  ds_read_b128 v[156:159], v2 offset:15360
  v_rcp_f32 v182, v182
  v_mul_f32 v101, v101, v181
  v_rcp_f32 v183, v183
  v_mfma_f32_32x32x16_bf16 v[40:55], v[148:151], a[116:119], v[40:55]
  s_waitcnt vmcnt(21)
  s_barrier
  ds_read_b128 v[160:163], v2 offset:16384
  v_mul_f32 v102, v102, v182
  v_cvt_pk_bf16_f32 v90, v100, v101
  v_mul_f32 v103, v103, v183
  v_cvt_pk_bf16_f32 v91, v102, v103
  buffer_store_dwordx4 v[88:91], v6, s[44:47], s71 offen sc1
  s_waitcnt lgkmcnt(1)
  v_mfma_f32_32x32x16_bf16 v[40:55], v[152:155], a[120:123], v[40:55]
  ds_read_b128 v[164:167], v2 offset:17408
  v_mfma_f32_32x32x16_bf16 v[40:55], v[156:159], a[124:127], v[40:55]
  ds_read_b128 v[144:147], v2 offset:18432
  buffer_load_dwordx4 v2, s[44:47], s64 offen sc1 lds
  s_waitcnt lgkmcnt(1)
  v_mfma_f32_32x32x16_bf16 v[40:55], v[160:163], a[128:131], v[40:55]
  ds_read_b128 v[148:151], v2 offset:19456
  v_mfma_f32_32x32x16_bf16 v[40:55], v[164:167], a[132:135], v[40:55]
  ds_read_b128 v[152:155], v2 offset:20480
  buffer_load_dwordx4 v2, s[44:47], s64 offen offset:1024 sc1 lds
  s_waitcnt lgkmcnt(1)
  v_mfma_f32_32x32x16_bf16 v[40:55], v[144:147], a[136:139], v[40:55]
  ds_read_b128 v[156:159], v2 offset:21504
  v_mfma_f32_32x32x16_bf16 v[40:55], v[148:151], a[140:143], v[40:55]
  ds_read_b128 v[160:163], v2 offset:22528
  buffer_load_dwordx4 v2, s[44:47], s64 offen offset:2048 sc1 lds
  s_waitcnt lgkmcnt(1)
  v_mfma_f32_32x32x16_bf16 v[40:55], v[152:155], a[144:147], v[40:55]
  ds_read_b128 v[164:167], v2 offset:23552
  v_mfma_f32_32x32x16_bf16 v[40:55], v[156:159], a[148:151], v[40:55]
  ds_read_b128 v[144:147], v5 offset:2048
  buffer_load_dwordx4 v2, s[44:47], s64 offen offset:3072 sc1 lds
  s_add_u32 s64, s64, 16384
  s_add_u32 m0, s66, 131072
  s_waitcnt lgkmcnt(1)
  v_mfma_f32_32x32x16_bf16 v[40:55], v[160:163], a[152:155], v[40:55]
  ds_read_b128 v[148:151], v2 offset:24576
  v_mfma_f32_32x32x16_bf16 v[40:55], v[164:167], a[156:159], v[40:55]
  ds_read_b128 v[152:155], v2 offset:25600
  buffer_load_dwordx4 v2, s[44:47], s64 offen sc1 lds
  s_waitcnt lgkmcnt(1)
  v_mfma_f32_32x32x16_bf16 v[40:55], v[144:147], a[160:163], v[40:55]
  ds_read_b128 v[156:159], v2 offset:26624
  v_mfma_f32_32x32x16_bf16 v[56:71], v[148:151], a[0:3], 0
  ds_read_b128 v[160:163], v2 offset:27648
  buffer_load_dwordx4 v2, s[44:47], s64 offen offset:1024 sc1 lds
  s_waitcnt lgkmcnt(1)
  v_mfma_f32_32x32x16_bf16 v[56:71], v[152:155], a[4:7], v[56:71]
  ds_read_b128 v[164:167], v2 offset:28672
  v_mfma_f32_32x32x16_bf16 v[56:71], v[156:159], a[8:11], v[56:71]
  ds_read_b128 v[144:147], v2 offset:29696
  buffer_load_dwordx4 v2, s[44:47], s64 offen offset:2048 sc1 lds
  s_waitcnt lgkmcnt(1)
  v_mfma_f32_32x32x16_bf16 v[56:71], v[160:163], a[12:15], v[56:71]
  ds_read_b128 v[148:151], v2 offset:30720
  v_mul_f32 v176, v40, v11
  v_mul_f32 v48, v40, v48
  v_mul_f32 v177, v41, v11
  v_mul_f32 v49, v41, v49
  v_mfma_f32_32x32x16_bf16 v[56:71], v[164:167], a[16:19], v[56:71]
  ds_read_b128 v[152:155], v2 offset:31744
  buffer_load_dwordx4 v2, s[44:47], s64 offen offset:3072 sc1 lds
  s_add_u32 s64, s64, 16384
  s_add_u32 m0, s66, 0
  s_waitcnt lgkmcnt(1)
  v_mfma_f32_32x32x16_bf16 v[56:71], v[144:147], a[20:23], v[56:71]
  ds_read_b128 v[156:159], v2 offset:32768
  v_exp_f32 v176, v176
  v_mul_f32 v178, v42, v11
  v_mul_f32 v50, v42, v50
  v_mfma_f32_32x32x16_bf16 v[56:71], v[148:151], a[24:27], v[56:71]
  ds_read_b128 v[160:163], v2 offset:33792
  s_waitcnt vmcnt(10)
  buffer_store_dword v8, v7, s[44:47], s75 offen offset:128 sc1
  v_exp_f32 v177, v177
  s_waitcnt lgkmcnt(1)
  v_mfma_f32_32x32x16_bf16 v[56:71], v[152:155], a[28:31], v[56:71]
  ds_read_b128 v[164:167], v2 offset:34816
  v_fma_f32 v176, v176, v12, v12
  v_mul_f32 v179, v43, v11
  v_mul_f32 v51, v43, v51
  v_exp_f32 v178, v178
  v_mfma_f32_32x32x16_bf16 v[56:71], v[156:159], a[32:35], v[56:71]
  ds_read_b128 v[144:147], v2 offset:35840
  v_fma_f32 v177, v177, v12, v12
  v_rcp_f32 v176, v176
  v_mul_f32 v180, v44, v11
  v_mul_f32 v52, v44, v52
  s_waitcnt lgkmcnt(1)
  v_mfma_f32_32x32x16_bf16 v[56:71], v[160:163], a[36:39], v[56:71]
  ds_read_b128 v[148:151], v2 offset:36864
  v_exp_f32 v179, v179
  v_fma_f32 v178, v178, v12, v12
  v_rcp_f32 v177, v177
  v_mfma_f32_32x32x16_bf16 v[56:71], v[164:167], a[40:43], v[56:71]
  ds_read_b128 v[152:155], v2 offset:37888
  v_mul_f32 v48, v48, v176
  v_mul_f32 v181, v45, v11
  v_mul_f32 v53, v45, v53
  v_exp_f32 v180, v180
  v_fma_f32 v179, v179, v12, v12
  s_waitcnt lgkmcnt(1)
  v_mfma_f32_32x32x16_bf16 v[56:71], v[144:147], a[44:47], v[56:71]
  ds_read_b128 v[156:159], v2 offset:38912
  v_rcp_f32 v178, v178
  v_mul_f32 v49, v49, v177
  v_mul_f32 v182, v46, v11
  v_mul_f32 v54, v46, v54
  v_mfma_f32_32x32x16_bf16 v[56:71], v[148:151], a[48:51], v[56:71]
  ds_read_b128 v[160:163], v2 offset:39936
  v_exp_f32 v181, v181
  v_fma_f32 v180, v180, v12, v12
  v_rcp_f32 v179, v179
  v_mul_f32 v50, v50, v178
  s_waitcnt lgkmcnt(1)
  v_mfma_f32_32x32x16_bf16 v[56:71], v[152:155], a[52:55], v[56:71]
  ds_read_b128 v[164:167], v2 offset:40960
  v_cvt_pk_bf16_f32 v40, v48, v49
  v_mul_f32 v183, v47, v11
  v_mul_f32 v55, v47, v55
  v_exp_f32 v182, v182
  v_mfma_f32_32x32x16_bf16 v[56:71], v[156:159], a[56:59], v[56:71]
  ds_read_b128 v[144:147], v2 offset:41984
  buffer_load_dword v184, v9, s[44:47], s77 offen offset:0 sc1
  v_fma_f32 v181, v181, v12, v12
  s_waitcnt lgkmcnt(1)
  v_mfma_f32_32x32x16_bf16 v[56:71], v[160:163], a[60:63], v[56:71]
  ds_read_b128 v[148:151], v2 offset:43008
  v_rcp_f32 v180, v180
  v_mul_f32 v51, v51, v179
  v_exp_f32 v183, v183
  v_mfma_f32_32x32x16_bf16 v[56:71], v[164:167], a[64:67], v[56:71]
  ds_read_b128 v[152:155], v2 offset:44032
  v_fma_f32 v182, v182, v12, v12
  v_rcp_f32 v181, v181
  v_mul_f32 v52, v52, v180
  v_cvt_pk_bf16_f32 v41, v50, v51
  v_fma_f32 v183, v183, v12, v12
  s_waitcnt lgkmcnt(1)
  v_mfma_f32_32x32x16_bf16 v[56:71], v[144:147], a[68:71], v[56:71]
  ds_read_b128 v[156:159], v2 offset:45056
  v_rcp_f32 v182, v182
  v_mul_f32 v53, v53, v181
  v_rcp_f32 v183, v183
  v_mfma_f32_32x32x16_bf16 v[56:71], v[148:151], a[72:75], v[56:71]
  ds_read_b128 v[160:163], v2 offset:46080
  v_mul_f32 v54, v54, v182
  v_cvt_pk_bf16_f32 v42, v52, v53
  v_mul_f32 v55, v55, v183
  v_cvt_pk_bf16_f32 v43, v54, v55
  buffer_store_dwordx4 v[40:43], v6, s[44:47], s72 offen sc1
  s_waitcnt lgkmcnt(1)
  v_mfma_f32_32x32x16_bf16 v[56:71], v[152:155], a[76:79], v[56:71]
  ds_read_b128 v[164:167], v2 offset:47104
  v_mfma_f32_32x32x16_bf16 v[56:71], v[156:159], a[80:83], v[56:71]
  ds_read_b128 v[144:147], v2 offset:48128
  s_waitcnt vmcnt(11)
  buffer_store_dword v8, v7, s[44:47], s75 offen offset:192 sc1
  s_waitcnt lgkmcnt(1)
  v_mfma_f32_32x32x16_bf16 v[56:71], v[160:163], a[84:87], v[56:71]
  s_waitcnt vmcnt(26)
  s_barrier
  ds_read_b128 v[148:151], v2 offset:49152
  v_mfma_f32_32x32x16_bf16 v[56:71], v[164:167], a[88:91], v[56:71]
  ds_read_b128 v[152:155], v2 offset:50176
  buffer_load_dwordx4 v2, s[44:47], s64 offen sc1 lds
  s_waitcnt lgkmcnt(1)
  v_mfma_f32_32x32x16_bf16 v[56:71], v[144:147], a[92:95], v[56:71]
  ds_read_b128 v[156:159], v2 offset:51200
  v_mfma_f32_32x32x16_bf16 v[56:71], v[148:151], a[96:99], v[56:71]
  ds_read_b128 v[160:163], v2 offset:52224
  buffer_load_dwordx4 v2, s[44:47], s64 offen offset:1024 sc1 lds
  s_waitcnt lgkmcnt(1)
  v_mfma_f32_32x32x16_bf16 v[56:71], v[152:155], a[100:103], v[56:71]
  ds_read_b128 v[164:167], v2 offset:53248
  v_mfma_f32_32x32x16_bf16 v[56:71], v[156:159], a[104:107], v[56:71]
  ds_read_b128 v[144:147], v2 offset:54272
  buffer_load_dwordx4 v2, s[44:47], s64 offen offset:2048 sc1 lds
  s_waitcnt lgkmcnt(1)
  v_mfma_f32_32x32x16_bf16 v[56:71], v[160:163], a[108:111], v[56:71]
  ds_read_b128 v[148:151], v2 offset:55296
  v_mfma_f32_32x32x16_bf16 v[56:71], v[164:167], a[112:115], v[56:71]
  ds_read_b128 v[152:155], v2 offset:56320
  buffer_load_dword v185, v9, s[44:47], s77 offen offset:64 sc1
  s_waitcnt lgkmcnt(1)
  v_mfma_f32_32x32x16_bf16 v[56:71], v[144:147], a[116:119], v[56:71]
  ds_read_b128 v[156:159], v2 offset:57344
  v_mfma_f32_32x32x16_bf16 v[56:71], v[148:151], a[120:123], v[56:71]
  ds_read_b128 v[160:163], v2 offset:58368
  buffer_load_dwordx4 v2, s[44:47], s64 offen offset:3072 sc1 lds
  s_add_u32 s64, s64, 16384
  s_add_u32 m0, s66, 16384
  s_waitcnt lgkmcnt(1)
  v_mfma_f32_32x32x16_bf16 v[56:71], v[152:155], a[124:127], v[56:71]
  ds_read_b128 v[164:167], v2 offset:59392
  v_mfma_f32_32x32x16_bf16 v[56:71], v[156:159], a[128:131], v[56:71]
  ds_read_b128 v[144:147], v2 offset:60416
  buffer_load_dwordx4 v2, s[44:47], s64 offen sc1 lds
  s_waitcnt lgkmcnt(1)
  v_mfma_f32_32x32x16_bf16 v[56:71], v[160:163], a[132:135], v[56:71]
  ds_read_b128 v[148:151], v2 offset:61440
  v_mfma_f32_32x32x16_bf16 v[56:71], v[164:167], a[136:139], v[56:71]
  ds_read_b128 v[152:155], v2 offset:62464
  buffer_load_dwordx4 v2, s[44:47], s64 offen offset:1024 sc1 lds
  s_waitcnt lgkmcnt(1)
  v_mfma_f32_32x32x16_bf16 v[56:71], v[144:147], a[140:143], v[56:71]
  ds_read_b128 v[156:159], v2 offset:63488
  v_mfma_f32_32x32x16_bf16 v[56:71], v[148:151], a[144:147], v[56:71]
  ds_read_b128 v[160:163], v2 offset:64512
  buffer_load_dwordx4 v2, s[44:47], s64 offen offset:2048 sc1 lds
  s_waitcnt lgkmcnt(1)
  v_mfma_f32_32x32x16_bf16 v[56:71], v[152:155], a[148:151], v[56:71]
  ds_read_b128 v[164:167], v5 offset:2560
  v_mfma_f32_32x32x16_bf16 v[56:71], v[156:159], a[152:155], v[56:71]
  ds_read_b128 v[144:147], v3 offset:0
  buffer_load_dwordx4 v2, s[44:47], s64 offen offset:3072 sc1 lds
  s_add_u32 s64, s64, 16384
  s_add_u32 m0, s66, 32768
  s_waitcnt lgkmcnt(1)
  v_mfma_f32_32x32x16_bf16 v[56:71], v[160:163], a[156:159], v[56:71]
  ds_read_b128 v[148:151], v3 offset:1024
  v_mfma_f32_32x32x16_bf16 v[56:71], v[164:167], a[160:163], v[56:71]
  ds_read_b128 v[152:155], v3 offset:2048
  s_waitcnt vmcnt(11)
  v_cmp_eq_u32 vcc, 0, v184
  s_waitcnt lgkmcnt(1)
  v_mfma_f32_32x32x16_bf16 v[72:87], v[144:147], a[0:3], 0
  ds_read_b128 v[156:159], v3 offset:3072
  v_mfma_f32_32x32x16_bf16 v[72:87], v[148:151], a[4:7], v[72:87]
  ds_read_b128 v[160:163], v3 offset:4096
  s_cbranch_vccnz L_slow_29
L_back_30:
  buffer_load_dwordx4 a[164:167], v2, s[44:47], s78 offen sc1
  s_waitcnt lgkmcnt(1)
  v_mfma_f32_32x32x16_bf16 v[72:87], v[152:155], a[8:11], v[72:87]
  ds_read_b128 v[164:167], v3 offset:5120
  v_mfma_f32_32x32x16_bf16 v[72:87], v[156:159], a[12:15], v[72:87]
  ds_read_b128 v[144:147], v3 offset:6144
  buffer_load_dwordx4 a[168:171], v2, s[44:47], s78 offen offset:1024 sc1
  v_mul_f32 v176, v56, v11
  v_mul_f32 v64, v56, v64
  s_waitcnt lgkmcnt(1)
  v_mfma_f32_32x32x16_bf16 v[72:87], v[160:163], a[16:19], v[72:87]
  ds_read_b128 v[148:151], v3 offset:7168
  v_mul_f32 v177, v57, v11
  v_mul_f32 v65, v57, v65
  v_exp_f32 v176, v176
  v_mul_f32 v178, v58, v11
  v_mfma_f32_32x32x16_bf16 v[72:87], v[164:167], a[20:23], v[72:87]
  ds_read_b128 v[152:155], v3 offset:8192
  buffer_load_dwordx4 a[172:175], v2, s[44:47], s78 offen offset:2048 sc1
  v_mul_f32 v66, v58, v66
  s_waitcnt lgkmcnt(1)
  v_mfma_f32_32x32x16_bf16 v[72:87], v[144:147], a[24:27], v[72:87]
  ds_read_b128 v[156:159], v3 offset:9216
  v_exp_f32 v177, v177
  v_fma_f32 v176, v176, v12, v12
  v_mul_f32 v179, v59, v11
  v_mul_f32 v67, v59, v67
  v_mfma_f32_32x32x16_bf16 v[72:87], v[148:151], a[28:31], v[72:87]
  ds_read_b128 v[160:163], v3 offset:10240
  buffer_load_dwordx4 a[176:179], v2, s[44:47], s78 offen offset:3072 sc1
  s_add_u32 s78, s78, 4096
  s_waitcnt lgkmcnt(1)
  v_mfma_f32_32x32x16_bf16 v[72:87], v[152:155], a[32:35], v[72:87]
  ds_read_b128 v[164:167], v3 offset:11264
  v_exp_f32 v178, v178
  v_fma_f32 v177, v177, v12, v12
  v_rcp_f32 v176, v176
  v_mfma_f32_32x32x16_bf16 v[72:87], v[156:159], a[36:39], v[72:87]
  ds_read_b128 v[144:147], v3 offset:12288
  s_waitcnt vmcnt(14)
  buffer_store_dword v8, v7, s[44:47], s75 offen offset:256 sc1
  v_mul_f32 v180, v60, v11
  v_mul_f32 v68, v60, v68
  s_waitcnt lgkmcnt(1)
  v_mfma_f32_32x32x16_bf16 v[72:87], v[160:163], a[40:43], v[72:87]
  ds_read_b128 v[148:151], v3 offset:13312
  v_exp_f32 v179, v179
  v_fma_f32 v178, v178, v12, v12
  v_rcp_f32 v177, v177
  v_mfma_f32_32x32x16_bf16 v[72:87], v[164:167], a[44:47], v[72:87]
  ds_read_b128 v[152:155], v3 offset:14336
  buffer_load_dwordx4 a[180:183], v2, s[44:47], s78 offen sc1
  v_mul_f32 v64, v64, v176
  v_mul_f32 v181, v61, v11
  s_waitcnt lgkmcnt(1)
  v_mfma_f32_32x32x16_bf16 v[72:87], v[144:147], a[48:51], v[72:87]
  ds_read_b128 v[156:159], v3 offset:15360
  v_mul_f32 v69, v61, v69
  v_exp_f32 v180, v180
  v_fma_f32 v179, v179, v12, v12
  v_mfma_f32_32x32x16_bf16 v[72:87], v[148:151], a[52:55], v[72:87]
  s_waitcnt vmcnt(30)
  s_barrier
  ds_read_b128 v[160:163], v3 offset:16384
  s_waitcnt vmcnt(11)
  v_cmp_eq_u32 vcc, 0, v185
  buffer_load_dwordx4 a[184:187], v2, s[44:47], s78 offen offset:1024 sc1
  s_waitcnt lgkmcnt(1)
  v_mfma_f32_32x32x16_bf16 v[72:87], v[152:155], a[56:59], v[72:87]
  ds_read_b128 v[164:167], v3 offset:17408
  v_rcp_f32 v178, v178
  v_mul_f32 v65, v65, v177
  v_mul_f32 v182, v62, v11
  v_mul_f32 v70, v62, v70
  v_mfma_f32_32x32x16_bf16 v[72:87], v[156:159], a[60:63], v[72:87]
  ds_read_b128 v[144:147], v3 offset:18432
  s_cbranch_vccnz L_slow_31
L_back_32:
  buffer_load_dwordx4 a[188:191], v2, s[44:47], s78 offen offset:2048 sc1
  s_waitcnt lgkmcnt(1)
  v_mfma_f32_32x32x16_bf16 v[72:87], v[160:163], a[64:67], v[72:87]
  ds_read_b128 v[148:151], v3 offset:19456
  v_exp_f32 v181, v181
  v_fma_f32 v180, v180, v12, v12
  v_rcp_f32 v179, v179
  v_mfma_f32_32x32x16_bf16 v[72:87], v[164:167], a[68:71], v[72:87]
  ds_read_b128 v[152:155], v3 offset:20480
  buffer_load_dwordx4 a[192:195], v2, s[44:47], s78 offen offset:3072 sc1
  s_add_u32 s78, s78, 4096
  v_mul_f32 v66, v66, v178
  s_waitcnt lgkmcnt(1)
  v_mfma_f32_32x32x16_bf16 v[72:87], v[144:147], a[72:75], v[72:87]
  ds_read_b128 v[156:159], v3 offset:21504
  v_cvt_pk_bf16_f32 v56, v64, v65
  v_mul_f32 v183, v63, v11
  v_mul_f32 v71, v63, v71
  v_exp_f32 v182, v182
  v_mfma_f32_32x32x16_bf16 v[72:87], v[148:151], a[76:79], v[72:87]
  ds_read_b128 v[160:163], v3 offset:22528
  buffer_load_dwordx4 a[196:199], v2, s[44:47], s78 offen sc1
  v_fma_f32 v181, v181, v12, v12
  s_waitcnt lgkmcnt(1)
  v_mfma_f32_32x32x16_bf16 v[72:87], v[152:155], a[80:83], v[72:87]
  ds_read_b128 v[164:167], v3 offset:23552
  v_rcp_f32 v180, v180
  v_mul_f32 v67, v67, v179
  v_exp_f32 v183, v183
  v_mfma_f32_32x32x16_bf16 v[72:87], v[156:159], a[84:87], v[72:87]
  ds_read_b128 v[144:147], v3 offset:24576
  buffer_load_dwordx4 a[200:203], v2, s[44:47], s78 offen offset:1024 sc1
  v_fma_f32 v182, v182, v12, v12
  s_waitcnt lgkmcnt(1)
  v_mfma_f32_32x32x16_bf16 v[72:87], v[160:163], a[88:91], v[72:87]
  ds_read_b128 v[148:151], v3 offset:25600
  v_rcp_f32 v181, v181
  v_mul_f32 v68, v68, v180
  v_cvt_pk_bf16_f32 v57, v66, v67
  v_fma_f32 v183, v183, v12, v12
  v_mfma_f32_32x32x16_bf16 v[72:87], v[164:167], a[92:95], v[72:87]
  ds_read_b128 v[152:155], v3 offset:26624
  buffer_load_dwordx4 a[204:207], v2, s[44:47], s78 offen offset:2048 sc1
  v_rcp_f32 v182, v182
  s_waitcnt lgkmcnt(1)
  v_mfma_f32_32x32x16_bf16 v[72:87], v[144:147], a[96:99], v[72:87]
  ds_read_b128 v[156:159], v3 offset:27648
  v_mul_f32 v69, v69, v181
  v_rcp_f32 v183, v183
  v_mul_f32 v70, v70, v182
  v_cvt_pk_bf16_f32 v58, v68, v69
  v_mfma_f32_32x32x16_bf16 v[72:87], v[148:151], a[100:103], v[72:87]
  ds_read_b128 v[160:163], v3 offset:28672
  buffer_load_dwordx4 a[208:211], v2, s[44:47], s78 offen offset:3072 sc1
  s_add_u32 s78, s78, 4096
  v_mul_f32 v71, v71, v183
  s_waitcnt lgkmcnt(1)
  v_mfma_f32_32x32x16_bf16 v[72:87], v[152:155], a[104:107], v[72:87]
  ds_read_b128 v[164:167], v3 offset:29696
  v_cvt_pk_bf16_f32 v59, v70, v71
  buffer_store_dwordx4 v[56:59], v6, s[44:47], s73 offen sc1
  v_mfma_f32_32x32x16_bf16 v[72:87], v[156:159], a[108:111], v[72:87]
  ds_read_b128 v[144:147], v3 offset:30720
  s_waitcnt lgkmcnt(1)
  v_mfma_f32_32x32x16_bf16 v[72:87], v[160:163], a[112:115], v[72:87]
  ds_read_b128 v[148:151], v3 offset:31744
  buffer_load_dwordx4 v2, s[44:47], s64 offen sc1 lds
  v_mfma_f32_32x32x16_bf16 v[72:87], v[164:167], a[116:119], v[72:87]
  ds_read_b128 v[152:155], v3 offset:32768
  s_waitcnt lgkmcnt(1)
  v_mfma_f32_32x32x16_bf16 v[72:87], v[144:147], a[120:123], v[72:87]
  ds_read_b128 v[156:159], v3 offset:33792
  buffer_load_dwordx4 v2, s[44:47], s64 offen offset:1024 sc1 lds
  v_mfma_f32_32x32x16_bf16 v[72:87], v[148:151], a[124:127], v[72:87]
  ds_read_b128 v[160:163], v3 offset:34816
  s_waitcnt lgkmcnt(1)
  v_mfma_f32_32x32x16_bf16 v[72:87], v[152:155], a[128:131], v[72:87]
  ds_read_b128 v[164:167], v3 offset:35840
  buffer_load_dwordx4 v2, s[44:47], s64 offen offset:2048 sc1 lds
  v_mfma_f32_32x32x16_bf16 v[72:87], v[156:159], a[132:135], v[72:87]
  ds_read_b128 v[144:147], v3 offset:36864
  s_waitcnt lgkmcnt(1)
  v_mfma_f32_32x32x16_bf16 v[72:87], v[160:163], a[136:139], v[72:87]
  ds_read_b128 v[148:151], v3 offset:37888
  buffer_load_dwordx4 v2, s[44:47], s64 offen offset:3072 sc1 lds
  s_add_u32 s64, s64, 16384
  s_add_u32 m0, s66, 49152
  v_mfma_f32_32x32x16_bf16 v[72:87], v[164:167], a[140:143], v[72:87]
  ds_read_b128 v[152:155], v3 offset:38912
  s_waitcnt lgkmcnt(1)
  v_mfma_f32_32x32x16_bf16 v[72:87], v[144:147], a[144:147], v[72:87]
  ds_read_b128 v[156:159], v3 offset:39936
  buffer_load_dwordx4 v2, s[44:47], s64 offen sc1 lds
  v_mfma_f32_32x32x16_bf16 v[72:87], v[148:151], a[148:151], v[72:87]
  ds_read_b128 v[160:163], v5 offset:3072
  s_waitcnt lgkmcnt(1)
  v_mfma_f32_32x32x16_bf16 v[72:87], v[152:155], a[152:155], v[72:87]
  buffer_load_dwordx4 v2, s[44:47], s64 offen offset:1024 sc1 lds
  v_mfma_f32_32x32x16_bf16 v[72:87], v[156:159], a[156:159], v[72:87]
  s_waitcnt lgkmcnt(0)
  v_mfma_f32_32x32x16_bf16 v[72:87], v[160:163], a[160:163], v[72:87]
  buffer_load_dwordx4 v2, s[44:47], s64 offen offset:2048 sc1 lds
  s_waitcnt vmcnt(34)
  s_barrier
  ds_read_b128 v[164:167], v14 offset:49152
  ds_read_b128 v[144:147], v14 offset:50176
  ds_read_b128 v[148:151], v14 offset:51200
  s_nop 5
  v_mul_f32 v176, v72, v11
  v_mul_f32 v80, v72, v80
  v_mul_f32 v177, v73, v11
  v_mul_f32 v81, v73, v81
  v_exp_f32 v176, v176
  v_mul_f32 v178, v74, v11
  v_mul_f32 v82, v74, v82
  v_exp_f32 v177, v177
  v_fma_f32 v176, v176, v12, v12
  v_mul_f32 v179, v75, v11
  v_mul_f32 v83, v75, v83
  v_exp_f32 v178, v178
  buffer_load_dword v186, v9, s[44:47], s77 offen offset:128 sc1
  v_fma_f32 v177, v177, v12, v12
  v_rcp_f32 v176, v176
  v_mul_f32 v180, v76, v11
  v_mul_f32 v84, v76, v84
  v_exp_f32 v179, v179
  v_fma_f32 v178, v178, v12, v12
  v_rcp_f32 v177, v177
  v_mul_f32 v80, v80, v176
  v_mul_f32 v181, v77, v11
  v_mul_f32 v85, v77, v85
  v_exp_f32 v180, v180
  v_fma_f32 v179, v179, v12, v12
  buffer_load_dwordx4 v2, s[44:47], s64 offen offset:3072 sc1 lds
  s_add_u32 s64, s64, 16384
  s_add_u32 m0, s66, 65536
  v_rcp_f32 v178, v178
  v_mul_f32 v81, v81, v177
  v_mul_f32 v182, v78, v11
  v_mul_f32 v86, v78, v86
  v_exp_f32 v181, v181
  v_fma_f32 v180, v180, v12, v12
  v_rcp_f32 v179, v179
  v_mul_f32 v82, v82, v178
  v_cvt_pk_bf16_f32 v72, v80, v81
  v_mul_f32 v183, v79, v11
  v_mul_f32 v87, v79, v87
  v_exp_f32 v182, v182
  buffer_load_dwordx4 a[212:215], v2, s[44:47], s78 offen sc1
  v_fma_f32 v181, v181, v12, v12
  v_rcp_f32 v180, v180
  v_mul_f32 v83, v83, v179
  v_exp_f32 v183, v183
  v_fma_f32 v182, v182, v12, v12
  v_rcp_f32 v181, v181
  v_mul_f32 v84, v84, v180
  v_cvt_pk_bf16_f32 v73, v82, v83
  v_fma_f32 v183, v183, v12, v12
  v_rcp_f32 v182, v182
  v_mul_f32 v85, v85, v181
  v_rcp_f32 v183, v183
  buffer_load_dwordx4 a[216:219], v2, s[44:47], s78 offen offset:1024 sc1
  v_mul_f32 v86, v86, v182
  v_cvt_pk_bf16_f32 v74, v84, v85
  v_mul_f32 v87, v87, v183
  v_cvt_pk_bf16_f32 v75, v86, v87
  buffer_store_dwordx4 v[72:75], v6, s[44:47], s74 offen sc1
  s_waitcnt vmcnt(24) lgkmcnt(1)
  v_mfma_f32_16x16x32_bf16 v[104:107], v[164:167], a[164:167], 0
  ds_read_b128 v[152:155], v14 offset:52224
  v_mfma_f32_16x16x32_bf16 v[108:111], v[164:167], a[168:171], 0
  buffer_load_dwordx4 a[220:223], v2, s[44:47], s78 offen offset:2048 sc1
  v_mfma_f32_16x16x32_bf16 v[112:115], v[144:147], a[164:167], 0
  ds_read_b128 v[156:159], v14 offset:53248
  v_mfma_f32_16x16x32_bf16 v[116:119], v[144:147], a[168:171], 0
  buffer_load_dwordx4 a[224:227], v2, s[44:47], s78 offen offset:3072 sc1
  s_add_u32 s78, s78, 4096
  s_waitcnt lgkmcnt(1)
  v_mfma_f32_16x16x32_bf16 v[120:123], v[148:151], a[164:167], 0
  ds_read_b128 v[160:163], v14 offset:59392
  v_mfma_f32_16x16x32_bf16 v[124:127], v[148:151], a[168:171], 0
  s_waitcnt vmcnt(14)
  buffer_store_dword v8, v7, s[44:47], s75 offen offset:320 sc1
  v_mfma_f32_16x16x32_bf16 v[128:131], v[152:155], a[164:167], 0
  ds_read_b128 v[164:167], v14 offset:60416
  v_mfma_f32_16x16x32_bf16 v[132:135], v[152:155], a[168:171], 0
  buffer_load_dwordx4 v2, s[44:47], s64 offen sc1 lds
  s_waitcnt lgkmcnt(1)
  v_mfma_f32_16x16x32_bf16 v[136:139], v[156:159], a[164:167], 0
  ds_read_b128 v[144:147], v14 offset:61440
  v_mfma_f32_16x16x32_bf16 v[140:143], v[156:159], a[168:171], 0
  buffer_load_dwordx4 v2, s[44:47], s64 offen offset:1024 sc1 lds
  s_waitcnt vmcnt(27)
  v_mfma_f32_16x16x32_bf16 v[104:107], v[160:163], a[172:175], v[104:107]
  ds_read_b128 v[148:151], v14 offset:62464
  v_mfma_f32_16x16x32_bf16 v[108:111], v[160:163], a[176:179], v[108:111]
  buffer_load_dwordx4 v2, s[44:47], s64 offen offset:2048 sc1 lds
  s_waitcnt lgkmcnt(1)
  v_mfma_f32_16x16x32_bf16 v[112:115], v[164:167], a[172:175], v[112:115]
  ds_read_b128 v[152:155], v14 offset:63488
  v_mfma_f32_16x16x32_bf16 v[116:119], v[164:167], a[176:179], v[116:119]
  buffer_load_dwordx4 v2, s[44:47], s64 offen offset:3072 sc1 lds
  s_add_u32 s64, s64, 16384
  s_add_u32 m0, s66, 81920
  v_mfma_f32_16x16x32_bf16 v[120:123], v[144:147], a[172:175], v[120:123]
  ds_read_b128 v[156:159], v15 offset:4096
  v_mfma_f32_16x16x32_bf16 v[124:127], v[144:147], a[176:179], v[124:127]
  buffer_load_dwordx4 v2, s[44:47], s64 offen sc1 lds
  s_waitcnt lgkmcnt(1)
  v_mfma_f32_16x16x32_bf16 v[128:131], v[148:151], a[172:175], v[128:131]
  ds_read_b128 v[160:163], v15 offset:5120
  v_mfma_f32_16x16x32_bf16 v[132:135], v[148:151], a[176:179], v[132:135]
  buffer_load_dwordx4 v2, s[44:47], s64 offen offset:1024 sc1 lds
  v_mfma_f32_16x16x32_bf16 v[136:139], v[152:155], a[172:175], v[136:139]
  ds_read_b128 v[164:167], v15 offset:6144
  v_mfma_f32_16x16x32_bf16 v[140:143], v[152:155], a[176:179], v[140:143]
  buffer_load_dwordx4 v2, s[44:47], s64 offen offset:2048 sc1 lds
  s_waitcnt vmcnt(29) lgkmcnt(1)
  v_mfma_f32_16x16x32_bf16 v[104:107], v[156:159], a[180:183], v[104:107]
  ds_read_b128 v[144:147], v15 offset:7168
  v_mfma_f32_16x16x32_bf16 v[108:111], v[156:159], a[184:187], v[108:111]
  buffer_load_dwordx4 v2, s[44:47], s64 offen offset:3072 sc1 lds
  s_add_u32 s64, s64, 16384
  s_add_u32 m0, s66, 98304
  v_mfma_f32_16x16x32_bf16 v[112:115], v[160:163], a[180:183], v[112:115]
  ds_read_b128 v[148:151], v15 offset:8192
  v_mfma_f32_16x16x32_bf16 v[116:119], v[160:163], a[184:187], v[116:119]
  buffer_load_dwordx4 v2, s[44:47], s64 offen sc1 lds
  s_waitcnt lgkmcnt(1)
  v_mfma_f32_16x16x32_bf16 v[120:123], v[164:167], a[180:183], v[120:123]
  s_waitcnt vmcnt(38)
  s_barrier
  ds_read_b128 v[152:155], v16 offset:3072
  v_mfma_f32_16x16x32_bf16 v[124:127], v[164:167], a[184:187], v[124:127]
  buffer_load_dwordx4 v2, s[44:47], s64 offen offset:1024 sc1 lds
  v_mfma_f32_16x16x32_bf16 v[128:131], v[144:147], a[180:183], v[128:131]
  ds_read_b128 v[156:159], v16 offset:4096
  v_mfma_f32_16x16x32_bf16 v[132:135], v[144:147], a[184:187], v[132:135]
  buffer_load_dwordx4 v2, s[44:47], s64 offen offset:2048 sc1 lds
  s_waitcnt lgkmcnt(1)
  v_mfma_f32_16x16x32_bf16 v[136:139], v[148:151], a[180:183], v[136:139]
  ds_read_b128 v[160:163], v13 offset:0
  v_mfma_f32_16x16x32_bf16 v[140:143], v[148:151], a[184:187], v[140:143]
  buffer_load_dword v187, v9, s[44:47], s77 offen offset:192 sc1
  s_waitcnt vmcnt(32)
  v_mfma_f32_16x16x32_bf16 v[104:107], v[152:155], a[188:191], v[104:107]
  ds_read_b128 v[164:167], v13 offset:1024
  v_mfma_f32_16x16x32_bf16 v[108:111], v[152:155], a[192:195], v[108:111]
  buffer_load_dwordx4 v2, s[44:47], s64 offen offset:3072 sc1 lds
  s_add_u32 s64, s64, 16384
  s_add_u32 m0, s66, 114688
  s_waitcnt lgkmcnt(1)
  v_mfma_f32_16x16x32_bf16 v[112:115], v[156:159], a[188:191], v[112:115]
  ds_read_b128 v[144:147], v13 offset:2048
  v_mfma_f32_16x16x32_bf16 v[116:119], v[156:159], a[192:195], v[116:119]
  buffer_load_dwordx4 v2, s[44:47], s64 offen sc1 lds
  v_mfma_f32_16x16x32_bf16 v[120:123], v[160:163], a[188:191], v[120:123]
  ds_read_b128 v[148:151], v13 offset:8192
  v_mfma_f32_16x16x32_bf16 v[124:127], v[160:163], a[192:195], v[124:127]
  s_waitcnt vmcnt(21)
  v_cmp_eq_u32 vcc, 0, v186
  buffer_load_dwordx4 v2, s[44:47], s64 offen offset:1024 sc1 lds
  s_waitcnt lgkmcnt(1)
  v_mfma_f32_16x16x32_bf16 v[128:131], v[164:167], a[188:191], v[128:131]
  ds_read_b128 v[152:155], v13 offset:9216
  v_mfma_f32_16x16x32_bf16 v[132:135], v[164:167], a[192:195], v[132:135]
  buffer_load_dwordx4 v2, s[44:47], s64 offen offset:2048 sc1 lds
  v_mfma_f32_16x16x32_bf16 v[136:139], v[144:147], a[188:191], v[136:139]
  ds_read_b128 v[156:159], v13 offset:10240
  s_cbranch_vccnz L_slow_33
L_back_34:
  v_mfma_f32_16x16x32_bf16 v[140:143], v[144:147], a[192:195], v[140:143]
  buffer_load_dwordx4 a[228:231], v2, s[44:47], s78 offen sc1
  s_waitcnt vmcnt(35) lgkmcnt(1)
  v_mfma_f32_16x16x32_bf16 v[104:107], v[148:151], a[196:199], v[104:107]
  ds_read_b128 v[160:163], v13 offset:11264
  v_mfma_f32_16x16x32_bf16 v[108:111], v[148:151], a[200:203], v[108:111]
  buffer_load_dwordx4 a[232:235], v2, s[44:47], s78 offen offset:1024 sc1
  v_mfma_f32_16x16x32_bf16 v[112:115], v[152:155], a[196:199], v[112:115]
  ds_read_b128 v[164:167], v13 offset:12288
  v_mfma_f32_16x16x32_bf16 v[116:119], v[152:155], a[200:203], v[116:119]
  s_waitcnt vmcnt(21)
  buffer_store_dword v8, v7, s[44:47], s75 offen offset:384 sc1
  s_waitcnt lgkmcnt(1)
  v_mfma_f32_16x16x32_bf16 v[120:123], v[156:159], a[196:199], v[120:123]
  ds_read_b128 v[144:147], v13 offset:18432
  v_mfma_f32_16x16x32_bf16 v[124:127], v[156:159], a[200:203], v[124:127]
  buffer_load_dwordx4 a[236:239], v2, s[44:47], s78 offen offset:2048 sc1
  v_mfma_f32_16x16x32_bf16 v[128:131], v[160:163], a[196:199], v[128:131]
  ds_read_b128 v[148:151], v13 offset:19456
  v_mfma_f32_16x16x32_bf16 v[132:135], v[160:163], a[200:203], v[132:135]
  buffer_load_dwordx4 a[240:243], v2, s[44:47], s78 offen offset:3072 sc1
  s_add_u32 s78, s78, 4096
  s_waitcnt lgkmcnt(1)
  v_mfma_f32_16x16x32_bf16 v[136:139], v[164:167], a[196:199], v[136:139]
  ds_read_b128 v[152:155], v13 offset:20480
  v_mfma_f32_16x16x32_bf16 v[140:143], v[164:167], a[200:203], v[140:143]
  buffer_load_dwordx4 a[244:247], v2, s[44:47], s78 offen sc1
  s_waitcnt vmcnt(38)
  v_mfma_f32_16x16x32_bf16 v[104:107], v[144:147], a[204:207], v[104:107]
  ds_read_b128 v[156:159], v13 offset:21504
  v_mfma_f32_16x16x32_bf16 v[108:111], v[144:147], a[208:211], v[108:111]
  buffer_load_dwordx4 a[248:251], v2, s[44:47], s78 offen offset:1024 sc1
  s_waitcnt lgkmcnt(1)
  v_mfma_f32_16x16x32_bf16 v[112:115], v[148:151], a[204:207], v[112:115]
  ds_read_b128 v[160:163], v13 offset:22528
  v_mfma_f32_16x16x32_bf16 v[116:119], v[148:151], a[208:211], v[116:119]
  buffer_load_dwordx4 a[0:3], v2, s[44:47], s78 offen offset:2048 sc1
  v_mfma_f32_16x16x32_bf16 v[120:123], v[152:155], a[204:207], v[120:123]
  s_waitcnt vmcnt(30)
  s_barrier
  ds_read_b128 v[164:167], v13 offset:28672
  v_mfma_f32_16x16x32_bf16 v[124:127], v[152:155], a[208:211], v[124:127]
  buffer_load_dwordx4 a[4:7], v2, s[44:47], s78 offen offset:3072 sc1
  s_add_u32 s78, s78, 4096
  s_waitcnt lgkmcnt(1)
  v_mfma_f32_16x16x32_bf16 v[128:131], v[156:159], a[204:207], v[128:131]
  ds_read_b128 v[144:147], v13 offset:29696
  v_mfma_f32_16x16x32_bf16 v[132:135], v[156:159], a[208:211], v[132:135]
  buffer_load_dwordx4 v2, s[44:47], s64 offen offset:3072 sc1 lds
  s_add_u32 s64, s64, 16384
  s_add_u32 m0, s66, 131072
  v_mfma_f32_16x16x32_bf16 v[136:139], v[160:163], a[204:207], v[136:139]
  ds_read_b128 v[148:151], v13 offset:30720
  v_mfma_f32_16x16x32_bf16 v[140:143], v[160:163], a[208:211], v[140:143]
  buffer_load_dword v188, v9, s[44:47], s77 offen offset:256 sc1
  s_waitcnt vmcnt(31) lgkmcnt(1)
  v_mfma_f32_16x16x32_bf16 v[104:107], v[164:167], a[212:215], v[104:107]
  ds_read_b128 v[152:155], v13 offset:31744
  v_mfma_f32_16x16x32_bf16 v[108:111], v[164:167], a[216:219], v[108:111]
  buffer_load_dwordx4 v2, s[44:47], s64 offen sc1 lds
  v_mfma_f32_16x16x32_bf16 v[112:115], v[144:147], a[212:215], v[112:115]
  ds_read_b128 v[156:159], v13 offset:32768
  v_mfma_f32_16x16x32_bf16 v[116:119], v[144:147], a[216:219], v[116:119]
  buffer_load_dwordx4 v2, s[44:47], s64 offen offset:1024 sc1 lds
  s_waitcnt lgkmcnt(1)
  v_mfma_f32_16x16x32_bf16 v[120:123], v[148:151], a[212:215], v[120:123]
  ds_read_b128 v[160:163], v13 offset:38912
  s_waitcnt vmcnt(17)
  v_cmp_eq_u32 vcc, 0, v187
  v_mfma_f32_16x16x32_bf16 v[124:127], v[148:151], a[216:219], v[124:127]
  buffer_load_dwordx4 v2, s[44:47], s64 offen offset:2048 sc1 lds
  v_mfma_f32_16x16x32_bf16 v[128:131], v[152:155], a[212:215], v[128:131]
  ds_read_b128 v[164:167], v13 offset:39936
  v_mfma_f32_16x16x32_bf16 v[132:135], v[152:155], a[216:219], v[132:135]
  s_cbranch_vccnz L_slow_35
L_back_36:
  buffer_load_dwordx4 a[8:11], v2, s[44:47], s78 offen sc1
  s_waitcnt lgkmcnt(1)
  v_mfma_f32_16x16x32_bf16 v[136:139], v[156:159], a[212:215], v[136:139]
  ds_read_b128 v[144:147], v13 offset:40960
  v_mfma_f32_16x16x32_bf16 v[140:143], v[156:159], a[216:219], v[140:143]
  buffer_load_dwordx4 a[12:15], v2, s[44:47], s78 offen offset:1024 sc1
  s_waitcnt vmcnt(33)
  v_mfma_f32_16x16x32_bf16 v[104:107], v[160:163], a[220:223], v[104:107]
  ds_read_b128 v[148:151], v13 offset:41984
  v_mfma_f32_16x16x32_bf16 v[108:111], v[160:163], a[224:227], v[108:111]
  buffer_load_dwordx4 a[16:19], v2, s[44:47], s78 offen offset:2048 sc1
  s_waitcnt lgkmcnt(1)
  v_mfma_f32_16x16x32_bf16 v[112:115], v[164:167], a[220:223], v[112:115]
  ds_read_b128 v[152:155], v13 offset:43008
  v_mfma_f32_16x16x32_bf16 v[116:119], v[164:167], a[224:227], v[116:119]
  buffer_load_dwordx4 a[20:23], v2, s[44:47], s78 offen offset:3072 sc1
  s_add_u32 s78, s78, 4096
  v_mfma_f32_16x16x32_bf16 v[120:123], v[144:147], a[220:223], v[120:123]
  ds_read_b128 v[156:159], v13 offset:49152
  v_mfma_f32_16x16x32_bf16 v[124:127], v[144:147], a[224:227], v[124:127]
  buffer_load_dwordx4 a[24:27], v2, s[44:47], s78 offen sc1
  s_waitcnt lgkmcnt(1)
  v_mfma_f32_16x16x32_bf16 v[128:131], v[148:151], a[220:223], v[128:131]
  ds_read_b128 v[160:163], v13 offset:50176
  v_mfma_f32_16x16x32_bf16 v[132:135], v[148:151], a[224:227], v[132:135]
  buffer_load_dwordx4 a[28:31], v2, s[44:47], s78 offen offset:1024 sc1
  v_mfma_f32_16x16x32_bf16 v[136:139], v[152:155], a[220:223], v[136:139]
  ds_read_b128 v[164:167], v13 offset:51200
  v_mfma_f32_16x16x32_bf16 v[140:143], v[152:155], a[224:227], v[140:143]
  buffer_load_dwordx4 v2, s[44:47], s64 offen offset:3072 sc1 lds
  s_add_u32 s64, s64, 16384
  s_add_u32 m0, s66, 0
  s_waitcnt vmcnt(19) lgkmcnt(1)
  v_mfma_f32_16x16x32_bf16 v[104:107], v[156:159], a[228:231], v[104:107]
  ds_read_b128 v[144:147], v13 offset:52224
  v_mfma_f32_16x16x32_bf16 v[108:111], v[156:159], a[232:235], v[108:111]
  buffer_load_dwordx4 v2, s[44:47], s64 offen sc1 lds
  v_mfma_f32_16x16x32_bf16 v[112:115], v[160:163], a[228:231], v[112:115]
  ds_read_b128 v[148:151], v13 offset:53248
  v_mfma_f32_16x16x32_bf16 v[116:119], v[160:163], a[232:235], v[116:119]
  buffer_load_dwordx4 v2, s[44:47], s64 offen offset:1024 sc1 lds
  s_waitcnt lgkmcnt(1)
  v_mfma_f32_16x16x32_bf16 v[120:123], v[164:167], a[228:231], v[120:123]
  s_waitcnt vmcnt(31)
  s_barrier
  ds_read_b128 v[152:155], v13 offset:59392
  v_mfma_f32_16x16x32_bf16 v[124:127], v[164:167], a[232:235], v[124:127]
  buffer_load_dwordx4 v2, s[44:47], s64 offen offset:2048 sc1 lds
  v_mfma_f32_16x16x32_bf16 v[128:131], v[144:147], a[228:231], v[128:131]
  ds_read_b128 v[156:159], v13 offset:60416
  v_mfma_f32_16x16x32_bf16 v[132:135], v[144:147], a[232:235], v[132:135]
  buffer_load_dwordx4 v2, s[44:47], s64 offen offset:3072 sc1 lds
  s_add_u32 s64, s64, 16384
  s_add_u32 m0, s66, 16384
  s_waitcnt lgkmcnt(1)
  v_mfma_f32_16x16x32_bf16 v[136:139], v[148:151], a[228:231], v[136:139]
  ds_read_b128 v[160:163], v13 offset:61440
  v_mfma_f32_16x16x32_bf16 v[140:143], v[148:151], a[232:235], v[140:143]
  buffer_load_dwordx4 v2, s[44:47], s64 offen sc1 lds
  s_waitcnt vmcnt(21)
  v_mfma_f32_16x16x32_bf16 v[104:107], v[152:155], a[236:239], v[104:107]
  ds_read_b128 v[164:167], v13 offset:62464
  v_mfma_f32_16x16x32_bf16 v[108:111], v[152:155], a[240:243], v[108:111]
  buffer_load_dwordx4 v2, s[44:47], s64 offen offset:1024 sc1 lds
  s_waitcnt lgkmcnt(1)
  v_mfma_f32_16x16x32_bf16 v[112:115], v[156:159], a[236:239], v[112:115]
  ds_read_b128 v[144:147], v13 offset:63488
  v_mfma_f32_16x16x32_bf16 v[116:119], v[156:159], a[240:243], v[116:119]
  buffer_load_dwordx4 v2, s[44:47], s64 offen offset:2048 sc1 lds
  v_mfma_f32_16x16x32_bf16 v[120:123], v[160:163], a[236:239], v[120:123]
  ds_read_b128 v[148:151], v14 offset:4096
  s_waitcnt vmcnt(17)
  v_cmp_eq_u32 vcc, 0, v188
  v_mfma_f32_16x16x32_bf16 v[124:127], v[160:163], a[240:243], v[124:127]
  buffer_load_dwordx4 v2, s[44:47], s64 offen offset:3072 sc1 lds
  s_add_u32 s64, s64, 16384
  s_add_u32 m0, s66, 32768
  s_waitcnt lgkmcnt(1)
  v_mfma_f32_16x16x32_bf16 v[128:131], v[164:167], a[236:239], v[128:131]
  ds_read_b128 v[152:155], v14 offset:5120
  v_mfma_f32_16x16x32_bf16 v[132:135], v[164:167], a[240:243], v[132:135]
  s_cbranch_vccnz L_slow_37
L_back_38:
  buffer_load_dwordx4 a[32:35], v2, s[44:47], s78 offen offset:2048 sc1
  v_mfma_f32_16x16x32_bf16 v[136:139], v[144:147], a[236:239], v[136:139]
  ds_read_b128 v[156:159], v14 offset:6144
  v_mfma_f32_16x16x32_bf16 v[140:143], v[144:147], a[240:243], v[140:143]
  buffer_load_dword v189, v9, s[44:47], s77 offen offset:320 sc1
  s_waitcnt vmcnt(24) lgkmcnt(1)
  v_mfma_f32_16x16x32_bf16 v[104:107], v[148:151], a[244:247], v[104:107]
  ds_read_b128 v[160:163], v14 offset:7168
  v_mfma_f32_16x16x32_bf16 v[108:111], v[148:151], a[248:251], v[108:111]
  buffer_load_dwordx4 a[36:39], v2, s[44:47], s78 offen offset:3072 sc1
  s_add_u32 s78, s78, 4096
  v_mfma_f32_16x16x32_bf16 v[112:115], v[152:155], a[244:247], v[112:115]
  ds_read_b128 v[164:167], v14 offset:8192
  v_mfma_f32_16x16x32_bf16 v[116:119], v[152:155], a[248:251], v[116:119]
  buffer_load_dwordx4 a[40:43], v2, s[44:47], s78 offen sc1
  s_waitcnt lgkmcnt(1)
  v_mfma_f32_16x16x32_bf16 v[120:123], v[156:159], a[244:247], v[120:123]
  ds_read_b128 v[144:147], v14 offset:14336
  v_mfma_f32_16x16x32_bf16 v[124:127], v[156:159], a[248:251], v[124:127]
  buffer_load_dwordx4 a[44:47], v2, s[44:47], s78 offen offset:1024 sc1
  v_mfma_f32_16x16x32_bf16 v[128:131], v[160:163], a[244:247], v[128:131]
  ds_read_b128 v[148:151], v14 offset:15360
  v_mfma_f32_16x16x32_bf16 v[132:135], v[160:163], a[248:251], v[132:135]
  buffer_load_dwordx4 a[48:51], v2, s[44:47], s78 offen offset:2048 sc1
  s_waitcnt lgkmcnt(1)
  v_mfma_f32_16x16x32_bf16 v[136:139], v[164:167], a[244:247], v[136:139]
  ds_read_b128 v[152:155], v14 offset:16384
  v_mfma_f32_16x16x32_bf16 v[140:143], v[164:167], a[248:251], v[140:143]
  buffer_load_dwordx4 a[52:55], v2, s[44:47], s78 offen offset:3072 sc1
  s_add_u32 s78, s78, 4096
  s_waitcnt vmcnt(27)
  v_mfma_f32_16x16x32_bf16 v[104:107], v[144:147], a[0:3], v[104:107]
  ds_read_b128 v[156:159], v14 offset:17408
  v_mfma_f32_16x16x32_bf16 v[108:111], v[144:147], a[4:7], v[108:111]
  buffer_load_dwordx4 v2, s[44:47], s64 offen sc1 lds
  s_waitcnt lgkmcnt(1)
  v_mfma_f32_16x16x32_bf16 v[112:115], v[148:151], a[0:3], v[112:115]
  ds_read_b128 v[160:163], v14 offset:18432
  v_mfma_f32_16x16x32_bf16 v[116:119], v[148:151], a[4:7], v[116:119]
  buffer_load_dwordx4 v2, s[44:47], s64 offen offset:1024 sc1 lds
  v_mfma_f32_16x16x32_bf16 v[120:123], v[152:155], a[0:3], v[120:123]
  s_waitcnt vmcnt(28)
  s_barrier
  ds_read_b128 v[164:167], v14 offset:24576
  v_mfma_f32_16x16x32_bf16 v[124:127], v[152:155], a[4:7], v[124:127]
  buffer_load_dwordx4 v2, s[44:47], s64 offen offset:2048 sc1 lds
  s_waitcnt lgkmcnt(1)
  v_mfma_f32_16x16x32_bf16 v[128:131], v[156:159], a[0:3], v[128:131]
  ds_read_b128 v[144:147], v14 offset:25600
  v_mfma_f32_16x16x32_bf16 v[132:135], v[156:159], a[4:7], v[132:135]
  buffer_load_dwordx4 v2, s[44:47], s64 offen offset:3072 sc1 lds
  s_add_u32 s64, s64, 16384
  s_add_u32 m0, s66, 49152
  v_mfma_f32_16x16x32_bf16 v[136:139], v[160:163], a[0:3], v[136:139]
  ds_read_b128 v[148:151], v14 offset:26624
  v_mfma_f32_16x16x32_bf16 v[140:143], v[160:163], a[4:7], v[140:143]
  buffer_load_dwordx4 a[56:59], v2, s[44:47], s78 offen sc1
  s_waitcnt vmcnt(25) lgkmcnt(1)
  v_mfma_f32_16x16x32_bf16 v[104:107], v[164:167], a[8:11], v[104:107]
  ds_read_b128 v[152:155], v14 offset:27648
  v_mfma_f32_16x16x32_bf16 v[108:111], v[164:167], a[12:15], v[108:111]
  buffer_load_dwordx4 a[60:63], v2, s[44:47], s78 offen offset:1024 sc1
  v_mfma_f32_16x16x32_bf16 v[112:115], v[144:147], a[8:11], v[112:115]
  ds_read_b128 v[156:159], v14 offset:28672
  v_mfma_f32_16x16x32_bf16 v[116:119], v[144:147], a[12:15], v[116:119]
  buffer_load_dwordx4 v2, s[44:47], s64 offen sc1 lds
  s_waitcnt lgkmcnt(1)
  v_mfma_f32_16x16x32_bf16 v[120:123], v[148:151], a[8:11], v[120:123]
  ds_read_b128 v[160:163], v14 offset:34816
  v_mfma_f32_16x16x32_bf16 v[124:127], v[148:151], a[12:15], v[124:127]
  buffer_load_dwordx4 v2, s[44:47], s64 offen offset:1024 sc1 lds
  v_mfma_f32_16x16x32_bf16 v[128:131], v[152:155], a[8:11], v[128:131]
  ds_read_b128 v[164:167], v14 offset:35840
  v_mfma_f32_16x16x32_bf16 v[132:135], v[152:155], a[12:15], v[132:135]
  buffer_load_dwordx4 v2, s[44:47], s64 offen offset:2048 sc1 lds
  s_waitcnt lgkmcnt(1)
  v_mfma_f32_16x16x32_bf16 v[136:139], v[156:159], a[8:11], v[136:139]
  ds_read_b128 v[144:147], v14 offset:36864
  v_mfma_f32_16x16x32_bf16 v[140:143], v[156:159], a[12:15], v[140:143]
  buffer_load_dwordx4 v2, s[44:47], s64 offen offset:3072 sc1 lds
  s_add_u32 s64, s64, 16384
  s_add_u32 m0, s66, 65536
  s_waitcnt vmcnt(28)
  v_mfma_f32_16x16x32_bf16 v[104:107], v[160:163], a[16:19], v[104:107]
  ds_read_b128 v[148:151], v14 offset:37888
  v_mfma_f32_16x16x32_bf16 v[108:111], v[160:163], a[20:23], v[108:111]
  s_waitcnt lgkmcnt(1)
  v_mfma_f32_16x16x32_bf16 v[112:115], v[164:167], a[16:19], v[112:115]
  ds_read_b128 v[152:155], v14 offset:38912
  v_mfma_f32_16x16x32_bf16 v[116:119], v[164:167], a[20:23], v[116:119]
  v_mfma_f32_16x16x32_bf16 v[120:123], v[144:147], a[16:19], v[120:123]
  ds_read_b128 v[156:159], v14 offset:45056
  s_waitcnt vmcnt(15)
  v_cmp_eq_u32 vcc, 0, v189
  v_mfma_f32_16x16x32_bf16 v[124:127], v[144:147], a[20:23], v[124:127]
  s_waitcnt lgkmcnt(1)
  v_mfma_f32_16x16x32_bf16 v[128:131], v[148:151], a[16:19], v[128:131]
  ds_read_b128 v[160:163], v14 offset:46080
  v_mfma_f32_16x16x32_bf16 v[132:135], v[148:151], a[20:23], v[132:135]
  s_cbranch_vccnz L_slow_39
L_back_40:
  buffer_load_dwordx4 a[64:67], v2, s[44:47], s78 offen offset:2048 sc1
  v_mfma_f32_16x16x32_bf16 v[136:139], v[152:155], a[16:19], v[136:139]
  ds_read_b128 v[164:167], v14 offset:47104
  v_mfma_f32_16x16x32_bf16 v[140:143], v[152:155], a[20:23], v[140:143]
  buffer_load_dword v190, v9, s[44:47], s77 offen offset:384 sc1
  s_waitcnt vmcnt(28) lgkmcnt(1)
  v_mfma_f32_16x16x32_bf16 v[104:107], v[156:159], a[24:27], v[104:107]
  ds_read_b128 v[144:147], v14 offset:48128
  v_mfma_f32_16x16x32_bf16 v[108:111], v[156:159], a[28:31], v[108:111]
  buffer_load_dwordx4 a[68:71], v2, s[44:47], s78 offen offset:3072 sc1
  s_add_u32 s78, s78, 4096
  v_mfma_f32_16x16x32_bf16 v[112:115], v[160:163], a[24:27], v[112:115]
  ds_read_b128 v[148:151], v14 offset:49152
  v_mfma_f32_16x16x32_bf16 v[116:119], v[160:163], a[28:31], v[116:119]
  buffer_load_dwordx4 a[72:75], v2, s[44:47], s78 offen sc1
  s_waitcnt lgkmcnt(1)
  v_mfma_f32_16x16x32_bf16 v[120:123], v[164:167], a[24:27], v[120:123]
  s_waitcnt vmcnt(25)
  s_barrier
  ds_read_b128 v[152:155], v14 offset:55296
  v_mfma_f32_16x16x32_bf16 v[124:127], v[164:167], a[28:31], v[124:127]
  buffer_load_dwordx4 a[76:79], v2, s[44:47], s78 offen offset:1024 sc1
  v_mfma_f32_16x16x32_bf16 v[128:131], v[144:147], a[24:27], v[128:131]
  ds_read_b128 v[156:159], v14 offset:56320
  v_mfma_f32_16x16x32_bf16 v[132:135], v[144:147], a[28:31], v[132:135]
  buffer_load_dwordx4 a[80:83], v2, s[44:47], s78 offen offset:2048 sc1
  s_waitcnt lgkmcnt(1)
  v_mfma_f32_16x16x32_bf16 v[136:139], v[148:151], a[24:27], v[136:139]
  ds_read_b128 v[160:163], v14 offset:57344
  v_mfma_f32_16x16x32_bf16 v[140:143], v[148:151], a[28:31], v[140:143]
  buffer_load_dwordx4 a[84:87], v2, s[44:47], s78 offen offset:3072 sc1
  s_add_u32 s78, s78, 4096
  s_waitcnt vmcnt(21)
  v_mfma_f32_16x16x32_bf16 v[104:107], v[152:155], a[32:35], v[104:107]
  ds_read_b128 v[164:167], v14 offset:58368
  v_mfma_f32_16x16x32_bf16 v[108:111], v[152:155], a[36:39], v[108:111]
  buffer_load_dwordx4 a[88:91], v2, s[44:47], s78 offen sc1
  s_waitcnt lgkmcnt(1)
  v_mfma_f32_16x16x32_bf16 v[112:115], v[156:159], a[32:35], v[112:115]
  ds_read_b128 v[144:147], v14 offset:59392
  v_mfma_f32_16x16x32_bf16 v[116:119], v[156:159], a[36:39], v[116:119]
  buffer_load_dwordx4 a[92:95], v2, s[44:47], s78 offen offset:1024 sc1
  v_mfma_f32_16x16x32_bf16 v[120:123], v[160:163], a[32:35], v[120:123]
  ds_read_b128 v[148:151], v15 offset:0
  v_mfma_f32_16x16x32_bf16 v[124:127], v[160:163], a[36:39], v[124:127]
  buffer_load_dwordx4 v2, s[44:47], s64 offen sc1 lds
  s_waitcnt lgkmcnt(1)
  v_mfma_f32_16x16x32_bf16 v[128:131], v[164:167], a[32:35], v[128:131]
  ds_read_b128 v[152:155], v15 offset:1024
  v_mfma_f32_16x16x32_bf16 v[132:135], v[164:167], a[36:39], v[132:135]
  buffer_load_dwordx4 v2, s[44:47], s64 offen offset:1024 sc1 lds
  v_mfma_f32_16x16x32_bf16 v[136:139], v[144:147], a[32:35], v[136:139]
  ds_read_b128 v[156:159], v15 offset:2048
  v_mfma_f32_16x16x32_bf16 v[140:143], v[144:147], a[36:39], v[140:143]
  buffer_load_dwordx4 v2, s[44:47], s64 offen offset:2048 sc1 lds
  s_waitcnt vmcnt(24) lgkmcnt(1)
  v_mfma_f32_16x16x32_bf16 v[104:107], v[148:151], a[40:43], v[104:107]
  ds_read_b128 v[160:163], v15 offset:3072
  v_mfma_f32_16x16x32_bf16 v[108:111], v[148:151], a[44:47], v[108:111]
  buffer_load_dwordx4 v2, s[44:47], s64 offen offset:3072 sc1 lds
  s_add_u32 s64, s64, 16384
  s_add_u32 m0, s66, 81920
  v_mfma_f32_16x16x32_bf16 v[112:115], v[152:155], a[40:43], v[112:115]
  ds_read_b128 v[164:167], v15 offset:4096
  v_mfma_f32_16x16x32_bf16 v[116:119], v[152:155], a[44:47], v[116:119]
  buffer_load_dwordx4 v2, s[44:47], s64 offen sc1 lds
  s_waitcnt lgkmcnt(1)
  v_mfma_f32_16x16x32_bf16 v[120:123], v[156:159], a[40:43], v[120:123]
  ds_read_b128 v[144:147], v15 offset:10240
  v_mfma_f32_16x16x32_bf16 v[124:127], v[156:159], a[44:47], v[124:127]
  buffer_load_dwordx4 v2, s[44:47], s64 offen offset:1024 sc1 lds
  v_mfma_f32_16x16x32_bf16 v[128:131], v[160:163], a[40:43], v[128:131]
  ds_read_b128 v[148:151], v16 offset:0
  v_mfma_f32_16x16x32_bf16 v[132:135], v[160:163], a[44:47], v[132:135]
  buffer_load_dwordx4 v2, s[44:47], s64 offen offset:2048 sc1 lds
  s_waitcnt lgkmcnt(1)
  v_mfma_f32_16x16x32_bf16 v[136:139], v[164:167], a[40:43], v[136:139]
  ds_read_b128 v[152:155], v16 offset:1024
  v_mfma_f32_16x16x32_bf16 v[140:143], v[164:167], a[44:47], v[140:143]
  buffer_load_dwordx4 v2, s[44:47], s64 offen offset:3072 sc1 lds
  s_add_u32 s64, s64, 16384
  s_add_u32 m0, s66, 98304
  s_waitcnt vmcnt(27)
  v_mfma_f32_16x16x32_bf16 v[104:107], v[144:147], a[48:51], v[104:107]
  ds_read_b128 v[156:159], v16 offset:2048
  v_mfma_f32_16x16x32_bf16 v[108:111], v[144:147], a[52:55], v[108:111]
  s_waitcnt lgkmcnt(1)
  v_mfma_f32_16x16x32_bf16 v[112:115], v[148:151], a[48:51], v[112:115]
  ds_read_b128 v[160:163], v16 offset:3072
  v_mfma_f32_16x16x32_bf16 v[116:119], v[148:151], a[52:55], v[116:119]
  v_mfma_f32_16x16x32_bf16 v[120:123], v[152:155], a[48:51], v[120:123]
  s_waitcnt vmcnt(23)
  s_barrier
  ds_read_b128 v[164:167], v13 offset:4096
  s_waitcnt vmcnt(15)
  v_cmp_eq_u32 vcc, 0, v190
  v_mfma_f32_16x16x32_bf16 v[124:127], v[152:155], a[52:55], v[124:127]
  s_waitcnt lgkmcnt(1)
  v_mfma_f32_16x16x32_bf16 v[128:131], v[156:159], a[48:51], v[128:131]
  ds_read_b128 v[144:147], v13 offset:5120
  v_mfma_f32_16x16x32_bf16 v[132:135], v[156:159], a[52:55], v[132:135]
  s_cbranch_vccnz L_slow_41
L_back_42:
  buffer_load_dwordx4 a[96:99], v2, s[44:47], s78 offen offset:2048 sc1
  v_mfma_f32_16x16x32_bf16 v[136:139], v[160:163], a[48:51], v[136:139]
  ds_read_b128 v[148:151], v13 offset:6144
  v_mfma_f32_16x16x32_bf16 v[140:143], v[160:163], a[52:55], v[140:143]
  buffer_load_dwordx4 a[100:103], v2, s[44:47], s78 offen offset:3072 sc1
  s_add_u32 s78, s78, 4096
  s_waitcnt vmcnt(23) lgkmcnt(1)
  v_mfma_f32_16x16x32_bf16 v[104:107], v[164:167], a[56:59], v[104:107]
  ds_read_b128 v[152:155], v13 offset:7168
  v_mfma_f32_16x16x32_bf16 v[108:111], v[164:167], a[60:63], v[108:111]
  buffer_load_dwordx4 a[104:107], v2, s[44:47], s78 offen sc1
  v_mfma_f32_16x16x32_bf16 v[112:115], v[144:147], a[56:59], v[112:115]
  ds_read_b128 v[156:159], v13 offset:8192
  v_mfma_f32_16x16x32_bf16 v[116:119], v[144:147], a[60:63], v[116:119]
  buffer_load_dwordx4 a[108:111], v2, s[44:47], s78 offen offset:1024 sc1
  s_waitcnt lgkmcnt(1)
  v_mfma_f32_16x16x32_bf16 v[120:123], v[148:151], a[56:59], v[120:123]
  ds_read_b128 v[160:163], v13 offset:14336
  v_mfma_f32_16x16x32_bf16 v[124:127], v[148:151], a[60:63], v[124:127]
  buffer_load_dwordx4 a[112:115], v2, s[44:47], s78 offen offset:2048 sc1
  v_mfma_f32_16x16x32_bf16 v[128:131], v[152:155], a[56:59], v[128:131]
  ds_read_b128 v[164:167], v13 offset:15360
  v_mfma_f32_16x16x32_bf16 v[132:135], v[152:155], a[60:63], v[132:135]
  buffer_load_dwordx4 a[116:119], v2, s[44:47], s78 offen offset:3072 sc1
  s_add_u32 s78, s78, 4096
  s_waitcnt lgkmcnt(1)
  v_mfma_f32_16x16x32_bf16 v[136:139], v[156:159], a[56:59], v[136:139]
  ds_read_b128 v[144:147], v13 offset:16384
  v_mfma_f32_16x16x32_bf16 v[140:143], v[156:159], a[60:63], v[140:143]
  buffer_load_dwordx4 a[120:123], v2, s[44:47], s78 offen sc1
  s_waitcnt vmcnt(21)
  v_mfma_f32_16x16x32_bf16 v[104:107], v[160:163], a[64:67], v[104:107]
  ds_read_b128 v[148:151], v13 offset:17408
  v_mfma_f32_16x16x32_bf16 v[108:111], v[160:163], a[68:71], v[108:111]
  buffer_load_dwordx4 a[124:127], v2, s[44:47], s78 offen offset:1024 sc1
  s_waitcnt lgkmcnt(1)
  v_mfma_f32_16x16x32_bf16 v[112:115], v[164:167], a[64:67], v[112:115]
  ds_read_b128 v[152:155], v13 offset:18432
  v_mfma_f32_16x16x32_bf16 v[116:119], v[164:167], a[68:71], v[116:119]
  v_mfma_f32_16x16x32_bf16 v[120:123], v[144:147], a[64:67], v[120:123]
  ds_read_b128 v[156:159], v13 offset:24576
  v_mfma_f32_16x16x32_bf16 v[124:127], v[144:147], a[68:71], v[124:127]
  s_waitcnt lgkmcnt(1)
  v_mfma_f32_16x16x32_bf16 v[128:131], v[148:151], a[64:67], v[128:131]
  ds_read_b128 v[160:163], v13 offset:25600
  v_mfma_f32_16x16x32_bf16 v[132:135], v[148:151], a[68:71], v[132:135]
  v_mfma_f32_16x16x32_bf16 v[136:139], v[152:155], a[64:67], v[136:139]
  ds_read_b128 v[164:167], v13 offset:26624
  v_mfma_f32_16x16x32_bf16 v[140:143], v[152:155], a[68:71], v[140:143]
  s_waitcnt vmcnt(20) lgkmcnt(1)
  v_mfma_f32_16x16x32_bf16 v[104:107], v[156:159], a[72:75], v[104:107]
  ds_read_b128 v[144:147], v13 offset:27648
  v_mfma_f32_16x16x32_bf16 v[108:111], v[156:159], a[76:79], v[108:111]
  v_mfma_f32_16x16x32_bf16 v[112:115], v[160:163], a[72:75], v[112:115]
  ds_read_b128 v[148:151], v13 offset:28672
  v_mfma_f32_16x16x32_bf16 v[116:119], v[160:163], a[76:79], v[116:119]
  s_waitcnt lgkmcnt(1)
  v_mfma_f32_16x16x32_bf16 v[120:123], v[164:167], a[72:75], v[120:123]
  s_waitcnt vmcnt(25)
  s_barrier
  ds_read_b128 v[152:155], v13 offset:34816
  v_mfma_f32_16x16x32_bf16 v[124:127], v[164:167], a[76:79], v[124:127]
  v_mfma_f32_16x16x32_bf16 v[128:131], v[144:147], a[72:75], v[128:131]
  ds_read_b128 v[156:159], v13 offset:35840
  v_mfma_f32_16x16x32_bf16 v[132:135], v[144:147], a[76:79], v[132:135]
  s_waitcnt lgkmcnt(1)
  v_mfma_f32_16x16x32_bf16 v[136:139], v[148:151], a[72:75], v[136:139]
  ds_read_b128 v[160:163], v13 offset:36864
  v_mfma_f32_16x16x32_bf16 v[140:143], v[148:151], a[76:79], v[140:143]
  s_waitcnt vmcnt(18)
  v_mfma_f32_16x16x32_bf16 v[104:107], v[152:155], a[80:83], v[104:107]
  ds_read_b128 v[164:167], v13 offset:37888
  v_mfma_f32_16x16x32_bf16 v[108:111], v[152:155], a[84:87], v[108:111]
  s_waitcnt lgkmcnt(1)
  v_mfma_f32_16x16x32_bf16 v[112:115], v[156:159], a[80:83], v[112:115]
  ds_read_b128 v[144:147], v13 offset:38912
  v_mfma_f32_16x16x32_bf16 v[116:119], v[156:159], a[84:87], v[116:119]
  v_mfma_f32_16x16x32_bf16 v[120:123], v[160:163], a[80:83], v[120:123]
  ds_read_b128 v[148:151], v13 offset:45056
  v_mfma_f32_16x16x32_bf16 v[124:127], v[160:163], a[84:87], v[124:127]
  s_waitcnt lgkmcnt(1)
  v_mfma_f32_16x16x32_bf16 v[128:131], v[164:167], a[80:83], v[128:131]
  ds_read_b128 v[152:155], v13 offset:46080
  v_mfma_f32_16x16x32_bf16 v[132:135], v[164:167], a[84:87], v[132:135]
  v_mfma_f32_16x16x32_bf16 v[136:139], v[144:147], a[80:83], v[136:139]
  ds_read_b128 v[156:159], v13 offset:47104
  v_mfma_f32_16x16x32_bf16 v[140:143], v[144:147], a[84:87], v[140:143]
  s_waitcnt vmcnt(16) lgkmcnt(1)
  v_mfma_f32_16x16x32_bf16 v[104:107], v[148:151], a[88:91], v[104:107]
  ds_read_b128 v[160:163], v13 offset:48128
  v_mfma_f32_16x16x32_bf16 v[108:111], v[148:151], a[92:95], v[108:111]
  v_mfma_f32_16x16x32_bf16 v[112:115], v[152:155], a[88:91], v[112:115]
  ds_read_b128 v[164:167], v13 offset:49152
  v_mfma_f32_16x16x32_bf16 v[116:119], v[152:155], a[92:95], v[116:119]
  s_waitcnt lgkmcnt(1)
  v_mfma_f32_16x16x32_bf16 v[120:123], v[156:159], a[88:91], v[120:123]
  ds_read_b128 v[144:147], v13 offset:55296
  v_mfma_f32_16x16x32_bf16 v[124:127], v[156:159], a[92:95], v[124:127]
  v_mfma_f32_16x16x32_bf16 v[128:131], v[160:163], a[88:91], v[128:131]
  ds_read_b128 v[148:151], v13 offset:56320
  v_mfma_f32_16x16x32_bf16 v[132:135], v[160:163], a[92:95], v[132:135]
  s_waitcnt lgkmcnt(1)
  v_mfma_f32_16x16x32_bf16 v[136:139], v[164:167], a[88:91], v[136:139]
  ds_read_b128 v[152:155], v13 offset:57344
  v_mfma_f32_16x16x32_bf16 v[140:143], v[164:167], a[92:95], v[140:143]
  s_waitcnt vmcnt(6)
  v_mfma_f32_16x16x32_bf16 v[104:107], v[144:147], a[96:99], v[104:107]
  ds_read_b128 v[156:159], v13 offset:58368
  v_mfma_f32_16x16x32_bf16 v[108:111], v[144:147], a[100:103], v[108:111]
  s_waitcnt lgkmcnt(1)
  v_mfma_f32_16x16x32_bf16 v[112:115], v[148:151], a[96:99], v[112:115]
  ds_read_b128 v[160:163], v13 offset:59392
  v_mfma_f32_16x16x32_bf16 v[116:119], v[148:151], a[100:103], v[116:119]
  v_mfma_f32_16x16x32_bf16 v[120:123], v[152:155], a[96:99], v[120:123]
  s_waitcnt vmcnt(8)
  s_barrier
  ds_read_b128 v[164:167], v14 offset:0
  v_mfma_f32_16x16x32_bf16 v[124:127], v[152:155], a[100:103], v[124:127]
  s_waitcnt lgkmcnt(1)
  v_mfma_f32_16x16x32_bf16 v[128:131], v[156:159], a[96:99], v[128:131]
  ds_read_b128 v[144:147], v14 offset:1024
  v_mfma_f32_16x16x32_bf16 v[132:135], v[156:159], a[100:103], v[132:135]
  v_mfma_f32_16x16x32_bf16 v[136:139], v[160:163], a[96:99], v[136:139]
  ds_read_b128 v[148:151], v14 offset:2048
  v_mfma_f32_16x16x32_bf16 v[140:143], v[160:163], a[100:103], v[140:143]
  s_waitcnt vmcnt(4) lgkmcnt(1)
  v_mfma_f32_16x16x32_bf16 v[104:107], v[164:167], a[104:107], v[104:107]
  ds_read_b128 v[152:155], v14 offset:3072
  v_mfma_f32_16x16x32_bf16 v[108:111], v[164:167], a[108:111], v[108:111]
  v_mfma_f32_16x16x32_bf16 v[112:115], v[144:147], a[104:107], v[112:115]
  ds_read_b128 v[156:159], v14 offset:4096
  v_mfma_f32_16x16x32_bf16 v[116:119], v[144:147], a[108:111], v[116:119]
  s_waitcnt lgkmcnt(1)
  v_mfma_f32_16x16x32_bf16 v[120:123], v[148:151], a[104:107], v[120:123]
  ds_read_b128 v[160:163], v14 offset:10240
  v_mfma_f32_16x16x32_bf16 v[124:127], v[148:151], a[108:111], v[124:127]
  v_mfma_f32_16x16x32_bf16 v[128:131], v[152:155], a[104:107], v[128:131]
  ds_read_b128 v[164:167], v14 offset:11264
  v_mfma_f32_16x16x32_bf16 v[132:135], v[152:155], a[108:111], v[132:135]
  s_waitcnt lgkmcnt(1)
  v_mfma_f32_16x16x32_bf16 v[136:139], v[156:159], a[104:107], v[136:139]
  ds_read_b128 v[144:147], v14 offset:12288
  v_mfma_f32_16x16x32_bf16 v[140:143], v[156:159], a[108:111], v[140:143]
  s_waitcnt vmcnt(2)
  v_mfma_f32_16x16x32_bf16 v[104:107], v[160:163], a[112:115], v[104:107]
  ds_read_b128 v[148:151], v14 offset:13312
  v_mfma_f32_16x16x32_bf16 v[108:111], v[160:163], a[116:119], v[108:111]
  s_waitcnt lgkmcnt(1)
  v_mfma_f32_16x16x32_bf16 v[112:115], v[164:167], a[112:115], v[112:115]
  ds_read_b128 v[152:155], v14 offset:14336
  v_mfma_f32_16x16x32_bf16 v[116:119], v[164:167], a[116:119], v[116:119]
  v_mfma_f32_16x16x32_bf16 v[120:123], v[144:147], a[112:115], v[120:123]
  ds_read_b128 v[156:159], v14 offset:20480
  v_mfma_f32_16x16x32_bf16 v[124:127], v[144:147], a[116:119], v[124:127]
  s_waitcnt lgkmcnt(1)
  v_mfma_f32_16x16x32_bf16 v[128:131], v[148:151], a[112:115], v[128:131]
  ds_read_b128 v[160:163], v14 offset:21504
  v_mfma_f32_16x16x32_bf16 v[132:135], v[148:151], a[116:119], v[132:135]
  v_mfma_f32_16x16x32_bf16 v[136:139], v[152:155], a[112:115], v[136:139]
  ds_read_b128 v[164:167], v14 offset:22528
  v_mfma_f32_16x16x32_bf16 v[140:143], v[152:155], a[116:119], v[140:143]
  s_waitcnt vmcnt(0) lgkmcnt(1)
  v_mfma_f32_16x16x32_bf16 v[104:107], v[156:159], a[120:123], v[104:107]
  ds_read_b128 v[144:147], v14 offset:23552
  v_mfma_f32_16x16x32_bf16 v[108:111], v[156:159], a[124:127], v[108:111]
  v_mfma_f32_16x16x32_bf16 v[112:115], v[160:163], a[120:123], v[112:115]
  ds_read_b128 v[148:151], v14 offset:24576
  v_mfma_f32_16x16x32_bf16 v[116:119], v[160:163], a[124:127], v[116:119]
  s_waitcnt lgkmcnt(1)
  v_mfma_f32_16x16x32_bf16 v[120:123], v[164:167], a[120:123], v[120:123]
  v_mfma_f32_16x16x32_bf16 v[124:127], v[164:167], a[124:127], v[124:127]
  v_mfma_f32_16x16x32_bf16 v[128:131], v[144:147], a[120:123], v[128:131]
  v_mfma_f32_16x16x32_bf16 v[132:135], v[144:147], a[124:127], v[132:135]
  s_waitcnt lgkmcnt(0)
  v_mfma_f32_16x16x32_bf16 v[136:139], v[148:151], a[120:123], v[136:139]
  v_mfma_f32_16x16x32_bf16 v[140:143], v[148:151], a[124:127], v[140:143]
  s_lshr_b32 s54, s95, 3
  s_lshl_b32 s54, s54, 3
  s_add_u32 s54, s54, s96
  s_and_b32 s55, s95, 7
  s_mul_i32 s56, s3, 5120
  v_add_u32 v5, s56, v2
  s_xor_b32 s57, s3, 1
  s_mul_i32 s57, s57, 5120
  v_add_u32 v6, s57, v2
  s_and_b32 s58, s3, 1
  s_cmp_eq_u32 s58, 0
  s_cbranch_scc0 L_p5_kh1
  ds_write_b128 v5, v[108:111] offset:0
  ds_write_b128 v5, v[116:119] offset:1024
  ds_write_b128 v5, v[124:127] offset:2048
  ds_write_b128 v5, v[132:135] offset:3072
  ds_write_b128 v5, v[140:143] offset:4096
  v_mov_b32 v40, v104
  v_mov_b32 v41, v105
  v_mov_b32 v42, v106
  v_mov_b32 v43, v107
  v_mov_b32 v44, v112
  v_mov_b32 v45, v113
  v_mov_b32 v46, v114
  v_mov_b32 v47, v115
  v_mov_b32 v48, v120
  v_mov_b32 v49, v121
  v_mov_b32 v50, v122
  v_mov_b32 v51, v123
  v_mov_b32 v52, v128
  v_mov_b32 v53, v129
  v_mov_b32 v54, v130
  v_mov_b32 v55, v131
  v_mov_b32 v56, v136
  v_mov_b32 v57, v137
  v_mov_b32 v58, v138
  v_mov_b32 v59, v139
  s_branch L_p5_c
L_p5_kh1:
  ds_write_b128 v5, v[104:107] offset:0
  ds_write_b128 v5, v[112:115] offset:1024
  ds_write_b128 v5, v[120:123] offset:2048
  ds_write_b128 v5, v[128:131] offset:3072
  ds_write_b128 v5, v[136:139] offset:4096
  v_mov_b32 v40, v108
  v_mov_b32 v41, v109
  v_mov_b32 v42, v110
  v_mov_b32 v43, v111
  v_mov_b32 v44, v116
  v_mov_b32 v45, v117
  v_mov_b32 v46, v118
  v_mov_b32 v47, v119
  v_mov_b32 v48, v124
  v_mov_b32 v49, v125
  v_mov_b32 v50, v126
  v_mov_b32 v51, v127
  v_mov_b32 v52, v132
  v_mov_b32 v53, v133
  v_mov_b32 v54, v134
  v_mov_b32 v55, v135
  v_mov_b32 v56, v140
  v_mov_b32 v57, v141
  v_mov_b32 v58, v142
  v_mov_b32 v59, v143
L_p5_c:
  s_waitcnt lgkmcnt(0)
  s_barrier
  ds_read_b128 v[60:63], v6 offset:0
  ds_read_b128 v[64:67], v6 offset:1024
  ds_read_b128 v[68:71], v6 offset:2048
  ds_read_b128 v[72:75], v6 offset:3072
  ds_read_b128 v[76:79], v6 offset:4096
  v_and_b32 v4, 15, v1
  v_lshrrev_b32 v5, 4, v1
  v_mul_u32_u24 v6, 0xa000, v4
  v_and_b32 v7, 1, v5
  v_lshl_add_u32 v8, v7, 5, v6
  v_lshrrev_b32 v7, 1, v5
  v_lshl_add_u32 v8, v7, 4, v8
  v_lshl_add_u32 v9, v5, 3, v6
  s_lshl_b32 s56, s3, 9
  s_add_u32 s56, s56, s54
  s_mul_i32 s56, s56, 1280
  s_mul_i32 s57, s55, 160
  s_add_u32 s56, s56, s57
  s_waitcnt lgkmcnt(0)
  v_pk_add_f32 v[40:41], v[40:41], v[60:61]
  v_pk_fma_f32 v[40:41], v[40:41], v[20:21], v[232:233]
  v_pk_add_f32 v[42:43], v[42:43], v[62:63]
  v_pk_fma_f32 v[42:43], v[42:43], v[22:23], v[234:235]
  v_pk_add_f32 v[44:45], v[44:45], v[64:65]
  v_pk_fma_f32 v[44:45], v[44:45], v[24:25], v[236:237]
  v_pk_add_f32 v[46:47], v[46:47], v[66:67]
  v_pk_fma_f32 v[46:47], v[46:47], v[26:27], v[238:239]
  v_pk_add_f32 v[48:49], v[48:49], v[68:69]
  v_pk_fma_f32 v[48:49], v[48:49], v[28:29], v[240:241]
  v_pk_add_f32 v[50:51], v[50:51], v[70:71]
  v_pk_fma_f32 v[50:51], v[50:51], v[30:31], v[242:243]
  v_pk_add_f32 v[52:53], v[52:53], v[72:73]
  v_pk_fma_f32 v[52:53], v[52:53], v[32:33], v[244:245]
  v_pk_add_f32 v[54:55], v[54:55], v[74:75]
  v_pk_fma_f32 v[54:55], v[54:55], v[34:35], v[246:247]
  v_pk_add_f32 v[56:57], v[56:57], v[76:77]
  v_pk_fma_f32 v[56:57], v[56:57], v[36:37], v[248:249]
  v_pk_add_f32 v[58:59], v[58:59], v[78:79]
  v_pk_fma_f32 v[58:59], v[58:59], v[38:39], v[250:251]
  v_cvt_pk_bf16_f32 v60, v40, v41
  v_cvt_pk_bf16_f32 v61, v42, v43
  v_cvt_pk_bf16_f32 v62, v44, v45
  v_cvt_pk_bf16_f32 v63, v46, v47
  v_cvt_pk_bf16_f32 v64, v48, v49
  v_cvt_pk_bf16_f32 v65, v50, v51
  v_cvt_pk_bf16_f32 v66, v52, v53
  v_cvt_pk_bf16_f32 v67, v54, v55
  v_cvt_pk_bf16_f32 v68, v56, v57
  v_cvt_pk_bf16_f32 v69, v58, v59
  v_permlane16_swap_b32 v60, v62
  v_permlane16_swap_b32 v61, v63
  v_permlane16_swap_b32 v64, v66
  v_permlane16_swap_b32 v65, v67
  buffer_store_dwordx4 v[60:63], v8, s[36:39], s56 offen
  buffer_store_dwordx4 v[64:67], v8, s[36:39], s56 offen offset:64
  buffer_store_dwordx2 v[68:69], v9, s[36:39], s56 offen offset:128
L_end:
  s_endpgm
L_slow_27:
  s_mov_b32 s49, 0
L_sl_43:
  s_add_u32 s49, s49, 1
  s_cmp_gt_u32 s49, 100000
  s_cbranch_scc1 L_back_28
  buffer_load_dword v19, v17, s[44:47], s80 offen sc1
  s_waitcnt vmcnt(0)
  v_cmp_gt_u32 vcc, 54, v19
  s_nop 4
  s_cbranch_vccnz L_sl_43
  s_branch L_back_28
L_slow_29:
  s_mov_b32 s49, 0
L_sl_44:
  s_add_u32 s49, s49, 1
  s_cmp_gt_u32 s49, 100000
  s_cbranch_scc1 L_back_30
  buffer_load_dword v184, v9, s[44:47], s77 offen offset:0 sc1
  s_waitcnt vmcnt(0)
  v_cmp_eq_u32 vcc, 0, v184
  s_nop 4
  s_cbranch_vccnz L_sl_44
  s_branch L_back_30
L_slow_31:
  s_mov_b32 s49, 0
L_sl_45:
  s_add_u32 s49, s49, 1
  s_cmp_gt_u32 s49, 100000
  s_cbranch_scc1 L_back_32
  buffer_load_dword v185, v9, s[44:47], s77 offen offset:64 sc1
  s_waitcnt vmcnt(0)
  v_cmp_eq_u32 vcc, 0, v185
  s_nop 4
  s_cbranch_vccnz L_sl_45
  s_branch L_back_32
L_slow_33:
  s_mov_b32 s49, 0
L_sl_46:
  s_add_u32 s49, s49, 1
  s_cmp_gt_u32 s49, 100000
  s_cbranch_scc1 L_back_34
  buffer_load_dword v186, v9, s[44:47], s77 offen offset:128 sc1
  s_waitcnt vmcnt(0)
  v_cmp_eq_u32 vcc, 0, v186
  s_nop 4
  s_cbranch_vccnz L_sl_46
  s_branch L_back_34
L_slow_35:
  s_mov_b32 s49, 0
L_sl_47:
  s_add_u32 s49, s49, 1
  s_cmp_gt_u32 s49, 100000
  s_cbranch_scc1 L_back_36
  buffer_load_dword v187, v9, s[44:47], s77 offen offset:192 sc1
  s_waitcnt vmcnt(0)
  v_cmp_eq_u32 vcc, 0, v187
  s_nop 4
  s_cbranch_vccnz L_sl_47
  s_branch L_back_36
L_slow_37:
  s_mov_b32 s49, 0
L_sl_48:
  s_add_u32 s49, s49, 1
  s_cmp_gt_u32 s49, 100000
  s_cbranch_scc1 L_back_38
  buffer_load_dword v188, v9, s[44:47], s77 offen offset:256 sc1
  s_waitcnt vmcnt(0)
  v_cmp_eq_u32 vcc, 0, v188
  s_nop 4
  s_cbranch_vccnz L_sl_48
  s_branch L_back_38
L_slow_39:
  s_mov_b32 s49, 0
L_sl_49:
  s_add_u32 s49, s49, 1
  s_cmp_gt_u32 s49, 100000
  s_cbranch_scc1 L_back_40
  buffer_load_dword v189, v9, s[44:47], s77 offen offset:320 sc1
  s_waitcnt vmcnt(0)
  v_cmp_eq_u32 vcc, 0, v189
  s_nop 4
  s_cbranch_vccnz L_sl_49
  s_branch L_back_40
L_slow_41:
  s_mov_b32 s49, 0
L_sl_50:
  s_add_u32 s49, s49, 1
  s_cmp_gt_u32 s49, 100000
  s_cbranch_scc1 L_back_42
  buffer_load_dword v190, v9, s[44:47], s77 offen offset:384 sc1
  s_waitcnt vmcnt(0)
  v_cmp_eq_u32 vcc, 0, v190
  s_nop 4
  s_cbranch_vccnz L_sl_50
  s_branch L_back_42
L_code_end:
  s_endpgm
.section .rodata,"a"
.p2align 6
.amdhsa_kernel adaLN_cond__spectral_gfnet__glu_gated_swiglu__prompt_kernel
  .amdhsa_next_free_vgpr 512
  .amdhsa_next_free_sgpr 102
  .amdhsa_accum_offset 256
  .amdhsa_group_segment_fixed_size 0
  .amdhsa_kernarg_size 96
  .amdhsa_user_sgpr_count 2
  .amdhsa_user_sgpr_kernarg_segment_ptr 1
  .amdhsa_system_sgpr_workgroup_id_x 1
.end_amdhsa_kernel
```
